```python
import torch

def _softmax(x, axis=-1):
    return torch.softmax(x, dim=axis)
def _gelu(x):
    return torch.nn.functional.gelu(x, approximate="tanh")
def _silu(x):
    return torch.nn.functional.silu(x)
def _sigmoid(x):
    return torch.sigmoid(x)
def _layernorm(x, axis=-1, eps=1e-5):
    m = x.mean(dim=axis, keepdim=True)
    v = x.var(dim=axis, keepdim=True, unbiased=False)
    return (x - m) / torch.sqrt(v + eps)
def _scatter_add(tgt, idx, src, axis=0):
    return tgt.clone().index_add_(axis, idx, src)
def _segment_sum(src, seg, n):
    out = torch.zeros((n,) + src.shape[1:], dtype=src.dtype)
    return out.index_add_(0, seg, src)
def _pad(x, pw):
    flat = tuple(v for pair in reversed(pw) for v in pair)
    return torch.nn.functional.pad(x, flat)

kernel_name = 'standalone__gqa_block_cached__near_ridge'

def setup_inputs():

    _w = (lambda a: (lambda t: t.to(torch.bfloat16) if t.is_floating_point() else t)(torch.as_tensor(a)))
    B, Sq, D = 8, 64, 576
    Hq, Hkv, Sk, Dh = 32, 16, 2048, 128
    assert Hq % Hkv == 0, (Hq, Hkv)
    return {
        "x": _w((lambda *s: torch.randn(*s, dtype=torch.bfloat16) * 0.8)(B, Sq, D)),
        "k_cache": _w((lambda *s: torch.randn(*s, dtype=torch.bfloat16) * 0.8)(B, Hkv, Sk, Dh)),
        "v_cache": _w((lambda *s: torch.randn(*s, dtype=torch.bfloat16) * 0.05)(B, Hkv, Sk, Dh)),
        "wq": _w((lambda *s: torch.randn(*s, dtype=torch.bfloat16) * 0.8)(D, Hq * Dh) * (D ** -0.5)),
        "wo": _w((lambda *s: torch.randn(*s, dtype=torch.bfloat16) * 0.05)(Hq * Dh, D) * ((Hq * Dh) ** -0.5)),
    }

def reference(x, k_cache, v_cache, wq, wo):
    B, Sq, D = x.shape
    Hq, Dh = 32, 128
    Hkv = k_cache.shape[1]
    rep = Hq // Hkv
    q = (lambda x, *d: x.permute(*d))((x @ wq).reshape(B, Sq, Hq, Dh), 0, 2, 1, 3)
    k = (lambda x, n, axis: torch.repeat_interleave(x, n, dim=axis))(k_cache, rep, axis=1)
    v = (lambda x, n, axis: torch.repeat_interleave(x, n, dim=axis))(v_cache, rep, axis=1)
    scores = torch.einsum("bhqd,bhkd->bhqk", q, k) * (Dh ** -0.5)
    p = _softmax(scores, axis=-1)
    o = torch.einsum("bhqk,bhkd->bhqd", p, v)
    return (lambda x, *d: x.permute(*d))(o, 0, 2, 1, 3).reshape(B, Sq, Hq * Dh) @ wo
```

```asm
; @launch grid=(256,1,1) block=(256,1,1) lds=163840
.amdgcn_target "amdgcn-amd-amdhsa--gfx950"
.text
.globl standalone__gqa_block_cached__near_ridge_kernel
.p2align 8
.type standalone__gqa_block_cached__near_ridge_kernel,@function
standalone__gqa_block_cached__near_ridge_kernel:
  s_cmp_ge_u32 s2, 256
  s_cbranch_scc1 L1_done
  s_memrealtime s[92:93]
  s_load_dwordx4 s[4:7], s[0:1], 0
  s_load_dwordx4 s[8:11], s[0:1], 16
  s_load_dwordx4 s[16:19], s[0:1], 48
  s_load_dwordx4 s[12:15], s[0:1], 32
  v_lshrrev_b32 v2, 6, v0
  v_and_b32 v1, 63, v0
  s_and_b32 s21, s2, 7
  v_readfirstlane_b32 s20, v2
  s_lshr_b32 s22, s2, 3
  s_lshr_b32 s23, s22, 1
  s_and_b32 s24, s22, 1
  s_add_u32 s26, s23, s21
  s_and_b32 s26, s26, 7
  s_add_u32 s27, s24, 2
  s_cmp_lt_u32 s22, 16
  s_cselect_b32 s23, s23, s26
  s_cselect_b32 s24, s27, s24
  s_lshl_b32 s25, s21, 2
  s_add_u32 s25, s25, s24
  s_lshr_b32 s26, s25, 1
  s_lshl_b32 s27, s23, 4
  s_add_u32 s27, s27, s26
  s_lshl_b32 s27, s27, 19
  s_mul_i32 s28, s23, 73728
  s_lshl_b32 s55, s20, 13
  s_lshr_b32 s56, s24, 1
  s_lshl_b32 s56, s56, 2
  s_add_u32 s56, s56, s23
  s_sub_u32 s57, s56, 9
  s_cmp_ge_u32 s56, 9
  s_cselect_b32 s56, s57, s56
  v_lshrrev_b32 v2, 3, v1
  v_and_b32 v3, 7, v1
  s_lshl_b32 s29, s20, 4
  v_add_u32 v4, s29, v2
  v_mul_u32_u24 v4, 1152, v4
  v_lshl_add_u32 v148, v3, 4, v4
  v_add_u32 v149, 9216, v148
  v_lshrrev_b32 v2, 4, v1
  v_and_b32 v3, 15, v1
  v_lshlrev_b32 v5, 2, v2
  v_xor_b32 v5, v5, v3
  v_lshlrev_b32 v4, 13, v2
  v_lshl_add_u32 v4, v5, 4, v4
  s_lshl_b32 s29, s25, 8
  s_lshl_b32 s30, s20, 17
  s_add_u32 s29, s29, s30
  v_add_u32 v144, s29, v4
  v_add_u32 v145, 31744, v144
  v_add_u32 v146, 63488, v144
  v_add_u32 v147, 95232, v144
  v_lshlrev_b32 v4, 8, v2
  v_lshl_add_u32 v14, v5, 4, v4
  v_add_u32 v5, 0, v2
  v_xor_b32 v5, v5, v3
  v_lshl_add_u32 v10, v5, 4, v4
  v_add_u32 v5, 4, v2
  v_xor_b32 v5, v5, v3
  v_lshl_add_u32 v11, v5, 4, v4
  v_add_u32 v5, 8, v2
  v_xor_b32 v5, v5, v3
  v_lshl_add_u32 v12, v5, 4, v4
  v_add_u32 v5, 12, v2
  v_xor_b32 v5, v5, v3
  v_lshl_add_u32 v13, v5, 4, v4
  s_mov_b32 s52, s55
  s_mov_b32 s68, 32768
  s_mov_b32 s69, 32768
  s_mov_b32 s53, s52
  s_lshl_b32 s31, s20, 12
  s_lshl_b32 s58, s56, 7
  s_lshl_b32 s59, s56, 19
  s_waitcnt lgkmcnt(0)
  s_add_u32 s40, s4, s28
  s_addc_u32 s41, s5, 0
  s_mov_b32 s42, 73728
  s_mov_b32 s43, 0x20000
  s_mov_b32 s44, s10
  s_mov_b32 s45, s11
  s_mov_b32 s46, 4718592
  s_mov_b32 s47, 0x20000
  buffer_load_dwordx4 v[160:163], v148, s[40:43], s58 offen
  buffer_load_dwordx4 v[164:167], v149, s[40:43], s58 offen
  s_add_u32 m0, s31, 131072
  s_nop 0
  buffer_load_dwordx4 v144, s[44:47], s59 offen offset:0 lds
  buffer_load_dwordx4 v145, s[44:47], s59 offen offset:1024 lds
  buffer_load_dwordx4 v146, s[44:47], s59 offen offset:2048 lds
  buffer_load_dwordx4 v147, s[44:47], s59 offen offset:3072 lds
  s_add_u32 s58, s58, 128
  s_add_u32 s59, s59, 524288
  s_cmp_ge_u32 s58, 1152
  s_cselect_b32 s58, 0, s58
  s_cselect_b32 s59, 0, s59
  buffer_load_dwordx4 v[168:171], v148, s[40:43], s58 offen
  buffer_load_dwordx4 v[172:175], v149, s[40:43], s58 offen
  s_add_u32 m0, s31, 0
  s_nop 0
  buffer_load_dwordx4 v144, s[44:47], s59 offen offset:0 lds
  buffer_load_dwordx4 v145, s[44:47], s59 offen offset:1024 lds
  buffer_load_dwordx4 v146, s[44:47], s59 offen offset:2048 lds
  buffer_load_dwordx4 v147, s[44:47], s59 offen offset:3072 lds
  s_add_u32 s58, s58, 128
  s_add_u32 s59, s59, 524288
  s_cmp_ge_u32 s58, 1152
  s_cselect_b32 s58, 0, s58
  s_cselect_b32 s59, 0, s59
  s_add_u32 s32, s6, s27
  s_addc_u32 s33, s7, 0
  s_mov_b32 s34, 524288
  s_mov_b32 s35, 0x20000
  s_add_u32 s36, s8, s27
  s_addc_u32 s37, s9, 0
  s_mov_b32 s38, 524288
  s_mov_b32 s39, 0x20000
  s_add_u32 s48, s18, 0
  s_addc_u32 s49, s19, 0
  s_mov_b32 s50, 4227072
  s_mov_b32 s51, 0x20000
  s_or_b32 s29, s2, s20
  s_cmp_lg_u32 s29, 0
  s_cbranch_scc1 L1_noep
  s_or_b32 s92, s92, 1
  v_mov_b32 v2, s92
  v_lshlrev_b32 v3, 8, v1
  s_mov_b32 s84, s16
  s_mov_b32 s85, s17
  s_mov_b32 s86, 256
  s_mov_b32 s87, 0x20000
  buffer_store_dword v2, v3, s[84:87], 0 offen sc1
L1_noep:
  v_and_b32 v2, 31, v1
  v_lshrrev_b32 v3, 5, v1
  v_and_b32 v4, 15, v1
  v_lshlrev_b32 v2, 8, v2
  v_add_u32 v5, 0, v3
  v_xor_b32 v5, v5, v4
  v_lshl_add_u32 v16, v5, 4, v2
  v_add_u32 v248, 131072, v16
  v_add_u32 v16, s55, v16
  v_add_u32 v5, 2, v3
  v_xor_b32 v5, v5, v4
  v_lshl_add_u32 v17, v5, 4, v2
  v_add_u32 v249, 131072, v17
  v_add_u32 v17, s55, v17
  v_add_u32 v5, 4, v3
  v_xor_b32 v5, v5, v4
  v_lshl_add_u32 v18, v5, 4, v2
  v_add_u32 v250, 131072, v18
  v_add_u32 v18, s55, v18
  v_add_u32 v5, 6, v3
  v_xor_b32 v5, v5, v4
  v_lshl_add_u32 v19, v5, 4, v2
  v_add_u32 v251, 131072, v19
  v_add_u32 v19, s55, v19
  v_add_u32 v5, 8, v3
  v_xor_b32 v5, v5, v4
  v_lshl_add_u32 v20, v5, 4, v2
  v_add_u32 v252, 131072, v20
  v_add_u32 v20, s55, v20
  v_add_u32 v5, 10, v3
  v_xor_b32 v5, v5, v4
  v_lshl_add_u32 v21, v5, 4, v2
  v_add_u32 v253, 131072, v21
  v_add_u32 v21, s55, v21
  v_add_u32 v5, 12, v3
  v_xor_b32 v5, v5, v4
  v_lshl_add_u32 v22, v5, 4, v2
  v_add_u32 v254, 131072, v22
  v_add_u32 v22, s55, v22
  v_add_u32 v5, 14, v3
  v_xor_b32 v5, v5, v4
  v_lshl_add_u32 v23, v5, 4, v2
  v_add_u32 v255, 131072, v23
  v_add_u32 v23, s55, v23
  v_bfe_u32 v5, v1, 2, 2
  v_bfe_u32 v4, v1, 4, 1
  v_and_b32 v6, 3, v1
  v_lshlrev_b32 v2, 8, v5
  v_lshl_add_u32 v2, v4, 5, v2
  v_lshl_add_u32 v2, v6, 3, v2
  v_lshl_add_u32 v4, v3, 10, v2
  s_add_u32 s29, s55, 65536
  v_add_u32 v4, s29, v4
  s_add_u32 s30, s20, 0
  s_and_b32 s30, s30, 3
  v_xor_b32 v6, s30, v5
  v_lshl_add_u32 v24, v6, 6, v4
  s_add_u32 s30, s20, 1
  s_and_b32 s30, s30, 3
  v_xor_b32 v6, s30, v5
  v_lshl_add_u32 v25, v6, 6, v4
  s_add_u32 s30, s20, 2
  s_and_b32 s30, s30, 3
  v_xor_b32 v6, s30, v5
  v_lshl_add_u32 v26, v6, 6, v4
  s_add_u32 s30, s20, 3
  s_and_b32 s30, s30, 3
  v_xor_b32 v6, s30, v5
  v_lshl_add_u32 v27, v6, 6, v4
  v_lshl_add_u32 v4, v3, 11, v2
  s_lshr_b32 s29, s20, 1
  s_lshl_b32 s29, s29, 1
  s_add_u32 s30, s29, 0
  v_xor_b32 v6, s30, v5
  v_lshl_add_u32 v232, v6, 6, v4
  v_add_u32 v233, 0x10000, v232
  v_add_u32 v234, 0x20000, v232
  s_add_u32 s30, s29, 1
  v_xor_b32 v6, s30, v5
  v_lshl_add_u32 v235, v6, 6, v4
  v_add_u32 v236, 0x10000, v235
  v_add_u32 v237, 0x20000, v235
  v_lshlrev_b32 v15, 4, v1
  v_add_u32 v15, s55, v15
  s_lshl_b32 s29, s20, 11
  s_add_u32 s29, s29, 147456
  v_lshrrev_b32 v2, 3, v1
  v_and_b32 v4, 7, v1
  v_add_u32 v5, 0, v2
  v_lshrrev_b32 v6, 1, v5
  v_xor_b32 v6, v6, v4
  v_lshlrev_b32 v6, 4, v6
  v_lshl_add_u32 v6, v5, 7, v6
  v_add_u32 v150, s29, v6
  v_add_u32 v5, 8, v2
  v_lshrrev_b32 v6, 1, v5
  v_xor_b32 v6, v6, v4
  v_lshlrev_b32 v6, 4, v6
  v_lshl_add_u32 v6, v5, 7, v6
  v_add_u32 v151, s29, v6
  s_and_b32 s29, s20, 1
  s_lshl_b32 s29, s29, 12
  s_add_u32 s29, s29, 147456
  v_and_b32 v2, 31, v1
  v_bfe_u32 v4, v1, 1, 3
  v_lshlrev_b32 v2, 7, v2
  v_add_u32 v2, s29, v2
  v_add_u32 v5, 0, v3
  v_xor_b32 v5, v5, v4
  v_lshl_add_u32 v152, v5, 4, v2
  v_add_u32 v5, 2, v3
  v_xor_b32 v5, v5, v4
  v_lshl_add_u32 v153, v5, 4, v2
  v_add_u32 v5, 4, v3
  v_xor_b32 v5, v5, v4
  v_lshl_add_u32 v154, v5, 4, v2
  v_add_u32 v5, 6, v3
  v_xor_b32 v5, v5, v4
  v_lshl_add_u32 v155, v5, 4, v2
  s_and_b32 s29, s20, 1
  s_lshl_b32 s29, s29, 13
  s_add_u32 s29, s29, 131072
  v_and_b32 v2, 31, v1
  v_lshlrev_b32 v2, 8, v2
  v_lshl_add_u32 v2, v3, 3, v2
  v_add_u32 v2, s29, v2
  v_and_b32 v4, 15, v1
  s_lshr_b32 s29, s20, 1
  s_lshl_b32 s29, s29, 3
  v_xor_b32 v4, s29, v4
  v_xor_b32 v5, 0, v4
  v_lshl_add_u32 v240, v5, 4, v2
  v_xor_b32 v5, 1, v4
  v_lshl_add_u32 v241, v5, 4, v2
  v_xor_b32 v5, 2, v4
  v_lshl_add_u32 v242, v5, 4, v2
  v_xor_b32 v5, 3, v4
  v_lshl_add_u32 v243, v5, 4, v2
  v_xor_b32 v5, 4, v4
  v_lshl_add_u32 v244, v5, 4, v2
  v_xor_b32 v5, 5, v4
  v_lshl_add_u32 v245, v5, 4, v2
  v_xor_b32 v5, 6, v4
  v_lshl_add_u32 v246, v5, 4, v2
  v_xor_b32 v5, 7, v4
  v_lshl_add_u32 v247, v5, 4, v2
  s_mov_b32 s65, 0x3e0293ee
  s_mov_b32 s66, 0x41000000
  v_mov_b32 v34, 0
  v_mov_b32 v35, 0
  buffer_load_dwordx4 v[176:179], v148, s[40:43], s58 offen
  buffer_load_dwordx4 v[180:183], v149, s[40:43], s58 offen
  s_add_u32 m0, s31, 16384
  s_nop 0
  buffer_load_dwordx4 v144, s[44:47], s59 offen offset:0 lds
  buffer_load_dwordx4 v145, s[44:47], s59 offen offset:1024 lds
  buffer_load_dwordx4 v146, s[44:47], s59 offen offset:2048 lds
  buffer_load_dwordx4 v147, s[44:47], s59 offen offset:3072 lds
  s_add_u32 s58, s58, 128
  s_add_u32 s59, s59, 524288
  s_cmp_ge_u32 s58, 1152
  s_cselect_b32 s58, 0, s58
  s_cselect_b32 s59, 0, s59
  buffer_load_dwordx4 v[184:187], v148, s[40:43], s58 offen
  buffer_load_dwordx4 v[188:191], v149, s[40:43], s58 offen
  s_add_u32 m0, s31, 32768
  s_nop 0
  buffer_load_dwordx4 v144, s[44:47], s59 offen offset:0 lds
  buffer_load_dwordx4 v145, s[44:47], s59 offen offset:1024 lds
  buffer_load_dwordx4 v146, s[44:47], s59 offen offset:2048 lds
  buffer_load_dwordx4 v147, s[44:47], s59 offen offset:3072 lds
  s_add_u32 s58, s58, 128
  s_add_u32 s59, s59, 524288
  s_cmp_ge_u32 s58, 1152
  s_cselect_b32 s58, 0, s58
  s_cselect_b32 s59, 0, s59
  s_waitcnt vmcnt(22)
  ds_write_b128 v150, v[160:163] offset:0
  ds_write_b128 v151, v[164:167] offset:0
  s_waitcnt vmcnt(18)
  s_waitcnt lgkmcnt(0)
  s_barrier
  ds_read_b128 v[112:115], v152 offset:0
  ds_read_b128 v[116:119], v153 offset:0
  ds_read_b128 v[120:123], v154 offset:0
  ds_read_b128 v[124:127], v155 offset:0
  ds_read_b64_tr_b16 v[80:81], v234 offset:0
  ds_read_b64_tr_b16 v[82:83], v234 offset:1024
  ds_read_b64_tr_b16 v[84:85], v237 offset:0
  ds_read_b64_tr_b16 v[86:87], v237 offset:1024
  ds_read_b64_tr_b16 v[88:89], v234 offset:4096
  ds_read_b64_tr_b16 v[90:91], v234 offset:5120
  ds_read_b64_tr_b16 v[92:93], v237 offset:4096
  ds_read_b64_tr_b16 v[94:95], v237 offset:5120
  s_waitcnt vmcnt(16)
  ds_write_b128 v150, v[168:171] offset:8192
  ds_write_b128 v151, v[172:175] offset:8192
  ds_read_b64_tr_b16 v[96:97], v234 offset:8192
  s_waitcnt lgkmcnt(8)
  ds_read_b64_tr_b16 v[98:99], v234 offset:9216
  ds_read_b64_tr_b16 v[100:101], v237 offset:8192
  ds_read_b64_tr_b16 v[102:103], v237 offset:9216
  v_mfma_f32_32x32x16_bf16 v[48:63], v[80:83], v[112:115], 0
  buffer_load_dwordx4 v[192:195], v148, s[40:43], s58 offen
  buffer_load_dwordx4 v[196:199], v149, s[40:43], s58 offen
  ds_read_b64_tr_b16 v[104:105], v234 offset:12288
  ds_read_b64_tr_b16 v[106:107], v234 offset:13312
  s_waitcnt lgkmcnt(12)
  v_mfma_f32_32x32x16_bf16 v[64:79], v[84:87], v[112:115], 0
  s_add_u32 m0, s31, 49152
  s_nop 0
  buffer_load_dwordx4 v144, s[44:47], s59 offen offset:0 lds
  buffer_load_dwordx4 v145, s[44:47], s59 offen offset:1024 lds
  ds_read_b64_tr_b16 v[108:109], v237 offset:12288
  ds_read_b64_tr_b16 v[110:111], v237 offset:13312
  s_waitcnt lgkmcnt(12)
  v_mfma_f32_32x32x16_bf16 v[48:63], v[88:91], v[116:119], v[48:63]
  buffer_load_dwordx4 v146, s[44:47], s59 offen offset:2048 lds
  buffer_load_dwordx4 v147, s[44:47], s59 offen offset:3072 lds
  s_add_u32 s58, s58, 128
  s_add_u32 s59, s59, 524288
  s_cmp_ge_u32 s58, 1152
  s_cselect_b32 s58, 0, s58
  s_cselect_b32 s59, 0, s59
  s_waitcnt vmcnt(18)
  s_waitcnt lgkmcnt(8)
  s_barrier
  ds_read_b128 v[128:131], v152 offset:8192
  ds_read_b128 v[132:135], v153 offset:8192
  ds_read_b128 v[136:139], v154 offset:8192
  ds_read_b128 v[140:143], v155 offset:8192
  ds_read_b64_tr_b16 v[80:81], v232 offset:0
  ds_read_b64_tr_b16 v[82:83], v232 offset:1024
  v_mfma_f32_32x32x16_bf16 v[64:79], v[92:95], v[116:119], v[64:79]
  buffer_load_dwordx4 v[200:203], v148, s[40:43], s58 offen
  buffer_load_dwordx4 v[204:207], v149, s[40:43], s58 offen
  ds_read_b64_tr_b16 v[84:85], v235 offset:0
  s_waitcnt lgkmcnt(8)
  ds_read_b64_tr_b16 v[86:87], v235 offset:1024
  v_mfma_f32_32x32x16_bf16 v[48:63], v[96:99], v[120:123], v[48:63]
  s_add_u32 m0, s31, 65536
  s_nop 0
  buffer_load_dwordx4 v144, s[44:47], s59 offen offset:0 lds
  buffer_load_dwordx4 v145, s[44:47], s59 offen offset:1024 lds
  ds_read_b64_tr_b16 v[88:89], v232 offset:4096
  ds_read_b64_tr_b16 v[90:91], v232 offset:5120
  v_mfma_f32_32x32x16_bf16 v[64:79], v[100:103], v[120:123], v[64:79]
  buffer_load_dwordx4 v146, s[44:47], s59 offen offset:2048 lds
  buffer_load_dwordx4 v147, s[44:47], s59 offen offset:3072 lds
  s_add_u32 s58, s58, 128
  s_add_u32 s59, s59, 524288
  s_cmp_ge_u32 s58, 1152
  s_cselect_b32 s58, 0, s58
  s_cselect_b32 s59, 0, s59
  ds_read_b64_tr_b16 v[92:93], v235 offset:4096
  ds_read_b64_tr_b16 v[94:95], v235 offset:5120
  v_mfma_f32_32x32x16_bf16 v[48:63], v[104:107], v[124:127], v[48:63]
  s_waitcnt vmcnt(22)
  ds_write_b128 v150, v[176:179] offset:0
  ds_write_b128 v151, v[180:183] offset:0
  s_waitcnt lgkmcnt(8)
  ds_read_b64_tr_b16 v[96:97], v232 offset:8192
  ds_read_b64_tr_b16 v[98:99], v232 offset:9216
  v_mfma_f32_32x32x16_bf16 v[64:79], v[108:111], v[124:127], v[64:79]
  ds_read_b64_tr_b16 v[100:101], v235 offset:8192
  ds_read_b64_tr_b16 v[102:103], v235 offset:9216
  v_mfma_f32_32x32x16_bf16 v[48:63], v[80:83], v[128:131], v[48:63]
  ds_read_b64_tr_b16 v[104:105], v232 offset:12288
  ds_read_b64_tr_b16 v[106:107], v232 offset:13312
  s_waitcnt lgkmcnt(12)
  v_mfma_f32_32x32x16_bf16 v[64:79], v[84:87], v[128:131], v[64:79]
  ds_read_b64_tr_b16 v[108:109], v235 offset:12288
  ds_read_b64_tr_b16 v[110:111], v235 offset:13312
  s_waitcnt lgkmcnt(12)
  v_mfma_f32_32x32x16_bf16 v[48:63], v[88:91], v[132:135], v[48:63]
  s_waitcnt vmcnt(18)
  s_waitcnt lgkmcnt(8)
  s_barrier
  ds_read_b128 v[112:115], v152 offset:0
  ds_read_b128 v[116:119], v153 offset:0
  ds_read_b128 v[120:123], v154 offset:0
  ds_read_b128 v[124:127], v155 offset:0
  ds_read_b64_tr_b16 v[80:81], v232 offset:16384
  ds_read_b64_tr_b16 v[82:83], v232 offset:17408
  v_mfma_f32_32x32x16_bf16 v[64:79], v[92:95], v[132:135], v[64:79]
  buffer_load_dwordx4 v[208:211], v148, s[40:43], s58 offen
  buffer_load_dwordx4 v[212:215], v149, s[40:43], s58 offen
  ds_read_b64_tr_b16 v[84:85], v235 offset:16384
  s_waitcnt lgkmcnt(8)
  ds_read_b64_tr_b16 v[86:87], v235 offset:17408
  v_mfma_f32_32x32x16_bf16 v[48:63], v[96:99], v[136:139], v[48:63]
  s_add_u32 m0, s31, 81920
  s_nop 0
  buffer_load_dwordx4 v144, s[44:47], s59 offen offset:0 lds
  buffer_load_dwordx4 v145, s[44:47], s59 offen offset:1024 lds
  ds_read_b64_tr_b16 v[88:89], v232 offset:20480
  ds_read_b64_tr_b16 v[90:91], v232 offset:21504
  v_mfma_f32_32x32x16_bf16 v[64:79], v[100:103], v[136:139], v[64:79]
  buffer_load_dwordx4 v146, s[44:47], s59 offen offset:2048 lds
  buffer_load_dwordx4 v147, s[44:47], s59 offen offset:3072 lds
  s_add_u32 s58, s58, 128
  s_add_u32 s59, s59, 524288
  s_cmp_ge_u32 s58, 1152
  s_cselect_b32 s58, 0, s58
  s_cselect_b32 s59, 0, s59
  ds_read_b64_tr_b16 v[92:93], v235 offset:20480
  ds_read_b64_tr_b16 v[94:95], v235 offset:21504
  v_mfma_f32_32x32x16_bf16 v[48:63], v[104:107], v[140:143], v[48:63]
  s_waitcnt vmcnt(22)
  ds_write_b128 v150, v[184:187] offset:8192
  ds_write_b128 v151, v[188:191] offset:8192
  s_waitcnt lgkmcnt(8)
  ds_read_b64_tr_b16 v[96:97], v232 offset:24576
  ds_read_b64_tr_b16 v[98:99], v232 offset:25600
  v_mfma_f32_32x32x16_bf16 v[64:79], v[108:111], v[140:143], v[64:79]
  ds_read_b64_tr_b16 v[100:101], v235 offset:24576
  ds_read_b64_tr_b16 v[102:103], v235 offset:25600
  v_mfma_f32_32x32x16_bf16 v[48:63], v[80:83], v[112:115], v[48:63]
  ds_read_b64_tr_b16 v[104:105], v232 offset:28672
  ds_read_b64_tr_b16 v[106:107], v232 offset:29696
  s_waitcnt lgkmcnt(12)
  v_mfma_f32_32x32x16_bf16 v[64:79], v[84:87], v[112:115], v[64:79]
  ds_read_b64_tr_b16 v[108:109], v235 offset:28672
  ds_read_b64_tr_b16 v[110:111], v235 offset:29696
  s_waitcnt lgkmcnt(12)
  v_mfma_f32_32x32x16_bf16 v[48:63], v[88:91], v[116:119], v[48:63]
  s_waitcnt vmcnt(18)
  s_waitcnt lgkmcnt(8)
  s_barrier
  ds_read_b128 v[128:131], v152 offset:8192
  ds_read_b128 v[132:135], v153 offset:8192
  ds_read_b128 v[136:139], v154 offset:8192
  ds_read_b128 v[140:143], v155 offset:8192
  ds_read_b64_tr_b16 v[80:81], v232 offset:32768
  ds_read_b64_tr_b16 v[82:83], v232 offset:33792
  v_mfma_f32_32x32x16_bf16 v[64:79], v[92:95], v[116:119], v[64:79]
  buffer_load_dwordx4 v[216:219], v148, s[40:43], s58 offen
  buffer_load_dwordx4 v[220:223], v149, s[40:43], s58 offen
  ds_read_b64_tr_b16 v[84:85], v235 offset:32768
  s_waitcnt lgkmcnt(8)
  ds_read_b64_tr_b16 v[86:87], v235 offset:33792
  v_mfma_f32_32x32x16_bf16 v[48:63], v[96:99], v[120:123], v[48:63]
  s_add_u32 m0, s31, 98304
  s_nop 0
  buffer_load_dwordx4 v144, s[44:47], s59 offen offset:0 lds
  buffer_load_dwordx4 v145, s[44:47], s59 offen offset:1024 lds
  ds_read_b64_tr_b16 v[88:89], v232 offset:36864
  ds_read_b64_tr_b16 v[90:91], v232 offset:37888
  v_mfma_f32_32x32x16_bf16 v[64:79], v[100:103], v[120:123], v[64:79]
  buffer_load_dwordx4 v146, s[44:47], s59 offen offset:2048 lds
  buffer_load_dwordx4 v147, s[44:47], s59 offen offset:3072 lds
  s_add_u32 s58, s58, 128
  s_add_u32 s59, s59, 524288
  s_cmp_ge_u32 s58, 1152
  s_cselect_b32 s58, 0, s58
  s_cselect_b32 s59, 0, s59
  ds_read_b64_tr_b16 v[92:93], v235 offset:36864
  ds_read_b64_tr_b16 v[94:95], v235 offset:37888
  v_mfma_f32_32x32x16_bf16 v[48:63], v[104:107], v[124:127], v[48:63]
  s_waitcnt vmcnt(22)
  ds_write_b128 v150, v[192:195] offset:0
  ds_write_b128 v151, v[196:199] offset:0
  s_waitcnt lgkmcnt(8)
  ds_read_b64_tr_b16 v[96:97], v232 offset:40960
  ds_read_b64_tr_b16 v[98:99], v232 offset:41984
  v_mfma_f32_32x32x16_bf16 v[64:79], v[108:111], v[124:127], v[64:79]
  ds_read_b64_tr_b16 v[100:101], v235 offset:40960
  ds_read_b64_tr_b16 v[102:103], v235 offset:41984
  v_mfma_f32_32x32x16_bf16 v[48:63], v[80:83], v[128:131], v[48:63]
  ds_read_b64_tr_b16 v[104:105], v232 offset:45056
  ds_read_b64_tr_b16 v[106:107], v232 offset:46080
  s_waitcnt lgkmcnt(12)
  v_mfma_f32_32x32x16_bf16 v[64:79], v[84:87], v[128:131], v[64:79]
  ds_read_b64_tr_b16 v[108:109], v235 offset:45056
  ds_read_b64_tr_b16 v[110:111], v235 offset:46080
  s_waitcnt lgkmcnt(12)
  v_mfma_f32_32x32x16_bf16 v[48:63], v[88:91], v[132:135], v[48:63]
  s_waitcnt vmcnt(18)
  s_waitcnt lgkmcnt(8)
  s_barrier
  ds_read_b128 v[112:115], v152 offset:0
  ds_read_b128 v[116:119], v153 offset:0
  ds_read_b128 v[120:123], v154 offset:0
  ds_read_b128 v[124:127], v155 offset:0
  ds_read_b64_tr_b16 v[80:81], v232 offset:49152
  ds_read_b64_tr_b16 v[82:83], v232 offset:50176
  v_mfma_f32_32x32x16_bf16 v[64:79], v[92:95], v[132:135], v[64:79]
  buffer_load_dwordx4 v[224:227], v148, s[40:43], s58 offen
  buffer_load_dwordx4 v[228:231], v149, s[40:43], s58 offen
  ds_read_b64_tr_b16 v[84:85], v235 offset:49152
  s_waitcnt lgkmcnt(8)
  ds_read_b64_tr_b16 v[86:87], v235 offset:50176
  v_mfma_f32_32x32x16_bf16 v[48:63], v[96:99], v[136:139], v[48:63]
  s_add_u32 m0, s31, 114688
  s_nop 0
  buffer_load_dwordx4 v144, s[44:47], s59 offen offset:0 lds
  buffer_load_dwordx4 v145, s[44:47], s59 offen offset:1024 lds
  ds_read_b64_tr_b16 v[88:89], v232 offset:53248
  ds_read_b64_tr_b16 v[90:91], v232 offset:54272
  v_mfma_f32_32x32x16_bf16 v[64:79], v[100:103], v[136:139], v[64:79]
  buffer_load_dwordx4 v146, s[44:47], s59 offen offset:2048 lds
  buffer_load_dwordx4 v147, s[44:47], s59 offen offset:3072 lds
  ds_read_b64_tr_b16 v[92:93], v235 offset:53248
  ds_read_b64_tr_b16 v[94:95], v235 offset:54272
  v_mfma_f32_32x32x16_bf16 v[48:63], v[104:107], v[140:143], v[48:63]
  s_add_u32 m0, s55, 0
  s_add_u32 s54, s52, 4096
  buffer_load_dwordx4 v10, s[32:35], s52 offen offset:0 sc1 nt lds
  buffer_load_dwordx4 v11, s[32:35], s52 offen offset:1024 sc1 nt lds
  s_waitcnt vmcnt(24)
  ds_write_b128 v150, v[200:203] offset:8192
  ds_write_b128 v151, v[204:207] offset:8192
  s_waitcnt lgkmcnt(8)
  ds_read_b64_tr_b16 v[96:97], v232 offset:57344
  ds_read_b64_tr_b16 v[98:99], v232 offset:58368
  v_mfma_f32_32x32x16_bf16 v[64:79], v[108:111], v[140:143], v[64:79]
  buffer_load_dwordx4 v12, s[32:35], s52 offen offset:2048 sc1 nt lds
  buffer_load_dwordx4 v13, s[32:35], s52 offen offset:3072 sc1 nt lds
  ds_read_b64_tr_b16 v[100:101], v235 offset:57344
  ds_read_b64_tr_b16 v[102:103], v235 offset:58368
  v_mfma_f32_32x32x16_bf16 v[48:63], v[80:83], v[112:115], v[48:63]
  s_add_u32 m0, s55, 4096
  s_nop 0
  buffer_load_dwordx4 v10, s[32:35], s54 offen offset:0 sc1 nt lds
  buffer_load_dwordx4 v11, s[32:35], s54 offen offset:1024 sc1 nt lds
  ds_read_b64_tr_b16 v[104:105], v232 offset:61440
  ds_read_b64_tr_b16 v[106:107], v232 offset:62464
  s_waitcnt lgkmcnt(12)
  v_mfma_f32_32x32x16_bf16 v[64:79], v[84:87], v[112:115], v[64:79]
  buffer_load_dwordx4 v12, s[32:35], s54 offen offset:2048 sc1 nt lds
  buffer_load_dwordx4 v13, s[32:35], s54 offen offset:3072 sc1 nt lds
  s_add_u32 s52, s52, s68
  ds_read_b64_tr_b16 v[108:109], v235 offset:61440
  ds_read_b64_tr_b16 v[110:111], v235 offset:62464
  s_waitcnt lgkmcnt(12)
  v_mfma_f32_32x32x16_bf16 v[48:63], v[88:91], v[116:119], v[48:63]
  s_waitcnt vmcnt(26)
  s_waitcnt lgkmcnt(8)
  s_barrier
  ds_read_b128 v[128:131], v152 offset:8192
  ds_read_b128 v[132:135], v153 offset:8192
  ds_read_b128 v[136:139], v154 offset:8192
  ds_read_b128 v[140:143], v155 offset:8192
  ds_read_b64_tr_b16 v[80:81], v233 offset:0
  ds_read_b64_tr_b16 v[82:83], v233 offset:1024
  v_mfma_f32_32x32x16_bf16 v[64:79], v[92:95], v[116:119], v[64:79]
  ds_read_b64_tr_b16 v[84:85], v236 offset:0
  s_waitcnt lgkmcnt(8)
  ds_read_b64_tr_b16 v[86:87], v236 offset:1024
  v_mfma_f32_32x32x16_bf16 v[48:63], v[96:99], v[120:123], v[48:63]
  ds_read_b64_tr_b16 v[88:89], v233 offset:4096
  ds_read_b64_tr_b16 v[90:91], v233 offset:5120
  v_mfma_f32_32x32x16_bf16 v[64:79], v[100:103], v[120:123], v[64:79]
  ds_read_b64_tr_b16 v[92:93], v236 offset:4096
  ds_read_b64_tr_b16 v[94:95], v236 offset:5120
  v_mfma_f32_32x32x16_bf16 v[48:63], v[104:107], v[124:127], v[48:63]
  s_waitcnt vmcnt(24)
  ds_write_b128 v150, v[208:211] offset:0
  ds_write_b128 v151, v[212:215] offset:0
  s_waitcnt lgkmcnt(8)
  ds_read_b64_tr_b16 v[96:97], v233 offset:8192
  ds_read_b64_tr_b16 v[98:99], v233 offset:9216
  v_mfma_f32_32x32x16_bf16 v[64:79], v[108:111], v[124:127], v[64:79]
  ds_read_b64_tr_b16 v[100:101], v236 offset:8192
  ds_read_b64_tr_b16 v[102:103], v236 offset:9216
  v_mfma_f32_32x32x16_bf16 v[48:63], v[80:83], v[128:131], v[48:63]
  ds_read_b64_tr_b16 v[104:105], v233 offset:12288
  ds_read_b64_tr_b16 v[106:107], v233 offset:13312
  s_waitcnt lgkmcnt(12)
  v_mfma_f32_32x32x16_bf16 v[64:79], v[84:87], v[128:131], v[64:79]
  ds_read_b64_tr_b16 v[108:109], v236 offset:12288
  ds_read_b64_tr_b16 v[110:111], v236 offset:13312
  s_waitcnt lgkmcnt(12)
  v_mfma_f32_32x32x16_bf16 v[48:63], v[88:91], v[132:135], v[48:63]
  s_waitcnt vmcnt(20)
  s_waitcnt lgkmcnt(8)
  s_barrier
  ds_read_b128 v[112:115], v152 offset:0
  ds_read_b128 v[116:119], v153 offset:0
  ds_read_b128 v[120:123], v154 offset:0
  ds_read_b128 v[124:127], v155 offset:0
  ds_read_b64_tr_b16 v[80:81], v233 offset:16384
  ds_read_b64_tr_b16 v[82:83], v233 offset:17408
  v_mfma_f32_32x32x16_bf16 v[64:79], v[92:95], v[132:135], v[64:79]
  s_add_u32 m0, s55, 32768
  s_add_u32 s54, s52, 4096
  buffer_load_dwordx4 v10, s[32:35], s52 offen offset:0 sc1 nt lds
  buffer_load_dwordx4 v11, s[32:35], s52 offen offset:1024 sc1 nt lds
  ds_read_b64_tr_b16 v[84:85], v236 offset:16384
  s_waitcnt lgkmcnt(8)
  ds_read_b64_tr_b16 v[86:87], v236 offset:17408
  v_mfma_f32_32x32x16_bf16 v[48:63], v[96:99], v[136:139], v[48:63]
  buffer_load_dwordx4 v12, s[32:35], s52 offen offset:2048 sc1 nt lds
  buffer_load_dwordx4 v13, s[32:35], s52 offen offset:3072 sc1 nt lds
  ds_read_b64_tr_b16 v[88:89], v233 offset:20480
  ds_read_b64_tr_b16 v[90:91], v233 offset:21504
  v_mfma_f32_32x32x16_bf16 v[64:79], v[100:103], v[136:139], v[64:79]
  s_add_u32 m0, s55, 36864
  s_nop 0
  buffer_load_dwordx4 v10, s[32:35], s54 offen offset:0 sc1 nt lds
  buffer_load_dwordx4 v11, s[32:35], s54 offen offset:1024 sc1 nt lds
  ds_read_b64_tr_b16 v[92:93], v236 offset:20480
  ds_read_b64_tr_b16 v[94:95], v236 offset:21504
  v_mfma_f32_32x32x16_bf16 v[48:63], v[104:107], v[140:143], v[48:63]
  buffer_load_dwordx4 v12, s[32:35], s54 offen offset:2048 sc1 nt lds
  buffer_load_dwordx4 v13, s[32:35], s54 offen offset:3072 sc1 nt lds
  s_add_u32 s52, s52, s69
  s_waitcnt vmcnt(26)
  ds_write_b128 v150, v[216:219] offset:8192
  ds_write_b128 v151, v[220:223] offset:8192
  s_waitcnt lgkmcnt(8)
  ds_read_b64_tr_b16 v[96:97], v233 offset:24576
  ds_read_b64_tr_b16 v[98:99], v233 offset:25600
  v_mfma_f32_32x32x16_bf16 v[64:79], v[108:111], v[140:143], v[64:79]
  ds_read_b64_tr_b16 v[100:101], v236 offset:24576
  ds_read_b64_tr_b16 v[102:103], v236 offset:25600
  v_mfma_f32_32x32x16_bf16 v[48:63], v[80:83], v[112:115], v[48:63]
  ds_read_b64_tr_b16 v[104:105], v233 offset:28672
  ds_read_b64_tr_b16 v[106:107], v233 offset:29696
  s_waitcnt lgkmcnt(12)
  v_mfma_f32_32x32x16_bf16 v[64:79], v[84:87], v[112:115], v[64:79]
  ds_read_b64_tr_b16 v[108:109], v236 offset:28672
  ds_read_b64_tr_b16 v[110:111], v236 offset:29696
  s_waitcnt lgkmcnt(12)
  v_mfma_f32_32x32x16_bf16 v[48:63], v[88:91], v[116:119], v[48:63]
  s_waitcnt vmcnt(22)
  s_waitcnt lgkmcnt(8)
  s_barrier
  ds_read_b128 v[128:131], v152 offset:8192
  ds_read_b128 v[132:135], v153 offset:8192
  ds_read_b128 v[136:139], v154 offset:8192
  ds_read_b128 v[140:143], v155 offset:8192
  ds_read_b64_tr_b16 v[80:81], v233 offset:32768
  ds_read_b64_tr_b16 v[82:83], v233 offset:33792
  v_mfma_f32_32x32x16_bf16 v[64:79], v[92:95], v[116:119], v[64:79]
  ds_read_b64_tr_b16 v[84:85], v236 offset:32768
  s_waitcnt lgkmcnt(8)
  ds_read_b64_tr_b16 v[86:87], v236 offset:33792
  v_mfma_f32_32x32x16_bf16 v[48:63], v[96:99], v[120:123], v[48:63]
  ds_read_b64_tr_b16 v[88:89], v233 offset:36864
  ds_read_b64_tr_b16 v[90:91], v233 offset:37888
  v_mfma_f32_32x32x16_bf16 v[64:79], v[100:103], v[120:123], v[64:79]
  ds_read_b64_tr_b16 v[92:93], v236 offset:36864
  ds_read_b64_tr_b16 v[94:95], v236 offset:37888
  v_mfma_f32_32x32x16_bf16 v[48:63], v[104:107], v[124:127], v[48:63]
  s_waitcnt vmcnt(20)
  ds_write_b128 v150, v[224:227] offset:0
  ds_write_b128 v151, v[228:231] offset:0
  s_waitcnt lgkmcnt(8)
  ds_read_b64_tr_b16 v[96:97], v233 offset:40960
  ds_read_b64_tr_b16 v[98:99], v233 offset:41984
  v_mfma_f32_32x32x16_bf16 v[64:79], v[108:111], v[124:127], v[64:79]
  ds_read_b64_tr_b16 v[100:101], v236 offset:40960
  ds_read_b64_tr_b16 v[102:103], v236 offset:41984
  v_mfma_f32_32x32x16_bf16 v[48:63], v[80:83], v[128:131], v[48:63]
  ds_read_b64_tr_b16 v[104:105], v233 offset:45056
  ds_read_b64_tr_b16 v[106:107], v233 offset:46080
  s_waitcnt lgkmcnt(12)
  v_mfma_f32_32x32x16_bf16 v[64:79], v[84:87], v[128:131], v[64:79]
  ds_read_b64_tr_b16 v[108:109], v236 offset:45056
  ds_read_b64_tr_b16 v[110:111], v236 offset:46080
  s_waitcnt lgkmcnt(12)
  v_mfma_f32_32x32x16_bf16 v[48:63], v[88:91], v[132:135], v[48:63]
  s_waitcnt vmcnt(16)
  s_waitcnt lgkmcnt(8)
  s_barrier
  ds_read_b128 v[112:115], v152 offset:0
  ds_read_b128 v[116:119], v153 offset:0
  ds_read_b128 v[120:123], v154 offset:0
  ds_read_b128 v[124:127], v155 offset:0
  ds_read_b64_tr_b16 v[80:81], v233 offset:49152
  ds_read_b64_tr_b16 v[82:83], v233 offset:50176
  v_mfma_f32_32x32x16_bf16 v[64:79], v[92:95], v[132:135], v[64:79]
  s_add_u32 m0, s55, 65536
  s_add_u32 s54, s53, 4096
  buffer_load_dwordx4 v14, s[36:39], s53 offen offset:0 sc1 nt lds
  buffer_load_dwordx4 v14, s[36:39], s53 offen offset:1024 sc1 nt lds
  ds_read_b64_tr_b16 v[84:85], v236 offset:49152
  s_waitcnt lgkmcnt(8)
  ds_read_b64_tr_b16 v[86:87], v236 offset:50176
  v_mfma_f32_32x32x16_bf16 v[48:63], v[96:99], v[136:139], v[48:63]
  buffer_load_dwordx4 v14, s[36:39], s53 offen offset:2048 sc1 nt lds
  buffer_load_dwordx4 v14, s[36:39], s53 offen offset:3072 sc1 nt lds
  ds_read_b64_tr_b16 v[88:89], v233 offset:53248
  ds_read_b64_tr_b16 v[90:91], v233 offset:54272
  v_mfma_f32_32x32x16_bf16 v[64:79], v[100:103], v[136:139], v[64:79]
  s_add_u32 m0, s55, 69632
  s_nop 0
  buffer_load_dwordx4 v14, s[36:39], s54 offen offset:0 sc1 nt lds
  buffer_load_dwordx4 v14, s[36:39], s54 offen offset:1024 sc1 nt lds
  ds_read_b64_tr_b16 v[92:93], v236 offset:53248
  ds_read_b64_tr_b16 v[94:95], v236 offset:54272
  v_mfma_f32_32x32x16_bf16 v[48:63], v[104:107], v[140:143], v[48:63]
  buffer_load_dwordx4 v14, s[36:39], s54 offen offset:2048 sc1 nt lds
  buffer_load_dwordx4 v14, s[36:39], s54 offen offset:3072 sc1 nt lds
  s_add_u32 s53, s53, s68
  ds_read_b64_tr_b16 v[96:97], v233 offset:57344
  ds_read_b64_tr_b16 v[98:99], v233 offset:58368
  s_waitcnt lgkmcnt(14)
  v_mfma_f32_32x32x16_bf16 v[64:79], v[108:111], v[140:143], v[64:79]
  ds_read_b64_tr_b16 v[100:101], v236 offset:57344
  s_waitcnt lgkmcnt(8)
  ds_read_b64_tr_b16 v[102:103], v236 offset:58368
  v_mfma_f32_32x32x16_bf16 v[48:63], v[80:83], v[112:115], v[48:63]
  ds_read_b64_tr_b16 v[104:105], v233 offset:61440
  ds_read_b64_tr_b16 v[106:107], v233 offset:62464
  s_waitcnt lgkmcnt(10)
  v_mfma_f32_32x32x16_bf16 v[64:79], v[84:87], v[112:115], v[64:79]
  ds_read_b64_tr_b16 v[108:109], v236 offset:61440
  ds_read_b64_tr_b16 v[110:111], v236 offset:62464
  s_waitcnt lgkmcnt(10)
  v_mfma_f32_32x32x16_bf16 v[48:63], v[88:91], v[116:119], v[48:63]
  s_waitcnt lgkmcnt(8)
  v_mfma_f32_32x32x16_bf16 v[64:79], v[92:95], v[116:119], v[64:79]
  s_waitcnt lgkmcnt(6)
  v_mfma_f32_32x32x16_bf16 v[48:63], v[96:99], v[120:123], v[48:63]
  s_waitcnt lgkmcnt(4)
  v_mfma_f32_32x32x16_bf16 v[64:79], v[100:103], v[120:123], v[64:79]
  s_waitcnt lgkmcnt(2)
  v_mfma_f32_32x32x16_bf16 v[48:63], v[104:107], v[124:127], v[48:63]
  s_waitcnt lgkmcnt(0)
  v_mfma_f32_32x32x16_bf16 v[64:79], v[108:111], v[124:127], v[64:79]
  s_nop 7
  s_nop 3
  v_cvt_pk_bf16_f32 v80, v48, v49
  v_cvt_pk_bf16_f32 v81, v50, v51
  v_cvt_pk_bf16_f32 v82, v52, v53
  v_cvt_pk_bf16_f32 v83, v54, v55
  v_cvt_pk_bf16_f32 v84, v56, v57
  v_cvt_pk_bf16_f32 v85, v58, v59
  v_cvt_pk_bf16_f32 v86, v60, v61
  v_cvt_pk_bf16_f32 v87, v62, v63
  v_cvt_pk_bf16_f32 v88, v64, v65
  v_cvt_pk_bf16_f32 v89, v66, v67
  v_cvt_pk_bf16_f32 v90, v68, v69
  v_cvt_pk_bf16_f32 v91, v70, v71
  v_cvt_pk_bf16_f32 v92, v72, v73
  v_cvt_pk_bf16_f32 v93, v74, v75
  v_cvt_pk_bf16_f32 v94, v76, v77
  v_cvt_pk_bf16_f32 v95, v78, v79
  ds_write_b64 v240, v[80:81]
  ds_write_b64 v241, v[82:83]
  ds_write_b64 v242, v[84:85]
  ds_write_b64 v243, v[86:87]
  ds_write_b64 v244, v[88:89]
  ds_write_b64 v245, v[90:91]
  ds_write_b64 v246, v[92:93]
  ds_write_b64 v247, v[94:95]
  s_waitcnt lgkmcnt(0)
  s_barrier
  ds_read_b128 a[128:131], v248 offset:0
  ds_read_b128 a[132:135], v249 offset:0
  s_add_u32 m0, s55, 98304
  s_add_u32 s54, s53, 4096
  buffer_load_dwordx4 v14, s[36:39], s53 offen offset:0 sc1 nt lds
  ds_read_b128 a[136:139], v250 offset:0
  ds_read_b128 a[140:143], v251 offset:0
  buffer_load_dwordx4 v14, s[36:39], s53 offen offset:1024 sc1 nt lds
  ds_read_b128 a[144:147], v252 offset:0
  ds_read_b128 a[148:151], v253 offset:0
  buffer_load_dwordx4 v14, s[36:39], s53 offen offset:2048 sc1 nt lds
  ds_read_b128 a[152:155], v254 offset:0
  ds_read_b128 a[156:159], v255 offset:0
  buffer_load_dwordx4 v14, s[36:39], s53 offen offset:3072 sc1 nt lds
  ds_read_b128 a[160:163], v248 offset:8192
  ds_read_b128 a[164:167], v249 offset:8192
  s_add_u32 m0, s55, 102400
  s_nop 0
  buffer_load_dwordx4 v14, s[36:39], s54 offen offset:0 sc1 nt lds
  ds_read_b128 a[168:171], v250 offset:8192
  ds_read_b128 a[172:175], v251 offset:8192
  buffer_load_dwordx4 v14, s[36:39], s54 offen offset:1024 sc1 nt lds
  ds_read_b128 a[176:179], v252 offset:8192
  ds_read_b128 a[180:183], v253 offset:8192
  buffer_load_dwordx4 v14, s[36:39], s54 offen offset:2048 sc1 nt lds
  ds_read_b128 a[184:187], v254 offset:8192
  s_waitcnt lgkmcnt(8)
  ds_read_b128 a[188:191], v255 offset:8192
  buffer_load_dwordx4 v14, s[36:39], s54 offen offset:3072 sc1 nt lds
  s_add_u32 s53, s53, s69
  s_waitcnt vmcnt(24)
  ds_read_b128 v[128:131], v16 offset:0
  ds_read_b128 v[132:135], v17 offset:0
  ds_read_b128 v[136:139], v18 offset:0
  ds_read_b128 v[140:143], v19 offset:0
  ds_read_b128 v[144:147], v20 offset:0
  ds_read_b128 v[148:151], v21 offset:0
  s_waitcnt lgkmcnt(7)
  ds_read_b128 v[152:155], v22 offset:0
  ds_read_b128 v[156:159], v23 offset:0
  s_waitcnt lgkmcnt(0)
  v_mfma_f32_32x32x16_bf16 v[48:63], v[128:131], a[128:131], 0
  s_add_u32 m0, s55, 0
  s_add_u32 s54, s52, 4096
  buffer_load_dwordx4 v10, s[32:35], s52 offen offset:0 sc1 nt lds
  v_mfma_f32_32x32x16_bf16 v[64:79], v[128:131], a[160:163], 0
  v_mfma_f32_32x32x16_bf16 v[48:63], v[132:135], a[132:135], v[48:63]
  buffer_load_dwordx4 v11, s[32:35], s52 offen offset:1024 sc1 nt lds
  v_mfma_f32_32x32x16_bf16 v[64:79], v[132:135], a[164:167], v[64:79]
  v_mfma_f32_32x32x16_bf16 v[48:63], v[136:139], a[136:139], v[48:63]
  buffer_load_dwordx4 v12, s[32:35], s52 offen offset:2048 sc1 nt lds
  v_mfma_f32_32x32x16_bf16 v[64:79], v[136:139], a[168:171], v[64:79]
  v_mfma_f32_32x32x16_bf16 v[48:63], v[140:143], a[140:143], v[48:63]
  buffer_load_dwordx4 v13, s[32:35], s52 offen offset:3072 sc1 nt lds
  v_mfma_f32_32x32x16_bf16 v[64:79], v[140:143], a[172:175], v[64:79]
  v_mfma_f32_32x32x16_bf16 v[48:63], v[144:147], a[144:147], v[48:63]
  s_add_u32 m0, s55, 4096
  s_nop 0
  buffer_load_dwordx4 v10, s[32:35], s54 offen offset:0 sc1 nt lds
  v_mfma_f32_32x32x16_bf16 v[64:79], v[144:147], a[176:179], v[64:79]
  v_mfma_f32_32x32x16_bf16 v[48:63], v[148:151], a[148:151], v[48:63]
  buffer_load_dwordx4 v11, s[32:35], s54 offen offset:1024 sc1 nt lds
  v_mfma_f32_32x32x16_bf16 v[64:79], v[148:151], a[180:183], v[64:79]
  v_mfma_f32_32x32x16_bf16 v[48:63], v[152:155], a[152:155], v[48:63]
  buffer_load_dwordx4 v12, s[32:35], s54 offen offset:2048 sc1 nt lds
  v_mfma_f32_32x32x16_bf16 v[64:79], v[152:155], a[184:187], v[64:79]
  v_mfma_f32_32x32x16_bf16 v[48:63], v[156:159], a[156:159], v[48:63]
  buffer_load_dwordx4 v13, s[32:35], s54 offen offset:3072 sc1 nt lds
  s_add_u32 s52, s52, s68
  v_mfma_f32_32x32x16_bf16 v[64:79], v[156:159], a[188:191], v[64:79]
  s_waitcnt vmcnt(24)
  ds_read_b128 v[128:131], v16 offset:32768
  ds_read_b128 v[132:135], v17 offset:32768
  ds_read_b128 v[136:139], v18 offset:32768
  ds_read_b128 v[140:143], v19 offset:32768
  ds_read_b128 v[144:147], v20 offset:32768
  ds_read_b128 v[148:151], v21 offset:32768
  ds_read_b128 v[152:155], v22 offset:32768
  ds_read_b128 v[156:159], v23 offset:32768
  s_nop 3
  v_mul_f32 v48, s65, v48
  v_mul_f32 v49, s65, v49
  v_mul_f32 v50, s65, v50
  v_mul_f32 v51, s65, v51
  v_mul_f32 v52, s65, v52
  v_mul_f32 v53, s65, v53
  v_mul_f32 v54, s65, v54
  v_mul_f32 v55, s65, v55
  v_mul_f32 v56, s65, v56
  v_mul_f32 v57, s65, v57
  v_mul_f32 v58, s65, v58
  v_mul_f32 v59, s65, v59
  v_mul_f32 v60, s65, v60
  v_mul_f32 v61, s65, v61
  v_mul_f32 v62, s65, v62
  v_mul_f32 v63, s65, v63
  v_mul_f32 v64, s65, v64
  v_mul_f32 v65, s65, v65
  v_mul_f32 v66, s65, v66
  v_mul_f32 v67, s65, v67
  v_mul_f32 v68, s65, v68
  v_mul_f32 v69, s65, v69
  v_mul_f32 v70, s65, v70
  v_mul_f32 v71, s65, v71
  v_mul_f32 v72, s65, v72
  v_mul_f32 v73, s65, v73
  v_mul_f32 v74, s65, v74
  v_mul_f32 v75, s65, v75
  v_mul_f32 v76, s65, v76
  v_mul_f32 v77, s65, v77
  v_mul_f32 v78, s65, v78
  v_mul_f32 v79, s65, v79
  v_max3_f32 v36, v48, v49, v50
  v_max3_f32 v36, v36, v51, v52
  v_max3_f32 v36, v36, v53, v54
  v_max3_f32 v36, v36, v55, v56
  v_max3_f32 v36, v36, v57, v58
  v_max3_f32 v36, v36, v59, v60
  v_max3_f32 v36, v36, v61, v62
  v_max_f32 v36, v36, v63
  v_max3_f32 v37, v64, v65, v66
  v_max3_f32 v37, v37, v67, v68
  v_max3_f32 v37, v37, v69, v70
  v_max3_f32 v37, v37, v71, v72
  v_max3_f32 v37, v37, v73, v74
  v_max3_f32 v37, v37, v75, v76
  v_max3_f32 v37, v37, v77, v78
  v_max_f32 v37, v37, v79
  v_mov_b32 v38, v36
  v_mov_b32 v39, v37
  s_nop 1
  v_permlane32_swap_b32 v38, v39
  v_max_f32 v38, v38, v39
  v_mov_b32 v39, v38
  s_nop 1
  v_permlane32_swap_b32 v38, v39
  v_mov_b32 v30, v38
  v_mov_b32 v31, v39
  v_sub_f32 v48, v48, v30
  v_sub_f32 v49, v49, v30
  v_sub_f32 v50, v50, v30
  v_sub_f32 v51, v51, v30
  v_sub_f32 v52, v52, v30
  v_sub_f32 v53, v53, v30
  v_sub_f32 v54, v54, v30
  v_sub_f32 v55, v55, v30
  v_sub_f32 v56, v56, v30
  v_sub_f32 v57, v57, v30
  v_sub_f32 v58, v58, v30
  v_sub_f32 v59, v59, v30
  v_sub_f32 v60, v60, v30
  v_sub_f32 v61, v61, v30
  v_sub_f32 v62, v62, v30
  v_sub_f32 v63, v63, v30
  v_sub_f32 v64, v64, v31
  v_sub_f32 v65, v65, v31
  v_sub_f32 v66, v66, v31
  v_sub_f32 v67, v67, v31
  v_sub_f32 v68, v68, v31
  v_sub_f32 v69, v69, v31
  v_sub_f32 v70, v70, v31
  v_sub_f32 v71, v71, v31
  v_sub_f32 v72, v72, v31
  v_sub_f32 v73, v73, v31
  v_sub_f32 v74, v74, v31
  v_sub_f32 v75, v75, v31
  v_sub_f32 v76, v76, v31
  v_sub_f32 v77, v77, v31
  v_sub_f32 v78, v78, v31
  v_sub_f32 v79, v79, v31
  s_waitcnt lgkmcnt(7)
  v_mfma_f32_32x32x16_bf16 v[80:95], v[128:131], a[128:131], 0
  v_exp_f32 v48, v48
  v_exp_f32 v49, v49
  v_mfma_f32_32x32x16_bf16 v[96:111], v[128:131], a[160:163], 0
  v_exp_f32 v50, v50
  v_exp_f32 v51, v51
  v_cvt_pk_bf16_f32 v112, v48, v49
  s_waitcnt lgkmcnt(6)
  v_mfma_f32_32x32x16_bf16 v[80:95], v[132:135], a[132:135], v[80:95]
  v_exp_f32 v52, v52
  v_exp_f32 v53, v53
  v_mfma_f32_32x32x16_bf16 v[96:111], v[132:135], a[164:167], v[96:111]
  v_cvt_pk_bf16_f32 v113, v50, v51
  v_exp_f32 v54, v54
  v_exp_f32 v55, v55
  s_waitcnt lgkmcnt(5)
  v_mfma_f32_32x32x16_bf16 v[80:95], v[136:139], a[136:139], v[80:95]
  v_cvt_pk_bf16_f32 v114, v52, v53
  v_exp_f32 v56, v56
  v_exp_f32 v57, v57
  v_mfma_f32_32x32x16_bf16 v[96:111], v[136:139], a[168:171], v[96:111]
  v_cvt_pk_bf16_f32 v115, v54, v55
  v_exp_f32 v58, v58
  s_waitcnt lgkmcnt(0)
  v_mfma_f32_32x32x16_bf16 v[80:95], v[140:143], a[140:143], v[80:95]
  v_exp_f32 v59, v59
  v_cvt_pk_bf16_f32 v116, v56, v57
  v_exp_f32 v60, v60
  v_mfma_f32_32x32x16_bf16 v[96:111], v[140:143], a[172:175], v[96:111]
  v_exp_f32 v61, v61
  v_cvt_pk_bf16_f32 v117, v58, v59
  v_exp_f32 v62, v62
  s_add_u32 m0, s55, 32768
  s_add_u32 s54, s52, 4096
  buffer_load_dwordx4 v10, s[32:35], s52 offen offset:0 sc1 nt lds
  v_mfma_f32_32x32x16_bf16 v[80:95], v[144:147], a[144:147], v[80:95]
  v_exp_f32 v63, v63
  v_cvt_pk_bf16_f32 v118, v60, v61
  v_exp_f32 v64, v64
  buffer_load_dwordx4 v11, s[32:35], s52 offen offset:1024 sc1 nt lds
  v_mfma_f32_32x32x16_bf16 v[96:111], v[144:147], a[176:179], v[96:111]
  v_exp_f32 v65, v65
  v_cvt_pk_bf16_f32 v119, v62, v63
  v_exp_f32 v66, v66
  buffer_load_dwordx4 v12, s[32:35], s52 offen offset:2048 sc1 nt lds
  v_exp_f32 v67, v67
  v_mfma_f32_32x32x16_bf16 v[80:95], v[148:151], a[148:151], v[80:95]
  v_cvt_pk_bf16_f32 v120, v64, v65
  v_exp_f32 v68, v68
  buffer_load_dwordx4 v13, s[32:35], s52 offen offset:3072 sc1 nt lds
  v_exp_f32 v69, v69
  v_mfma_f32_32x32x16_bf16 v[96:111], v[148:151], a[180:183], v[96:111]
  v_cvt_pk_bf16_f32 v121, v66, v67
  v_exp_f32 v70, v70
  s_add_u32 m0, s55, 36864
  s_nop 0
  buffer_load_dwordx4 v10, s[32:35], s54 offen offset:0 sc1 nt lds
  v_exp_f32 v71, v71
  v_mfma_f32_32x32x16_bf16 v[80:95], v[152:155], a[152:155], v[80:95]
  v_cvt_pk_bf16_f32 v122, v68, v69
  v_exp_f32 v72, v72
  buffer_load_dwordx4 v11, s[32:35], s54 offen offset:1024 sc1 nt lds
  v_exp_f32 v73, v73
  v_mfma_f32_32x32x16_bf16 v[96:111], v[152:155], a[184:187], v[96:111]
  v_cvt_pk_bf16_f32 v123, v70, v71
  v_exp_f32 v74, v74
  buffer_load_dwordx4 v12, s[32:35], s54 offen offset:2048 sc1 nt lds
  v_exp_f32 v75, v75
  v_mfma_f32_32x32x16_bf16 v[80:95], v[156:159], a[156:159], v[80:95]
  v_cvt_pk_bf16_f32 v124, v72, v73
  v_exp_f32 v76, v76
  buffer_load_dwordx4 v13, s[32:35], s54 offen offset:3072 sc1 nt lds
  s_add_u32 s52, s52, s69
  v_exp_f32 v77, v77
  v_cvt_pk_bf16_f32 v125, v74, v75
  v_mfma_f32_32x32x16_bf16 v[96:111], v[156:159], a[188:191], v[96:111]
  v_exp_f32 v78, v78
  v_exp_f32 v79, v79
  v_cvt_pk_bf16_f32 v126, v76, v77
  s_nop 0
  v_cvt_pk_bf16_f32 v127, v78, v79
  s_waitcnt vmcnt(24)
  ds_read_b64_tr_b16 v[160:161], v24 offset:0
  ds_read_b64_tr_b16 v[162:163], v24 offset:2048
  ds_read_b64_tr_b16 v[164:165], v25 offset:0
  ds_read_b64_tr_b16 v[166:167], v25 offset:2048
  ds_read_b64_tr_b16 v[168:169], v26 offset:0
  ds_read_b64_tr_b16 v[170:171], v26 offset:2048
  ds_read_b64_tr_b16 v[172:173], v27 offset:0
  ds_read_b64_tr_b16 v[174:175], v27 offset:2048
  ds_read_b64_tr_b16 v[176:177], v24 offset:4096
  ds_read_b64_tr_b16 v[178:179], v24 offset:6144
  ds_read_b64_tr_b16 v[180:181], v25 offset:4096
  ds_read_b64_tr_b16 v[182:183], v25 offset:6144
  ds_read_b64_tr_b16 v[184:185], v26 offset:4096
  ds_read_b64_tr_b16 v[186:187], v26 offset:6144
  ds_read_b64_tr_b16 v[188:189], v27 offset:4096
  v_add_f32 v34, v34, v48
  v_add_f32 v35, v35, v64
  v_add_f32 v34, v34, v49
  v_add_f32 v35, v35, v65
  v_add_f32 v34, v34, v50
  v_add_f32 v35, v35, v66
  v_add_f32 v34, v34, v51
  v_add_f32 v35, v35, v67
  s_waitcnt lgkmcnt(13)
  ds_read_b64_tr_b16 v[190:191], v27 offset:6144
  v_mfma_f32_32x32x16_bf16 a[0:15], v[160:163], v[112:115], 0
  v_add_f32 v34, v34, v52
  v_add_f32 v35, v35, v68
  v_mfma_f32_32x32x16_bf16 a[16:31], v[160:163], v[120:123], 0
  v_add_f32 v34, v34, v53
  v_add_f32 v35, v35, v69
  v_add_f32 v34, v34, v54
  s_waitcnt lgkmcnt(12)
  v_mfma_f32_32x32x16_bf16 a[32:47], v[164:167], v[112:115], 0
  v_add_f32 v35, v35, v70
  v_add_f32 v34, v34, v55
  v_mfma_f32_32x32x16_bf16 a[48:63], v[164:167], v[120:123], 0
  v_add_f32 v35, v35, v71
  v_add_f32 v34, v34, v56
  s_waitcnt lgkmcnt(10)
  v_mfma_f32_32x32x16_bf16 a[64:79], v[168:171], v[112:115], 0
  v_add_f32 v35, v35, v72
  v_add_f32 v34, v34, v57
  v_mfma_f32_32x32x16_bf16 a[80:95], v[168:171], v[120:123], 0
  v_add_f32 v35, v35, v73
  v_add_f32 v34, v34, v58
  v_add_f32 v35, v35, v74
  s_waitcnt lgkmcnt(0)
  v_mfma_f32_32x32x16_bf16 a[96:111], v[172:175], v[112:115], 0
  v_add_f32 v34, v34, v59
  v_add_f32 v35, v35, v75
  v_mfma_f32_32x32x16_bf16 a[112:127], v[172:175], v[120:123], 0
  v_add_f32 v34, v34, v60
  v_add_f32 v35, v35, v76
  v_add_f32 v34, v34, v61
  v_add_f32 v35, v35, v77
  v_add_f32 v34, v34, v62
  v_add_f32 v35, v35, v78
  v_add_f32 v34, v34, v63
  s_add_u32 m0, s55, 65536
  s_add_u32 s54, s53, 4096
  buffer_load_dwordx4 v14, s[36:39], s53 offen offset:0 sc1 nt lds
  v_mfma_f32_32x32x16_bf16 a[0:15], v[176:179], v[116:119], a[0:15]
  v_add_f32 v35, v35, v79
  v_fma_f32 v80, v80, s65, -v30
  v_fma_f32 v81, v81, s65, -v30
  v_fma_f32 v82, v82, s65, -v30
  v_fma_f32 v83, v83, s65, -v30
  v_fma_f32 v84, v84, s65, -v30
  v_fma_f32 v85, v85, s65, -v30
  v_mfma_f32_32x32x16_bf16 a[16:31], v[176:179], v[124:127], a[16:31]
  buffer_load_dwordx4 v14, s[36:39], s53 offen offset:1024 sc1 nt lds
  v_fma_f32 v86, v86, s65, -v30
  v_fma_f32 v87, v87, s65, -v30
  v_fma_f32 v88, v88, s65, -v30
  v_fma_f32 v89, v89, s65, -v30
  v_fma_f32 v90, v90, s65, -v30
  v_fma_f32 v91, v91, s65, -v30
  v_mfma_f32_32x32x16_bf16 a[32:47], v[180:183], v[116:119], a[32:47]
  v_fma_f32 v92, v92, s65, -v30
  buffer_load_dwordx4 v14, s[36:39], s53 offen offset:2048 sc1 nt lds
  v_fma_f32 v93, v93, s65, -v30
  v_fma_f32 v94, v94, s65, -v30
  v_fma_f32 v95, v95, s65, -v30
  v_fma_f32 v96, v96, s65, -v31
  v_fma_f32 v97, v97, s65, -v31
  v_mfma_f32_32x32x16_bf16 a[48:63], v[180:183], v[124:127], a[48:63]
  v_fma_f32 v98, v98, s65, -v31
  v_fma_f32 v99, v99, s65, -v31
  buffer_load_dwordx4 v14, s[36:39], s53 offen offset:3072 sc1 nt lds
  v_fma_f32 v100, v100, s65, -v31
  v_fma_f32 v101, v101, s65, -v31
  v_fma_f32 v102, v102, s65, -v31
  v_fma_f32 v103, v103, s65, -v31
  v_mfma_f32_32x32x16_bf16 a[64:79], v[184:187], v[116:119], a[64:79]
  v_fma_f32 v104, v104, s65, -v31
  v_fma_f32 v105, v105, s65, -v31
  v_fma_f32 v106, v106, s65, -v31
  s_add_u32 m0, s55, 69632
  s_nop 0
  buffer_load_dwordx4 v14, s[36:39], s54 offen offset:0 sc1 nt lds
  v_fma_f32 v107, v107, s65, -v31
  v_fma_f32 v108, v108, s65, -v31
  v_fma_f32 v109, v109, s65, -v31
  v_mfma_f32_32x32x16_bf16 a[80:95], v[184:187], v[124:127], a[80:95]
  v_fma_f32 v110, v110, s65, -v31
  v_fma_f32 v111, v111, s65, -v31
  v_max3_f32 v36, v80, v81, v82
  v_max3_f32 v36, v36, v83, v84
  buffer_load_dwordx4 v14, s[36:39], s54 offen offset:1024 sc1 nt lds
  v_max3_f32 v36, v36, v85, v86
  v_max3_f32 v36, v36, v87, v88
  v_mfma_f32_32x32x16_bf16 a[96:111], v[188:191], v[116:119], a[96:111]
  v_max3_f32 v36, v36, v89, v90
  v_max3_f32 v36, v36, v91, v92
  v_max3_f32 v36, v36, v93, v94
  v_max_f32 v36, v36, v95
  v_max3_f32 v37, v96, v97, v98
  buffer_load_dwordx4 v14, s[36:39], s54 offen offset:2048 sc1 nt lds
  v_max3_f32 v37, v37, v99, v100
  v_mfma_f32_32x32x16_bf16 a[112:127], v[188:191], v[124:127], a[112:127]
  v_max3_f32 v37, v37, v101, v102
  v_max3_f32 v37, v37, v103, v104
  v_max3_f32 v37, v37, v105, v106
  v_max3_f32 v37, v37, v107, v108
  v_max3_f32 v37, v37, v109, v110
  v_max_f32 v37, v37, v111
  buffer_load_dwordx4 v14, s[36:39], s54 offen offset:3072 sc1 nt lds
  s_add_u32 s53, s53, s68
  v_cmp_lt_f32 vcc, s66, v36
  v_cmp_lt_f32 s[60:61], s66, v37
  s_waitcnt vmcnt(16)
  ds_read_b128 v[128:131], v16 offset:0
  ds_read_b128 v[132:135], v17 offset:0
  ds_read_b128 v[136:139], v18 offset:0
  ds_read_b128 v[140:143], v19 offset:0
  ds_read_b128 v[144:147], v20 offset:0
  ds_read_b128 v[148:151], v21 offset:0
  ds_read_b128 v[152:155], v22 offset:0
  ds_read_b128 v[156:159], v23 offset:0
  s_or_b64 s[60:61], s[60:61], vcc
  s_cbranch_scc1 L1_rareS0
L1_backS0:
  s_mov_b32 s64, 6
  s_mov_b32 s44, s12
  s_mov_b32 s45, s13
  s_mov_b32 s40, s16
  s_mov_b32 s41, s17
  s_mov_b32 s42, 256
  s_lshl_b32 s26, s23, 1
  s_add_u32 s26, s26, s24
  s_sub_u32 s26, s26, 2
  s_add_u32 s27, s24, 16
  s_cmp_eq_u32 s23, s21
  s_cselect_b32 s82, 1, 0
  s_cmp_ge_u32 s24, 2
  s_cselect_b32 s82, 1, s82
  s_cselect_b32 s26, s26, s27
  s_lshr_b32 s27, s21, 2
  s_and_b32 s28, s21, 3
  s_lshl_b32 s28, s28, 1
  s_lshr_b32 s83, s26, 3
  s_and_b32 s84, s26, 7
  s_mul_i32 s85, s84, 2
  s_mul_i32 s86, s83, 1
  s_add_u32 s85, s85, s86
  s_and_b32 s85, s85, 15
  s_mov_b32 s86, s85
  s_add_u32 s29, s84, s28
  s_add_u32 s83, s83, s28
  s_cmp_ge_u32 s26, 16
  s_cselect_b32 s83, 8, s83
  s_cselect_b32 s84, s29, s84
  s_lshl_b32 s29, s27, 3
  s_add_u32 s84, s84, s29
  s_mul_i32 s87, s20, 1179648
  s_lshl_b32 s29, s83, 7
  s_add_u32 s87, s87, s29
  s_cmp_eq_u32 s82, 0
  s_cselect_b32 s87, 0x7f000000, s87
  s_add_u32 s94, s87, 294912
  s_lshl_b32 s95, s84, 17
  s_lshl_b32 s29, s20, 14
  s_add_u32 s95, s95, s29
  s_add_u32 s88, s95, 0x200000
  s_lshl_b32 s89, s20, 12
  v_lshrrev_b32 v2, 3, v1
  v_mul_u32_u24 v2, 1152, v2
  v_bfe_u32 v3, v1, 1, 2
  v_lshrrev_b32 v4, 4, v1
  v_xor_b32 v3, v3, v4
  v_lshl_add_u32 v2, v3, 5, v2
  v_and_b32 v3, 1, v1
  v_lshl_add_u32 v192, v3, 4, v2
  v_add_u32 v193, 8192, v192
  v_add_u32 v194, 16384, v192
  v_add_u32 v195, 24576, v192
  v_bfe_u32 v3, v1, 2, 2
  v_lshl_add_u32 v5, v4, 2, v3
  v_bfe_u32 v6, v5, 1, 2
  v_lshlrev_b32 v5, 7, v5
  v_and_b32 v3, 3, v1
  v_lshl_add_u32 v5, v3, 3, v5
  s_add_u32 s29, s89, 131072
  v_xor_b32 v3, 0, v6
  v_lshl_add_u32 v3, v3, 5, v5
  v_add_u32 v196, s55, v3
  v_add_u32 v228, s29, v3
  v_add_u32 v248, 0x10000, v196
  v_xor_b32 v3, 1, v6
  v_lshl_add_u32 v3, v3, 5, v5
  v_add_u32 v197, s55, v3
  v_add_u32 v229, s29, v3
  v_add_u32 v249, 0x10000, v197
  v_xor_b32 v3, 2, v6
  v_lshl_add_u32 v3, v3, 5, v5
  v_add_u32 v198, s55, v3
  v_add_u32 v230, s29, v3
  v_add_u32 v250, 0x10000, v198
  v_xor_b32 v3, 3, v6
  v_lshl_add_u32 v3, v3, 5, v5
  v_add_u32 v199, s55, v3
  v_add_u32 v231, s29, v3
  v_add_u32 v251, 0x10000, v199
  s_lshl_b32 s29, s23, 1
  s_add_u32 s29, s29, s24
  s_sub_u32 s30, s29, 2
  s_cmp_gt_u32 s23, s21
  s_cselect_b32 s29, s30, s29
  s_lshl_b32 s29, s29, 2
  s_add_u32 s29, s29, s20
  s_mul_i32 s56, s29, 85248
  s_mul_i32 s58, s29, 2
  s_cmp_eq_u32 s82, 0
  s_cselect_b32 s59, 2, 0
  s_mov_b32 s98, 0x4000000
  s_mov_b32 s99, 0x20000
  v_lshlrev_b32 v33, 7, v1
  s_cmp_eq_u32 s82, 0
  s_cselect_b32 s57, 4, 0
  s_lshl_b32 s30, s28, 7
  v_mul_u32_u24 v2, 86, v1
  v_lshrrev_b32 v2, 8, v2
  v_mul_u32_u24 v3, 3, v2
  v_sub_u32 v3, v1, v3
  v_lshlrev_b32 v4, 7, v3
  v_add_u32 v4, s30, v4
  v_mov_b32 v5, 1024
  v_cmp_eq_u32 vcc, 2, v3
  v_mul_u32_u24 v2, 1152, v2
  s_nop 0
  v_cndmask_b32 v4, v4, v5, vcc
  v_add_u32 v28, v2, v4
L1_loop:
  s_cmp_gt_u32 s64, 5
  s_cbranch_scc1 L1_nopf
  s_cmp_eq_u32 s57, 0
  s_cbranch_scc1 L1_nopf
  buffer_load_dword v29, v28, s[44:47], s56 offen
  s_add_u32 s56, s56, 24192
  s_sub_u32 s57, s57, 1
L1_nopf:
  s_cmp_gt_u32 s64, 6
  s_cbranch_scc1 L1_nokv
  s_cmp_eq_u32 s59, 0
  s_cbranch_scc1 L1_nokv
  s_mul_i32 s26, s58, 5462
  s_lshr_b32 s26, s26, 16
  s_mul_i32 s27, s26, 12
  s_sub_u32 s27, s58, s27
  s_lshr_b32 s28, s27, 2
  s_and_b32 s27, s27, 3
  s_add_u32 s29, s28, 1
  s_lshr_b32 s29, s29, 1
  s_sub_u32 s29, 12, s29
  s_lshr_b32 s30, s28, 1
  s_sub_u32 s30, 14, s30
  s_and_b32 s31, s28, 1
  s_cmp_eq_u32 s28, 0
  s_cselect_b32 s31, 1, s31
  s_cmp_eq_u32 s31, 1
  s_cselect_b32 s29, s29, s30
  s_cselect_b32 s96, s8, s6
  s_cselect_b32 s97, s9, s7
  s_lshl_b32 s29, s29, 15
  s_lshl_b32 s27, s27, 13
  s_add_u32 s29, s29, s27
  s_lshl_b32 s30, s21, 1
  s_add_u32 s31, s30, 1
  s_cmp_lt_u32 s26, 8
  s_cselect_b32 s30, s31, s30
  s_cselect_b32 s31, s26, s21
  s_lshl_b32 s31, s31, 4
  s_add_u32 s31, s31, s30
  s_lshl_b32 s31, s31, 19
  s_add_u32 s29, s29, s31
  s_cmp_gt_u32 s26, 8
  s_cselect_b32 s29, 0x7f000000, s29
  buffer_load_dword v29, v33, s[96:99], s29 offen
  s_add_u32 s58, s58, 1
  s_sub_u32 s59, s59, 1
L1_nokv:
  s_barrier
  s_waitcnt lgkmcnt(7)
  v_mfma_f32_32x32x16_bf16 v[48:63], v[128:131], a[128:131], 0
  v_exp_f32 v80, v80
  v_exp_f32 v81, v81
  v_mfma_f32_32x32x16_bf16 v[64:79], v[128:131], a[160:163], 0
  v_exp_f32 v82, v82
  v_exp_f32 v83, v83
  v_cvt_pk_bf16_f32 v112, v80, v81
  s_waitcnt lgkmcnt(6)
  v_mfma_f32_32x32x16_bf16 v[48:63], v[132:135], a[132:135], v[48:63]
  v_exp_f32 v84, v84
  v_exp_f32 v85, v85
  v_mfma_f32_32x32x16_bf16 v[64:79], v[132:135], a[164:167], v[64:79]
  v_cvt_pk_bf16_f32 v113, v82, v83
  v_exp_f32 v86, v86
  v_exp_f32 v87, v87
  s_waitcnt lgkmcnt(5)
  v_mfma_f32_32x32x16_bf16 v[48:63], v[136:139], a[136:139], v[48:63]
  v_cvt_pk_bf16_f32 v114, v84, v85
  v_exp_f32 v88, v88
  v_exp_f32 v89, v89
  v_mfma_f32_32x32x16_bf16 v[64:79], v[136:139], a[168:171], v[64:79]
  v_cvt_pk_bf16_f32 v115, v86, v87
  v_exp_f32 v90, v90
  s_waitcnt lgkmcnt(0)
  v_mfma_f32_32x32x16_bf16 v[48:63], v[140:143], a[140:143], v[48:63]
  v_exp_f32 v91, v91
  v_cvt_pk_bf16_f32 v116, v88, v89
  v_exp_f32 v92, v92
  v_mfma_f32_32x32x16_bf16 v[64:79], v[140:143], a[172:175], v[64:79]
  v_exp_f32 v93, v93
  v_cvt_pk_bf16_f32 v117, v90, v91
  v_exp_f32 v94, v94
  s_add_u32 m0, s55, 0
  s_add_u32 s54, s52, 4096
  buffer_load_dwordx4 v10, s[32:35], s52 offen offset:0 sc1 nt lds
  v_mfma_f32_32x32x16_bf16 v[48:63], v[144:147], a[144:147], v[48:63]
  v_exp_f32 v95, v95
  v_cvt_pk_bf16_f32 v118, v92, v93
  v_exp_f32 v96, v96
  buffer_load_dwordx4 v11, s[32:35], s52 offen offset:1024 sc1 nt lds
  v_mfma_f32_32x32x16_bf16 v[64:79], v[144:147], a[176:179], v[64:79]
  v_exp_f32 v97, v97
  v_cvt_pk_bf16_f32 v119, v94, v95
  v_exp_f32 v98, v98
  buffer_load_dwordx4 v12, s[32:35], s52 offen offset:2048 sc1 nt lds
  v_exp_f32 v99, v99
  v_mfma_f32_32x32x16_bf16 v[48:63], v[148:151], a[148:151], v[48:63]
  v_cvt_pk_bf16_f32 v120, v96, v97
  v_exp_f32 v100, v100
  buffer_load_dwordx4 v13, s[32:35], s52 offen offset:3072 sc1 nt lds
  v_exp_f32 v101, v101
  v_mfma_f32_32x32x16_bf16 v[64:79], v[148:151], a[180:183], v[64:79]
  v_cvt_pk_bf16_f32 v121, v98, v99
  v_exp_f32 v102, v102
  s_add_u32 m0, s55, 4096
  s_nop 0
  buffer_load_dwordx4 v10, s[32:35], s54 offen offset:0 sc1 nt lds
  v_exp_f32 v103, v103
  v_mfma_f32_32x32x16_bf16 v[48:63], v[152:155], a[152:155], v[48:63]
  v_cvt_pk_bf16_f32 v122, v100, v101
  v_exp_f32 v104, v104
  buffer_load_dwordx4 v11, s[32:35], s54 offen offset:1024 sc1 nt lds
  v_exp_f32 v105, v105
  v_mfma_f32_32x32x16_bf16 v[64:79], v[152:155], a[184:187], v[64:79]
  v_cvt_pk_bf16_f32 v123, v102, v103
  v_exp_f32 v106, v106
  buffer_load_dwordx4 v12, s[32:35], s54 offen offset:2048 sc1 nt lds
  v_exp_f32 v107, v107
  v_mfma_f32_32x32x16_bf16 v[48:63], v[156:159], a[156:159], v[48:63]
  v_cvt_pk_bf16_f32 v124, v104, v105
  v_exp_f32 v108, v108
  buffer_load_dwordx4 v13, s[32:35], s54 offen offset:3072 sc1 nt lds
  s_add_u32 s52, s52, s68
  v_exp_f32 v109, v109
  v_cvt_pk_bf16_f32 v125, v106, v107
  v_mfma_f32_32x32x16_bf16 v[64:79], v[156:159], a[188:191], v[64:79]
  v_exp_f32 v110, v110
  v_exp_f32 v111, v111
  v_cvt_pk_bf16_f32 v126, v108, v109
  s_nop 0
  v_cvt_pk_bf16_f32 v127, v110, v111
  s_waitcnt vmcnt(24)
  ds_read_b64_tr_b16 v[160:161], v24 offset:32768
  ds_read_b64_tr_b16 v[162:163], v24 offset:34816
  ds_read_b64_tr_b16 v[164:165], v25 offset:32768
  ds_read_b64_tr_b16 v[166:167], v25 offset:34816
  ds_read_b64_tr_b16 v[168:169], v26 offset:32768
  ds_read_b64_tr_b16 v[170:171], v26 offset:34816
  ds_read_b64_tr_b16 v[172:173], v27 offset:32768
  ds_read_b64_tr_b16 v[174:175], v27 offset:34816
  ds_read_b64_tr_b16 v[176:177], v24 offset:36864
  ds_read_b64_tr_b16 v[178:179], v24 offset:38912
  ds_read_b64_tr_b16 v[180:181], v25 offset:36864
  ds_read_b64_tr_b16 v[182:183], v25 offset:38912
  ds_read_b64_tr_b16 v[184:185], v26 offset:36864
  ds_read_b64_tr_b16 v[186:187], v26 offset:38912
  ds_read_b64_tr_b16 v[188:189], v27 offset:36864
  v_add_f32 v34, v34, v80
  v_add_f32 v35, v35, v96
  v_add_f32 v34, v34, v81
  v_add_f32 v35, v35, v97
  v_add_f32 v34, v34, v82
  v_add_f32 v35, v35, v98
  v_add_f32 v34, v34, v83
  v_add_f32 v35, v35, v99
  s_waitcnt lgkmcnt(13)
  ds_read_b64_tr_b16 v[190:191], v27 offset:38912
  v_mfma_f32_32x32x16_bf16 a[0:15], v[160:163], v[112:115], a[0:15]
  v_add_f32 v34, v34, v84
  v_add_f32 v35, v35, v100
  v_mfma_f32_32x32x16_bf16 a[16:31], v[160:163], v[120:123], a[16:31]
  v_add_f32 v34, v34, v85
  v_add_f32 v35, v35, v101
  v_add_f32 v34, v34, v86
  s_waitcnt lgkmcnt(12)
  v_mfma_f32_32x32x16_bf16 a[32:47], v[164:167], v[112:115], a[32:47]
  v_add_f32 v35, v35, v102
  v_add_f32 v34, v34, v87
  v_mfma_f32_32x32x16_bf16 a[48:63], v[164:167], v[120:123], a[48:63]
  v_add_f32 v35, v35, v103
  v_add_f32 v34, v34, v88
  s_waitcnt lgkmcnt(10)
  v_mfma_f32_32x32x16_bf16 a[64:79], v[168:171], v[112:115], a[64:79]
  v_add_f32 v35, v35, v104
  v_add_f32 v34, v34, v89
  v_mfma_f32_32x32x16_bf16 a[80:95], v[168:171], v[120:123], a[80:95]
  v_add_f32 v35, v35, v105
  v_add_f32 v34, v34, v90
  v_add_f32 v35, v35, v106
  s_waitcnt lgkmcnt(0)
  v_mfma_f32_32x32x16_bf16 a[96:111], v[172:175], v[112:115], a[96:111]
  v_add_f32 v34, v34, v91
  v_add_f32 v35, v35, v107
  v_mfma_f32_32x32x16_bf16 a[112:127], v[172:175], v[120:123], a[112:127]
  v_add_f32 v34, v34, v92
  v_add_f32 v35, v35, v108
  v_add_f32 v34, v34, v93
  v_add_f32 v35, v35, v109
  v_add_f32 v34, v34, v94
  v_add_f32 v35, v35, v110
  v_add_f32 v34, v34, v95
  s_add_u32 m0, s55, 98304
  s_add_u32 s54, s53, 4096
  buffer_load_dwordx4 v14, s[36:39], s53 offen offset:0 sc1 nt lds
  v_mfma_f32_32x32x16_bf16 a[0:15], v[176:179], v[116:119], a[0:15]
  v_add_f32 v35, v35, v111
  v_fma_f32 v48, v48, s65, -v30
  v_fma_f32 v49, v49, s65, -v30
  v_fma_f32 v50, v50, s65, -v30
  v_fma_f32 v51, v51, s65, -v30
  v_fma_f32 v52, v52, s65, -v30
  v_fma_f32 v53, v53, s65, -v30
  v_mfma_f32_32x32x16_bf16 a[16:31], v[176:179], v[124:127], a[16:31]
  buffer_load_dwordx4 v14, s[36:39], s53 offen offset:1024 sc1 nt lds
  v_fma_f32 v54, v54, s65, -v30
  v_fma_f32 v55, v55, s65, -v30
  v_fma_f32 v56, v56, s65, -v30
  v_fma_f32 v57, v57, s65, -v30
  v_fma_f32 v58, v58, s65, -v30
  v_fma_f32 v59, v59, s65, -v30
  v_mfma_f32_32x32x16_bf16 a[32:47], v[180:183], v[116:119], a[32:47]
  v_fma_f32 v60, v60, s65, -v30
  buffer_load_dwordx4 v14, s[36:39], s53 offen offset:2048 sc1 nt lds
  v_fma_f32 v61, v61, s65, -v30
  v_fma_f32 v62, v62, s65, -v30
  v_fma_f32 v63, v63, s65, -v30
  v_fma_f32 v64, v64, s65, -v31
  v_fma_f32 v65, v65, s65, -v31
  v_mfma_f32_32x32x16_bf16 a[48:63], v[180:183], v[124:127], a[48:63]
  v_fma_f32 v66, v66, s65, -v31
  v_fma_f32 v67, v67, s65, -v31
  buffer_load_dwordx4 v14, s[36:39], s53 offen offset:3072 sc1 nt lds
  v_fma_f32 v68, v68, s65, -v31
  v_fma_f32 v69, v69, s65, -v31
  v_fma_f32 v70, v70, s65, -v31
  v_fma_f32 v71, v71, s65, -v31
  v_mfma_f32_32x32x16_bf16 a[64:79], v[184:187], v[116:119], a[64:79]
  v_fma_f32 v72, v72, s65, -v31
  v_fma_f32 v73, v73, s65, -v31
  v_fma_f32 v74, v74, s65, -v31
  s_add_u32 m0, s55, 102400
  s_nop 0
  buffer_load_dwordx4 v14, s[36:39], s54 offen offset:0 sc1 nt lds
  v_fma_f32 v75, v75, s65, -v31
  v_fma_f32 v76, v76, s65, -v31
  v_fma_f32 v77, v77, s65, -v31
  v_mfma_f32_32x32x16_bf16 a[80:95], v[184:187], v[124:127], a[80:95]
  v_fma_f32 v78, v78, s65, -v31
  v_fma_f32 v79, v79, s65, -v31
  v_max3_f32 v36, v48, v49, v50
  v_max3_f32 v36, v36, v51, v52
  buffer_load_dwordx4 v14, s[36:39], s54 offen offset:1024 sc1 nt lds
  v_max3_f32 v36, v36, v53, v54
  v_max3_f32 v36, v36, v55, v56
  v_mfma_f32_32x32x16_bf16 a[96:111], v[188:191], v[116:119], a[96:111]
  v_max3_f32 v36, v36, v57, v58
  v_max3_f32 v36, v36, v59, v60
  v_max3_f32 v36, v36, v61, v62
  v_max_f32 v36, v36, v63
  v_max3_f32 v37, v64, v65, v66
  buffer_load_dwordx4 v14, s[36:39], s54 offen offset:2048 sc1 nt lds
  v_max3_f32 v37, v37, v67, v68
  v_mfma_f32_32x32x16_bf16 a[112:127], v[188:191], v[124:127], a[112:127]
  v_max3_f32 v37, v37, v69, v70
  v_max3_f32 v37, v37, v71, v72
  v_max3_f32 v37, v37, v73, v74
  v_max3_f32 v37, v37, v75, v76
  v_max3_f32 v37, v37, v77, v78
  v_max_f32 v37, v37, v79
  buffer_load_dwordx4 v14, s[36:39], s54 offen offset:3072 sc1 nt lds
  s_add_u32 s53, s53, s69
  v_cmp_lt_f32 vcc, s66, v36
  v_cmp_lt_f32 s[60:61], s66, v37
  s_waitcnt vmcnt(24)
  ds_read_b128 v[128:131], v16 offset:32768
  ds_read_b128 v[132:135], v17 offset:32768
  ds_read_b128 v[136:139], v18 offset:32768
  ds_read_b128 v[140:143], v19 offset:32768
  ds_read_b128 v[144:147], v20 offset:32768
  ds_read_b128 v[148:151], v21 offset:32768
  ds_read_b128 v[152:155], v22 offset:32768
  ds_read_b128 v[156:159], v23 offset:32768
  s_or_b64 s[60:61], s[60:61], vcc
  s_cbranch_scc1 L1_rare1
L1_back1:
  s_waitcnt lgkmcnt(7)
  v_mfma_f32_32x32x16_bf16 v[80:95], v[128:131], a[128:131], 0
  v_exp_f32 v48, v48
  v_exp_f32 v49, v49
  v_mfma_f32_32x32x16_bf16 v[96:111], v[128:131], a[160:163], 0
  v_exp_f32 v50, v50
  v_exp_f32 v51, v51
  v_cvt_pk_bf16_f32 v112, v48, v49
  s_waitcnt lgkmcnt(6)
  v_mfma_f32_32x32x16_bf16 v[80:95], v[132:135], a[132:135], v[80:95]
  v_exp_f32 v52, v52
  v_exp_f32 v53, v53
  v_mfma_f32_32x32x16_bf16 v[96:111], v[132:135], a[164:167], v[96:111]
  v_cvt_pk_bf16_f32 v113, v50, v51
  v_exp_f32 v54, v54
  v_exp_f32 v55, v55
  s_waitcnt lgkmcnt(5)
  v_mfma_f32_32x32x16_bf16 v[80:95], v[136:139], a[136:139], v[80:95]
  v_cvt_pk_bf16_f32 v114, v52, v53
  v_exp_f32 v56, v56
  v_exp_f32 v57, v57
  v_mfma_f32_32x32x16_bf16 v[96:111], v[136:139], a[168:171], v[96:111]
  v_cvt_pk_bf16_f32 v115, v54, v55
  v_exp_f32 v58, v58
  s_waitcnt lgkmcnt(0)
  v_mfma_f32_32x32x16_bf16 v[80:95], v[140:143], a[140:143], v[80:95]
  v_exp_f32 v59, v59
  v_cvt_pk_bf16_f32 v116, v56, v57
  v_exp_f32 v60, v60
  v_mfma_f32_32x32x16_bf16 v[96:111], v[140:143], a[172:175], v[96:111]
  v_exp_f32 v61, v61
  v_cvt_pk_bf16_f32 v117, v58, v59
  v_exp_f32 v62, v62
  s_add_u32 m0, s55, 32768
  s_add_u32 s54, s52, 4096
  buffer_load_dwordx4 v10, s[32:35], s52 offen offset:0 sc1 nt lds
  v_mfma_f32_32x32x16_bf16 v[80:95], v[144:147], a[144:147], v[80:95]
  v_exp_f32 v63, v63
  v_cvt_pk_bf16_f32 v118, v60, v61
  v_exp_f32 v64, v64
  buffer_load_dwordx4 v11, s[32:35], s52 offen offset:1024 sc1 nt lds
  v_mfma_f32_32x32x16_bf16 v[96:111], v[144:147], a[176:179], v[96:111]
  v_exp_f32 v65, v65
  v_cvt_pk_bf16_f32 v119, v62, v63
  v_exp_f32 v66, v66
  buffer_load_dwordx4 v12, s[32:35], s52 offen offset:2048 sc1 nt lds
  v_exp_f32 v67, v67
  v_mfma_f32_32x32x16_bf16 v[80:95], v[148:151], a[148:151], v[80:95]
  v_cvt_pk_bf16_f32 v120, v64, v65
  v_exp_f32 v68, v68
  buffer_load_dwordx4 v13, s[32:35], s52 offen offset:3072 sc1 nt lds
  v_exp_f32 v69, v69
  v_mfma_f32_32x32x16_bf16 v[96:111], v[148:151], a[180:183], v[96:111]
  v_cvt_pk_bf16_f32 v121, v66, v67
  v_exp_f32 v70, v70
  s_add_u32 m0, s55, 36864
  s_nop 0
  buffer_load_dwordx4 v10, s[32:35], s54 offen offset:0 sc1 nt lds
  v_exp_f32 v71, v71
  v_mfma_f32_32x32x16_bf16 v[80:95], v[152:155], a[152:155], v[80:95]
  v_cvt_pk_bf16_f32 v122, v68, v69
  v_exp_f32 v72, v72
  buffer_load_dwordx4 v11, s[32:35], s54 offen offset:1024 sc1 nt lds
  v_exp_f32 v73, v73
  v_mfma_f32_32x32x16_bf16 v[96:111], v[152:155], a[184:187], v[96:111]
  v_cvt_pk_bf16_f32 v123, v70, v71
  v_exp_f32 v74, v74
  buffer_load_dwordx4 v12, s[32:35], s54 offen offset:2048 sc1 nt lds
  v_exp_f32 v75, v75
  v_mfma_f32_32x32x16_bf16 v[80:95], v[156:159], a[156:159], v[80:95]
  v_cvt_pk_bf16_f32 v124, v72, v73
  v_exp_f32 v76, v76
  buffer_load_dwordx4 v13, s[32:35], s54 offen offset:3072 sc1 nt lds
  s_add_u32 s52, s52, s69
  v_exp_f32 v77, v77
  v_cvt_pk_bf16_f32 v125, v74, v75
  v_mfma_f32_32x32x16_bf16 v[96:111], v[156:159], a[188:191], v[96:111]
  v_exp_f32 v78, v78
  v_exp_f32 v79, v79
  v_cvt_pk_bf16_f32 v126, v76, v77
  s_nop 0
  v_cvt_pk_bf16_f32 v127, v78, v79
  s_waitcnt vmcnt(24)
  ds_read_b64_tr_b16 v[160:161], v24 offset:0
  ds_read_b64_tr_b16 v[162:163], v24 offset:2048
  ds_read_b64_tr_b16 v[164:165], v25 offset:0
  ds_read_b64_tr_b16 v[166:167], v25 offset:2048
  ds_read_b64_tr_b16 v[168:169], v26 offset:0
  ds_read_b64_tr_b16 v[170:171], v26 offset:2048
  ds_read_b64_tr_b16 v[172:173], v27 offset:0
  ds_read_b64_tr_b16 v[174:175], v27 offset:2048
  ds_read_b64_tr_b16 v[176:177], v24 offset:4096
  ds_read_b64_tr_b16 v[178:179], v24 offset:6144
  ds_read_b64_tr_b16 v[180:181], v25 offset:4096
  ds_read_b64_tr_b16 v[182:183], v25 offset:6144
  ds_read_b64_tr_b16 v[184:185], v26 offset:4096
  ds_read_b64_tr_b16 v[186:187], v26 offset:6144
  ds_read_b64_tr_b16 v[188:189], v27 offset:4096
  v_add_f32 v34, v34, v48
  v_add_f32 v35, v35, v64
  v_add_f32 v34, v34, v49
  v_add_f32 v35, v35, v65
  v_add_f32 v34, v34, v50
  v_add_f32 v35, v35, v66
  v_add_f32 v34, v34, v51
  v_add_f32 v35, v35, v67
  s_waitcnt lgkmcnt(13)
  ds_read_b64_tr_b16 v[190:191], v27 offset:6144
  v_mfma_f32_32x32x16_bf16 a[0:15], v[160:163], v[112:115], a[0:15]
  v_add_f32 v34, v34, v52
  v_add_f32 v35, v35, v68
  v_mfma_f32_32x32x16_bf16 a[16:31], v[160:163], v[120:123], a[16:31]
  v_add_f32 v34, v34, v53
  v_add_f32 v35, v35, v69
  v_add_f32 v34, v34, v54
  s_waitcnt lgkmcnt(12)
  v_mfma_f32_32x32x16_bf16 a[32:47], v[164:167], v[112:115], a[32:47]
  v_add_f32 v35, v35, v70
  v_add_f32 v34, v34, v55
  v_mfma_f32_32x32x16_bf16 a[48:63], v[164:167], v[120:123], a[48:63]
  v_add_f32 v35, v35, v71
  v_add_f32 v34, v34, v56
  s_waitcnt lgkmcnt(10)
  v_mfma_f32_32x32x16_bf16 a[64:79], v[168:171], v[112:115], a[64:79]
  v_add_f32 v35, v35, v72
  v_add_f32 v34, v34, v57
  v_mfma_f32_32x32x16_bf16 a[80:95], v[168:171], v[120:123], a[80:95]
  v_add_f32 v35, v35, v73
  v_add_f32 v34, v34, v58
  v_add_f32 v35, v35, v74
  s_waitcnt lgkmcnt(0)
  v_mfma_f32_32x32x16_bf16 a[96:111], v[172:175], v[112:115], a[96:111]
  v_add_f32 v34, v34, v59
  v_add_f32 v35, v35, v75
  v_mfma_f32_32x32x16_bf16 a[112:127], v[172:175], v[120:123], a[112:127]
  v_add_f32 v34, v34, v60
  v_add_f32 v35, v35, v76
  v_add_f32 v34, v34, v61
  v_add_f32 v35, v35, v77
  v_add_f32 v34, v34, v62
  v_add_f32 v35, v35, v78
  v_add_f32 v34, v34, v63
  s_add_u32 m0, s55, 65536
  s_add_u32 s54, s53, 4096
  buffer_load_dwordx4 v14, s[36:39], s53 offen offset:0 sc1 nt lds
  v_mfma_f32_32x32x16_bf16 a[0:15], v[176:179], v[116:119], a[0:15]
  v_add_f32 v35, v35, v79
  v_fma_f32 v80, v80, s65, -v30
  v_fma_f32 v81, v81, s65, -v30
  v_fma_f32 v82, v82, s65, -v30
  v_fma_f32 v83, v83, s65, -v30
  v_fma_f32 v84, v84, s65, -v30
  v_fma_f32 v85, v85, s65, -v30
  v_mfma_f32_32x32x16_bf16 a[16:31], v[176:179], v[124:127], a[16:31]
  buffer_load_dwordx4 v14, s[36:39], s53 offen offset:1024 sc1 nt lds
  v_fma_f32 v86, v86, s65, -v30
  v_fma_f32 v87, v87, s65, -v30
  v_fma_f32 v88, v88, s65, -v30
  v_fma_f32 v89, v89, s65, -v30
  v_fma_f32 v90, v90, s65, -v30
  v_fma_f32 v91, v91, s65, -v30
  v_mfma_f32_32x32x16_bf16 a[32:47], v[180:183], v[116:119], a[32:47]
  v_fma_f32 v92, v92, s65, -v30
  buffer_load_dwordx4 v14, s[36:39], s53 offen offset:2048 sc1 nt lds
  v_fma_f32 v93, v93, s65, -v30
  v_fma_f32 v94, v94, s65, -v30
  v_fma_f32 v95, v95, s65, -v30
  v_fma_f32 v96, v96, s65, -v31
  v_fma_f32 v97, v97, s65, -v31
  v_mfma_f32_32x32x16_bf16 a[48:63], v[180:183], v[124:127], a[48:63]
  v_fma_f32 v98, v98, s65, -v31
  v_fma_f32 v99, v99, s65, -v31
  buffer_load_dwordx4 v14, s[36:39], s53 offen offset:3072 sc1 nt lds
  v_fma_f32 v100, v100, s65, -v31
  v_fma_f32 v101, v101, s65, -v31
  v_fma_f32 v102, v102, s65, -v31
  v_fma_f32 v103, v103, s65, -v31
  v_mfma_f32_32x32x16_bf16 a[64:79], v[184:187], v[116:119], a[64:79]
  v_fma_f32 v104, v104, s65, -v31
  v_fma_f32 v105, v105, s65, -v31
  v_fma_f32 v106, v106, s65, -v31
  s_add_u32 m0, s55, 69632
  s_nop 0
  buffer_load_dwordx4 v14, s[36:39], s54 offen offset:0 sc1 nt lds
  v_fma_f32 v107, v107, s65, -v31
  v_fma_f32 v108, v108, s65, -v31
  v_fma_f32 v109, v109, s65, -v31
  v_mfma_f32_32x32x16_bf16 a[80:95], v[184:187], v[124:127], a[80:95]
  v_fma_f32 v110, v110, s65, -v31
  v_fma_f32 v111, v111, s65, -v31
  v_max3_f32 v36, v80, v81, v82
  v_max3_f32 v36, v36, v83, v84
  buffer_load_dwordx4 v14, s[36:39], s54 offen offset:1024 sc1 nt lds
  v_max3_f32 v36, v36, v85, v86
  v_max3_f32 v36, v36, v87, v88
  v_mfma_f32_32x32x16_bf16 a[96:111], v[188:191], v[116:119], a[96:111]
  v_max3_f32 v36, v36, v89, v90
  v_max3_f32 v36, v36, v91, v92
  v_max3_f32 v36, v36, v93, v94
  v_max_f32 v36, v36, v95
  v_max3_f32 v37, v96, v97, v98
  buffer_load_dwordx4 v14, s[36:39], s54 offen offset:2048 sc1 nt lds
  v_max3_f32 v37, v37, v99, v100
  v_mfma_f32_32x32x16_bf16 a[112:127], v[188:191], v[124:127], a[112:127]
  v_max3_f32 v37, v37, v101, v102
  v_max3_f32 v37, v37, v103, v104
  v_max3_f32 v37, v37, v105, v106
  v_max3_f32 v37, v37, v107, v108
  v_max3_f32 v37, v37, v109, v110
  v_max_f32 v37, v37, v111
  buffer_load_dwordx4 v14, s[36:39], s54 offen offset:3072 sc1 nt lds
  s_add_u32 s53, s53, s68
  v_cmp_lt_f32 vcc, s66, v36
  v_cmp_lt_f32 s[60:61], s66, v37
  s_waitcnt vmcnt(24)
  ds_read_b128 v[128:131], v16 offset:0
  ds_read_b128 v[132:135], v17 offset:0
  ds_read_b128 v[136:139], v18 offset:0
  ds_read_b128 v[140:143], v19 offset:0
  ds_read_b128 v[144:147], v20 offset:0
  ds_read_b128 v[148:151], v21 offset:0
  ds_read_b128 v[152:155], v22 offset:0
  ds_read_b128 v[156:159], v23 offset:0
  s_or_b64 s[60:61], s[60:61], vcc
  s_cbranch_scc1 L1_rare0
L1_back0:
  s_sub_u32 s64, s64, 1
  s_cmp_lg_u32 s64, 0
  s_cbranch_scc1 L1_loop
  v_mov_b32 v33, 0
  buffer_load_dword v32, v33, s[40:43], 0 offen sc1
  s_barrier
  s_waitcnt lgkmcnt(7)
  v_mfma_f32_32x32x16_bf16 v[48:63], v[128:131], a[128:131], 0
  v_exp_f32 v80, v80
  v_exp_f32 v81, v81
  v_mfma_f32_32x32x16_bf16 v[64:79], v[128:131], a[160:163], 0
  v_exp_f32 v82, v82
  v_exp_f32 v83, v83
  v_cvt_pk_bf16_f32 v112, v80, v81
  s_waitcnt lgkmcnt(6)
  v_mfma_f32_32x32x16_bf16 v[48:63], v[132:135], a[132:135], v[48:63]
  v_exp_f32 v84, v84
  v_exp_f32 v85, v85
  v_mfma_f32_32x32x16_bf16 v[64:79], v[132:135], a[164:167], v[64:79]
  v_cvt_pk_bf16_f32 v113, v82, v83
  v_exp_f32 v86, v86
  v_exp_f32 v87, v87
  s_waitcnt lgkmcnt(5)
  v_mfma_f32_32x32x16_bf16 v[48:63], v[136:139], a[136:139], v[48:63]
  v_cvt_pk_bf16_f32 v114, v84, v85
  v_exp_f32 v88, v88
  v_exp_f32 v89, v89
  v_mfma_f32_32x32x16_bf16 v[64:79], v[136:139], a[168:171], v[64:79]
  v_cvt_pk_bf16_f32 v115, v86, v87
  v_exp_f32 v90, v90
  s_waitcnt lgkmcnt(0)
  v_mfma_f32_32x32x16_bf16 v[48:63], v[140:143], a[140:143], v[48:63]
  v_exp_f32 v91, v91
  v_cvt_pk_bf16_f32 v116, v88, v89
  v_exp_f32 v92, v92
  v_mfma_f32_32x32x16_bf16 v[64:79], v[140:143], a[172:175], v[64:79]
  v_exp_f32 v93, v93
  v_cvt_pk_bf16_f32 v117, v90, v91
  v_exp_f32 v94, v94
  v_mfma_f32_32x32x16_bf16 v[48:63], v[144:147], a[144:147], v[48:63]
  v_exp_f32 v95, v95
  v_cvt_pk_bf16_f32 v118, v92, v93
  v_exp_f32 v96, v96
  v_exp_f32 v97, v97
  v_mfma_f32_32x32x16_bf16 v[64:79], v[144:147], a[176:179], v[64:79]
  v_cvt_pk_bf16_f32 v119, v94, v95
  v_exp_f32 v98, v98
  v_exp_f32 v99, v99
  v_mfma_f32_32x32x16_bf16 v[48:63], v[148:151], a[148:151], v[48:63]
  v_cvt_pk_bf16_f32 v120, v96, v97
  v_exp_f32 v100, v100
  v_exp_f32 v101, v101
  v_mfma_f32_32x32x16_bf16 v[64:79], v[148:151], a[180:183], v[64:79]
  v_cvt_pk_bf16_f32 v121, v98, v99
  v_exp_f32 v102, v102
  v_exp_f32 v103, v103
  v_cvt_pk_bf16_f32 v122, v100, v101
  v_mfma_f32_32x32x16_bf16 v[48:63], v[152:155], a[152:155], v[48:63]
  v_exp_f32 v104, v104
  v_exp_f32 v105, v105
  v_cvt_pk_bf16_f32 v123, v102, v103
  v_mfma_f32_32x32x16_bf16 v[64:79], v[152:155], a[184:187], v[64:79]
  v_exp_f32 v106, v106
  v_exp_f32 v107, v107
  v_cvt_pk_bf16_f32 v124, v104, v105
  v_mfma_f32_32x32x16_bf16 v[48:63], v[156:159], a[156:159], v[48:63]
  v_exp_f32 v108, v108
  v_exp_f32 v109, v109
  v_cvt_pk_bf16_f32 v125, v106, v107
  v_exp_f32 v110, v110
  v_mfma_f32_32x32x16_bf16 v[64:79], v[156:159], a[188:191], v[64:79]
  v_exp_f32 v111, v111
  v_cvt_pk_bf16_f32 v126, v108, v109
  s_nop 0
  v_cvt_pk_bf16_f32 v127, v110, v111
  s_waitcnt vmcnt(17)
  ds_read_b64_tr_b16 v[160:161], v24 offset:32768
  ds_read_b64_tr_b16 v[162:163], v24 offset:34816
  ds_read_b64_tr_b16 v[164:165], v25 offset:32768
  ds_read_b64_tr_b16 v[166:167], v25 offset:34816
  ds_read_b64_tr_b16 v[168:169], v26 offset:32768
  ds_read_b64_tr_b16 v[170:171], v26 offset:34816
  ds_read_b64_tr_b16 v[172:173], v27 offset:32768
  ds_read_b64_tr_b16 v[174:175], v27 offset:34816
  ds_read_b64_tr_b16 v[176:177], v24 offset:36864
  ds_read_b64_tr_b16 v[178:179], v24 offset:38912
  ds_read_b64_tr_b16 v[180:181], v25 offset:36864
  ds_read_b64_tr_b16 v[182:183], v25 offset:38912
  ds_read_b64_tr_b16 v[184:185], v26 offset:36864
  ds_read_b64_tr_b16 v[186:187], v26 offset:38912
  ds_read_b64_tr_b16 v[188:189], v27 offset:36864
  v_add_f32 v34, v34, v80
  v_add_f32 v35, v35, v96
  v_add_f32 v34, v34, v81
  v_add_f32 v35, v35, v97
  v_add_f32 v34, v34, v82
  v_add_f32 v35, v35, v98
  v_add_f32 v34, v34, v83
  v_add_f32 v35, v35, v99
  s_waitcnt lgkmcnt(13)
  ds_read_b64_tr_b16 v[190:191], v27 offset:38912
  v_mfma_f32_32x32x16_bf16 a[0:15], v[160:163], v[112:115], a[0:15]
  v_add_f32 v34, v34, v84
  v_add_f32 v35, v35, v100
  v_mfma_f32_32x32x16_bf16 a[16:31], v[160:163], v[120:123], a[16:31]
  v_add_f32 v34, v34, v85
  v_add_f32 v35, v35, v101
  v_add_f32 v34, v34, v86
  s_waitcnt lgkmcnt(12)
  v_mfma_f32_32x32x16_bf16 a[32:47], v[164:167], v[112:115], a[32:47]
  v_add_f32 v35, v35, v102
  v_add_f32 v34, v34, v87
  v_mfma_f32_32x32x16_bf16 a[48:63], v[164:167], v[120:123], a[48:63]
  v_add_f32 v35, v35, v103
  v_add_f32 v34, v34, v88
  s_waitcnt lgkmcnt(10)
  v_mfma_f32_32x32x16_bf16 a[64:79], v[168:171], v[112:115], a[64:79]
  v_add_f32 v35, v35, v104
  v_add_f32 v34, v34, v89
  v_mfma_f32_32x32x16_bf16 a[80:95], v[168:171], v[120:123], a[80:95]
  v_add_f32 v35, v35, v105
  v_add_f32 v34, v34, v90
  v_add_f32 v35, v35, v106
  s_waitcnt lgkmcnt(0)
  v_mfma_f32_32x32x16_bf16 a[96:111], v[172:175], v[112:115], a[96:111]
  v_add_f32 v34, v34, v91
  v_add_f32 v35, v35, v107
  v_mfma_f32_32x32x16_bf16 a[112:127], v[172:175], v[120:123], a[112:127]
  v_add_f32 v34, v34, v92
  v_add_f32 v35, v35, v108
  v_add_f32 v34, v34, v93
  v_add_f32 v35, v35, v109
  v_add_f32 v34, v34, v94
  v_add_f32 v35, v35, v110
  v_add_f32 v34, v34, v95
  s_add_u32 m0, s55, 98304
  s_add_u32 s54, s53, 4096
  buffer_load_dwordx4 v14, s[36:39], s53 offen offset:0 sc1 nt lds
  v_mfma_f32_32x32x16_bf16 a[0:15], v[176:179], v[116:119], a[0:15]
  v_add_f32 v35, v35, v111
  v_fma_f32 v48, v48, s65, -v30
  v_fma_f32 v49, v49, s65, -v30
  v_fma_f32 v50, v50, s65, -v30
  v_fma_f32 v51, v51, s65, -v30
  v_fma_f32 v52, v52, s65, -v30
  v_fma_f32 v53, v53, s65, -v30
  v_mfma_f32_32x32x16_bf16 a[16:31], v[176:179], v[124:127], a[16:31]
  buffer_load_dwordx4 v14, s[36:39], s53 offen offset:1024 sc1 nt lds
  v_fma_f32 v54, v54, s65, -v30
  v_fma_f32 v55, v55, s65, -v30
  v_fma_f32 v56, v56, s65, -v30
  v_fma_f32 v57, v57, s65, -v30
  v_fma_f32 v58, v58, s65, -v30
  v_fma_f32 v59, v59, s65, -v30
  v_mfma_f32_32x32x16_bf16 a[32:47], v[180:183], v[116:119], a[32:47]
  v_fma_f32 v60, v60, s65, -v30
  buffer_load_dwordx4 v14, s[36:39], s53 offen offset:2048 sc1 nt lds
  v_fma_f32 v61, v61, s65, -v30
  v_fma_f32 v62, v62, s65, -v30
  v_fma_f32 v63, v63, s65, -v30
  v_fma_f32 v64, v64, s65, -v31
  v_fma_f32 v65, v65, s65, -v31
  v_mfma_f32_32x32x16_bf16 a[48:63], v[180:183], v[124:127], a[48:63]
  v_fma_f32 v66, v66, s65, -v31
  v_fma_f32 v67, v67, s65, -v31
  buffer_load_dwordx4 v14, s[36:39], s53 offen offset:3072 sc1 nt lds
  v_fma_f32 v68, v68, s65, -v31
  v_fma_f32 v69, v69, s65, -v31
  v_fma_f32 v70, v70, s65, -v31
  v_fma_f32 v71, v71, s65, -v31
  v_mfma_f32_32x32x16_bf16 a[64:79], v[184:187], v[116:119], a[64:79]
  v_fma_f32 v72, v72, s65, -v31
  v_fma_f32 v73, v73, s65, -v31
  v_fma_f32 v74, v74, s65, -v31
  s_add_u32 m0, s55, 102400
  s_nop 0
  buffer_load_dwordx4 v14, s[36:39], s54 offen offset:0 sc1 nt lds
  v_fma_f32 v75, v75, s65, -v31
  v_fma_f32 v76, v76, s65, -v31
  v_fma_f32 v77, v77, s65, -v31
  v_mfma_f32_32x32x16_bf16 a[80:95], v[184:187], v[124:127], a[80:95]
  v_fma_f32 v78, v78, s65, -v31
  v_fma_f32 v79, v79, s65, -v31
  v_max3_f32 v36, v48, v49, v50
  v_max3_f32 v36, v36, v51, v52
  buffer_load_dwordx4 v14, s[36:39], s54 offen offset:1024 sc1 nt lds
  v_max3_f32 v36, v36, v53, v54
  v_max3_f32 v36, v36, v55, v56
  v_mfma_f32_32x32x16_bf16 a[96:111], v[188:191], v[116:119], a[96:111]
  v_max3_f32 v36, v36, v57, v58
  v_max3_f32 v36, v36, v59, v60
  v_max3_f32 v36, v36, v61, v62
  v_max_f32 v36, v36, v63
  v_max3_f32 v37, v64, v65, v66
  buffer_load_dwordx4 v14, s[36:39], s54 offen offset:2048 sc1 nt lds
  v_max3_f32 v37, v37, v67, v68
  v_mfma_f32_32x32x16_bf16 a[112:127], v[188:191], v[124:127], a[112:127]
  v_max3_f32 v37, v37, v69, v70
  v_max3_f32 v37, v37, v71, v72
  v_max3_f32 v37, v37, v73, v74
  v_max3_f32 v37, v37, v75, v76
  v_max3_f32 v37, v37, v77, v78
  v_max_f32 v37, v37, v79
  buffer_load_dwordx4 v14, s[36:39], s54 offen offset:3072 sc1 nt lds
  s_add_u32 s53, s53, s69
  v_cmp_lt_f32 vcc, s66, v36
  v_cmp_lt_f32 s[60:61], s66, v37
  s_waitcnt vmcnt(17)
  ds_read_b128 v[128:131], v16 offset:32768
  ds_read_b128 v[132:135], v17 offset:32768
  ds_read_b128 v[136:139], v18 offset:32768
  ds_read_b128 v[140:143], v19 offset:32768
  ds_read_b128 v[144:147], v20 offset:32768
  ds_read_b128 v[148:151], v21 offset:32768
  ds_read_b128 v[152:155], v22 offset:32768
  ds_read_b128 v[156:159], v23 offset:32768
  s_or_b64 s[60:61], s[60:61], vcc
  s_cbranch_scc1 L1_rareT1
L1_backT1:
  s_cmp_eq_u32 s82, 0
  s_cbranch_scc1 L1_ptail
  s_waitcnt lgkmcnt(7)
  v_mfma_f32_32x32x16_bf16 v[80:95], v[128:131], a[128:131], 0
  v_exp_f32 v48, v48
  v_exp_f32 v49, v49
  v_mfma_f32_32x32x16_bf16 v[96:111], v[128:131], a[160:163], 0
  v_exp_f32 v50, v50
  v_exp_f32 v51, v51
  v_cvt_pk_bf16_f32 v112, v48, v49
  s_waitcnt lgkmcnt(6)
  v_mfma_f32_32x32x16_bf16 v[80:95], v[132:135], a[132:135], v[80:95]
  v_exp_f32 v52, v52
  v_exp_f32 v53, v53
  v_mfma_f32_32x32x16_bf16 v[96:111], v[132:135], a[164:167], v[96:111]
  v_cvt_pk_bf16_f32 v113, v50, v51
  v_exp_f32 v54, v54
  v_exp_f32 v55, v55
  s_waitcnt lgkmcnt(5)
  v_mfma_f32_32x32x16_bf16 v[80:95], v[136:139], a[136:139], v[80:95]
  v_cvt_pk_bf16_f32 v114, v52, v53
  v_exp_f32 v56, v56
  v_exp_f32 v57, v57
  v_mfma_f32_32x32x16_bf16 v[96:111], v[136:139], a[168:171], v[96:111]
  v_cvt_pk_bf16_f32 v115, v54, v55
  v_exp_f32 v58, v58
  s_waitcnt lgkmcnt(0)
  v_mfma_f32_32x32x16_bf16 v[80:95], v[140:143], a[140:143], v[80:95]
  v_exp_f32 v59, v59
  v_cvt_pk_bf16_f32 v116, v56, v57
  v_exp_f32 v60, v60
  s_add_u32 m0, s55, 0
  s_and_b32 s90, s85, 8
  s_add_u32 s90, s90, s85
  s_mul_i32 s90, s90, 36864
  s_add_u32 s90, s90, s94
  buffer_load_dwordx4 v192, s[44:47], s90 offen offset:0 lds
  buffer_load_dwordx4 v193, s[44:47], s90 offen offset:1024 lds
  buffer_load_dwordx4 v194, s[44:47], s90 offen offset:2048 lds
  buffer_load_dwordx4 v195, s[44:47], s90 offen offset:3072 lds
  s_add_u32 s85, s85, 1
  s_and_b32 s85, s85, 15
  s_add_u32 m0, s55, 4096
  s_and_b32 s90, s85, 8
  s_add_u32 s90, s90, s85
  s_mul_i32 s90, s90, 36864
  s_add_u32 s90, s90, s94
  buffer_load_dwordx4 v192, s[44:47], s90 offen offset:0 lds
  buffer_load_dwordx4 v193, s[44:47], s90 offen offset:1024 lds
  buffer_load_dwordx4 v194, s[44:47], s90 offen offset:2048 lds
  buffer_load_dwordx4 v195, s[44:47], s90 offen offset:3072 lds
  s_add_u32 s85, s85, 1
  s_and_b32 s85, s85, 15
  s_add_u32 m0, s89, 131072
  s_and_b32 s90, s85, 8
  s_add_u32 s90, s90, s85
  s_mul_i32 s90, s90, 36864
  s_add_u32 s90, s90, s94
  buffer_load_dwordx4 v192, s[44:47], s90 offen offset:0 lds
  buffer_load_dwordx4 v193, s[44:47], s90 offen offset:1024 lds
  buffer_load_dwordx4 v194, s[44:47], s90 offen offset:2048 lds
  buffer_load_dwordx4 v195, s[44:47], s90 offen offset:3072 lds
  s_add_u32 s85, s85, 1
  s_and_b32 s85, s85, 15
  v_mfma_f32_32x32x16_bf16 v[96:111], v[140:143], a[172:175], v[96:111]
  v_exp_f32 v61, v61
  v_cvt_pk_bf16_f32 v117, v58, v59
  v_exp_f32 v62, v62
  v_mfma_f32_32x32x16_bf16 v[80:95], v[144:147], a[144:147], v[80:95]
  v_exp_f32 v63, v63
  v_cvt_pk_bf16_f32 v118, v60, v61
  v_exp_f32 v64, v64
  v_exp_f32 v65, v65
  v_mfma_f32_32x32x16_bf16 v[96:111], v[144:147], a[176:179], v[96:111]
  v_cvt_pk_bf16_f32 v119, v62, v63
  v_exp_f32 v66, v66
  v_exp_f32 v67, v67
  v_mfma_f32_32x32x16_bf16 v[80:95], v[148:151], a[148:151], v[80:95]
  v_cvt_pk_bf16_f32 v120, v64, v65
  v_exp_f32 v68, v68
  v_exp_f32 v69, v69
  v_mfma_f32_32x32x16_bf16 v[96:111], v[148:151], a[180:183], v[96:111]
  v_cvt_pk_bf16_f32 v121, v66, v67
  v_exp_f32 v70, v70
  v_exp_f32 v71, v71
  v_cvt_pk_bf16_f32 v122, v68, v69
  v_mfma_f32_32x32x16_bf16 v[80:95], v[152:155], a[152:155], v[80:95]
  v_exp_f32 v72, v72
  v_exp_f32 v73, v73
  v_cvt_pk_bf16_f32 v123, v70, v71
  v_mfma_f32_32x32x16_bf16 v[96:111], v[152:155], a[184:187], v[96:111]
  v_exp_f32 v74, v74
  v_exp_f32 v75, v75
  v_cvt_pk_bf16_f32 v124, v72, v73
  v_mfma_f32_32x32x16_bf16 v[80:95], v[156:159], a[156:159], v[80:95]
  v_exp_f32 v76, v76
  v_exp_f32 v77, v77
  v_cvt_pk_bf16_f32 v125, v74, v75
  v_exp_f32 v78, v78
  v_mfma_f32_32x32x16_bf16 v[96:111], v[156:159], a[188:191], v[96:111]
  v_exp_f32 v79, v79
  v_cvt_pk_bf16_f32 v126, v76, v77
  s_nop 0
  v_cvt_pk_bf16_f32 v127, v78, v79
  s_waitcnt vmcnt(21)
  ds_read_b64_tr_b16 v[160:161], v24 offset:0
  ds_read_b64_tr_b16 v[162:163], v24 offset:2048
  ds_read_b64_tr_b16 v[164:165], v25 offset:0
  ds_read_b64_tr_b16 v[166:167], v25 offset:2048
  ds_read_b64_tr_b16 v[168:169], v26 offset:0
  ds_read_b64_tr_b16 v[170:171], v26 offset:2048
  ds_read_b64_tr_b16 v[172:173], v27 offset:0
  ds_read_b64_tr_b16 v[174:175], v27 offset:2048
  ds_read_b64_tr_b16 v[176:177], v24 offset:4096
  ds_read_b64_tr_b16 v[178:179], v24 offset:6144
  ds_read_b64_tr_b16 v[180:181], v25 offset:4096
  ds_read_b64_tr_b16 v[182:183], v25 offset:6144
  ds_read_b64_tr_b16 v[184:185], v26 offset:4096
  ds_read_b64_tr_b16 v[186:187], v26 offset:6144
  ds_read_b64_tr_b16 v[188:189], v27 offset:4096
  v_add_f32 v34, v34, v48
  v_add_f32 v35, v35, v64
  v_add_f32 v34, v34, v49
  v_add_f32 v35, v35, v65
  v_add_f32 v34, v34, v50
  v_add_f32 v35, v35, v66
  v_add_f32 v34, v34, v51
  v_add_f32 v35, v35, v67
  s_waitcnt lgkmcnt(13)
  ds_read_b64_tr_b16 v[190:191], v27 offset:6144
  v_mfma_f32_32x32x16_bf16 a[0:15], v[160:163], v[112:115], a[0:15]
  v_add_f32 v34, v34, v52
  v_add_f32 v35, v35, v68
  v_mfma_f32_32x32x16_bf16 a[16:31], v[160:163], v[120:123], a[16:31]
  v_add_f32 v34, v34, v53
  v_add_f32 v35, v35, v69
  v_add_f32 v34, v34, v54
  s_waitcnt lgkmcnt(12)
  v_mfma_f32_32x32x16_bf16 a[32:47], v[164:167], v[112:115], a[32:47]
  v_add_f32 v35, v35, v70
  v_add_f32 v34, v34, v55
  v_mfma_f32_32x32x16_bf16 a[48:63], v[164:167], v[120:123], a[48:63]
  v_add_f32 v35, v35, v71
  v_add_f32 v34, v34, v56
  s_waitcnt lgkmcnt(10)
  v_mfma_f32_32x32x16_bf16 a[64:79], v[168:171], v[112:115], a[64:79]
  v_add_f32 v35, v35, v72
  v_add_f32 v34, v34, v57
  v_mfma_f32_32x32x16_bf16 a[80:95], v[168:171], v[120:123], a[80:95]
  v_add_f32 v35, v35, v73
  v_add_f32 v34, v34, v58
  v_add_f32 v35, v35, v74
  s_waitcnt lgkmcnt(0)
  v_mfma_f32_32x32x16_bf16 a[96:111], v[172:175], v[112:115], a[96:111]
  v_add_f32 v34, v34, v59
  v_add_f32 v35, v35, v75
  v_mfma_f32_32x32x16_bf16 a[112:127], v[172:175], v[120:123], a[112:127]
  v_add_f32 v34, v34, v60
  v_add_f32 v35, v35, v76
  v_add_f32 v34, v34, v61
  v_add_f32 v35, v35, v77
  v_add_f32 v34, v34, v62
  v_add_f32 v35, v35, v78
  v_mfma_f32_32x32x16_bf16 a[0:15], v[176:179], v[116:119], a[0:15]
  v_add_f32 v34, v34, v63
  v_add_f32 v35, v35, v79
  v_fma_f32 v80, v80, s65, -v30
  v_fma_f32 v81, v81, s65, -v30
  v_fma_f32 v82, v82, s65, -v30
  v_fma_f32 v83, v83, s65, -v30
  v_mfma_f32_32x32x16_bf16 a[16:31], v[176:179], v[124:127], a[16:31]
  v_fma_f32 v84, v84, s65, -v30
  v_fma_f32 v85, v85, s65, -v30
  v_fma_f32 v86, v86, s65, -v30
  v_fma_f32 v87, v87, s65, -v30
  v_fma_f32 v88, v88, s65, -v30
  v_fma_f32 v89, v89, s65, -v30
  v_fma_f32 v90, v90, s65, -v30
  v_mfma_f32_32x32x16_bf16 a[32:47], v[180:183], v[116:119], a[32:47]
  v_fma_f32 v91, v91, s65, -v30
  v_fma_f32 v92, v92, s65, -v30
  v_fma_f32 v93, v93, s65, -v30
  v_fma_f32 v94, v94, s65, -v30
  v_fma_f32 v95, v95, s65, -v30
  v_fma_f32 v96, v96, s65, -v31
  v_mfma_f32_32x32x16_bf16 a[48:63], v[180:183], v[124:127], a[48:63]
  v_fma_f32 v97, v97, s65, -v31
  v_fma_f32 v98, v98, s65, -v31
  v_fma_f32 v99, v99, s65, -v31
  v_fma_f32 v100, v100, s65, -v31
  v_fma_f32 v101, v101, s65, -v31
  v_fma_f32 v102, v102, s65, -v31
  v_mfma_f32_32x32x16_bf16 a[64:79], v[184:187], v[116:119], a[64:79]
  v_fma_f32 v103, v103, s65, -v31
  v_fma_f32 v104, v104, s65, -v31
  v_fma_f32 v105, v105, s65, -v31
  v_fma_f32 v106, v106, s65, -v31
  v_fma_f32 v107, v107, s65, -v31
  v_fma_f32 v108, v108, s65, -v31
  v_mfma_f32_32x32x16_bf16 a[80:95], v[184:187], v[124:127], a[80:95]
  v_fma_f32 v109, v109, s65, -v31
  v_fma_f32 v110, v110, s65, -v31
  v_fma_f32 v111, v111, s65, -v31
  v_max3_f32 v36, v80, v81, v82
  v_max3_f32 v36, v36, v83, v84
  v_max3_f32 v36, v36, v85, v86
  v_max3_f32 v36, v36, v87, v88
  v_mfma_f32_32x32x16_bf16 a[96:111], v[188:191], v[116:119], a[96:111]
  v_max3_f32 v36, v36, v89, v90
  v_max3_f32 v36, v36, v91, v92
  v_max3_f32 v36, v36, v93, v94
  v_max_f32 v36, v36, v95
  v_max3_f32 v37, v96, v97, v98
  v_max3_f32 v37, v37, v99, v100
  v_mfma_f32_32x32x16_bf16 a[112:127], v[188:191], v[124:127], a[112:127]
  v_max3_f32 v37, v37, v101, v102
  v_max3_f32 v37, v37, v103, v104
  v_max3_f32 v37, v37, v105, v106
  v_max3_f32 v37, v37, v107, v108
  v_max3_f32 v37, v37, v109, v110
  v_max_f32 v37, v37, v111
  s_waitcnt vmcnt(8)
  ds_read_b64_tr_b16 a[192:193], v196 offset:0
  ds_read_b64_tr_b16 a[194:195], v196 offset:2048
  ds_read_b64_tr_b16 a[196:197], v197 offset:0
  ds_read_b64_tr_b16 a[198:199], v197 offset:2048
  ds_read_b64_tr_b16 a[200:201], v198 offset:0
  ds_read_b64_tr_b16 a[202:203], v198 offset:2048
  ds_read_b64_tr_b16 a[204:205], v199 offset:0
  ds_read_b64_tr_b16 a[206:207], v199 offset:2048
  v_cmp_lt_f32 vcc, s66, v36
  v_cmp_lt_f32 s[60:61], s66, v37
  s_or_b64 s[60:61], s[60:61], vcc
  s_cbranch_scc1 L1_rareT0C
L1_backT0C:
  s_barrier
  v_exp_f32 v80, v80
  v_exp_f32 v81, v81
  v_exp_f32 v82, v82
  v_exp_f32 v83, v83
  v_cvt_pk_bf16_f32 v112, v80, v81
  v_exp_f32 v84, v84
  v_exp_f32 v85, v85
  v_cvt_pk_bf16_f32 v113, v82, v83
  v_exp_f32 v86, v86
  v_exp_f32 v87, v87
  v_cvt_pk_bf16_f32 v114, v84, v85
  v_exp_f32 v88, v88
  v_exp_f32 v89, v89
  v_cvt_pk_bf16_f32 v115, v86, v87
  v_exp_f32 v90, v90
  v_exp_f32 v91, v91
  v_cvt_pk_bf16_f32 v116, v88, v89
  v_exp_f32 v92, v92
  v_exp_f32 v93, v93
  v_cvt_pk_bf16_f32 v117, v90, v91
  v_exp_f32 v94, v94
  v_exp_f32 v95, v95
  v_cvt_pk_bf16_f32 v118, v92, v93
  v_exp_f32 v96, v96
  v_exp_f32 v97, v97
  s_waitcnt lgkmcnt(0)
  s_add_u32 m0, s55, 0
  s_and_b32 s90, s85, 8
  s_add_u32 s90, s90, s85
  s_mul_i32 s90, s90, 36864
  s_add_u32 s90, s90, s94
  buffer_load_dwordx4 v192, s[44:47], s90 offen offset:0 lds
  buffer_load_dwordx4 v193, s[44:47], s90 offen offset:1024 lds
  buffer_load_dwordx4 v194, s[44:47], s90 offen offset:2048 lds
  buffer_load_dwordx4 v195, s[44:47], s90 offen offset:3072 lds
  s_add_u32 s85, s85, 1
  s_and_b32 s85, s85, 15
  s_waitcnt vmcnt(8)
  ds_read_b64_tr_b16 a[208:209], v196 offset:4096
  ds_read_b64_tr_b16 a[210:211], v196 offset:6144
  ds_read_b64_tr_b16 a[212:213], v197 offset:4096
  ds_read_b64_tr_b16 a[214:215], v197 offset:6144
  ds_read_b64_tr_b16 a[216:217], v198 offset:4096
  ds_read_b64_tr_b16 a[218:219], v198 offset:6144
  ds_read_b64_tr_b16 a[220:221], v199 offset:4096
  ds_read_b64_tr_b16 a[222:223], v199 offset:6144
  v_cvt_pk_bf16_f32 v119, v94, v95
  v_exp_f32 v98, v98
  v_exp_f32 v99, v99
  v_cvt_pk_bf16_f32 v120, v96, v97
  v_exp_f32 v100, v100
  v_exp_f32 v101, v101
  v_cvt_pk_bf16_f32 v121, v98, v99
  v_exp_f32 v102, v102
  v_exp_f32 v103, v103
  v_cvt_pk_bf16_f32 v122, v100, v101
  v_exp_f32 v104, v104
  v_exp_f32 v105, v105
  v_cvt_pk_bf16_f32 v123, v102, v103
  v_exp_f32 v106, v106
  v_exp_f32 v107, v107
  v_cvt_pk_bf16_f32 v124, v104, v105
  v_exp_f32 v108, v108
  v_exp_f32 v109, v109
  v_cvt_pk_bf16_f32 v125, v106, v107
  v_exp_f32 v110, v110
  v_exp_f32 v111, v111
  v_cvt_pk_bf16_f32 v126, v108, v109
  s_nop 0
  v_cvt_pk_bf16_f32 v127, v110, v111
  s_waitcnt lgkmcnt(0)
  s_add_u32 m0, s55, 4096
  s_and_b32 s90, s85, 8
  s_add_u32 s90, s90, s85
  s_mul_i32 s90, s90, 36864
  s_add_u32 s90, s90, s94
  buffer_load_dwordx4 v192, s[44:47], s90 offen offset:0 lds
  buffer_load_dwordx4 v193, s[44:47], s90 offen offset:1024 lds
  buffer_load_dwordx4 v194, s[44:47], s90 offen offset:2048 lds
  buffer_load_dwordx4 v195, s[44:47], s90 offen offset:3072 lds
  s_add_u32 s85, s85, 1
  s_and_b32 s85, s85, 15
  s_waitcnt vmcnt(8)
  ds_read_b64_tr_b16 a[224:225], v228 offset:0
  ds_read_b64_tr_b16 a[226:227], v228 offset:2048
  ds_read_b64_tr_b16 a[228:229], v229 offset:0
  ds_read_b64_tr_b16 a[230:231], v229 offset:2048
  ds_read_b64_tr_b16 a[232:233], v230 offset:0
  ds_read_b64_tr_b16 a[234:235], v230 offset:2048
  ds_read_b64_tr_b16 a[236:237], v231 offset:0
  ds_read_b64_tr_b16 a[238:239], v231 offset:2048
  v_add_f32 v34, v34, v80
  v_add_f32 v35, v35, v96
  v_add_f32 v34, v34, v81
  v_add_f32 v35, v35, v97
  v_add_f32 v34, v34, v82
  v_add_f32 v35, v35, v98
  v_add_f32 v34, v34, v83
  v_add_f32 v35, v35, v99
  v_add_f32 v34, v34, v84
  v_add_f32 v35, v35, v100
  v_add_f32 v34, v34, v85
  v_add_f32 v35, v35, v101
  v_add_f32 v34, v34, v86
  v_add_f32 v35, v35, v102
  v_add_f32 v34, v34, v87
  v_add_f32 v35, v35, v103
  v_add_f32 v34, v34, v88
  v_add_f32 v35, v35, v104
  v_add_f32 v34, v34, v89
  v_add_f32 v35, v35, v105
  v_add_f32 v34, v34, v90
  v_add_f32 v35, v35, v106
  v_add_f32 v34, v34, v91
  v_add_f32 v35, v35, v107
  v_add_f32 v34, v34, v92
  v_add_f32 v35, v35, v108
  v_add_f32 v34, v34, v93
  v_add_f32 v35, v35, v109
  v_add_f32 v34, v34, v94
  v_add_f32 v35, v35, v110
  v_add_f32 v34, v34, v95
  v_add_f32 v35, v35, v111
  v_mov_b32 v38, v34
  v_mov_b32 v39, v35
  v_mov_b32 v40, v30
  v_mov_b32 v41, v31
  s_lshl_b32 s29, s20, 9
  s_add_u32 s29, s29, 147456
  v_permlane32_swap_b32 v38, v39
  v_permlane32_swap_b32 v40, v41
  v_add_f32 v41, v38, v39
  v_lshlrev_b32 v2, 3, v1
  v_add_u32 v3, s29, v2
  ds_write_b64 v3, v[40:41]
  v_and_b32 v2, 31, v1
  v_lshlrev_b32 v2, 3, v2
  v_lshlrev_b32 v3, 4, v1
  s_sub_u32 s29, s20, 0
  s_and_b32 s29, s29, 3
  s_lshl_b32 s30, s29, 9
  s_add_u32 s30, s30, 147456
  v_add_u32 v42, s30, v2
  s_sub_u32 s29, s20, 1
  s_and_b32 s29, s29, 3
  s_lshl_b32 s30, s29, 9
  s_add_u32 s30, s30, 147456
  v_add_u32 v43, s30, v2
  s_lshl_b32 s30, s29, 13
  s_add_u32 s30, s30, 32768
  v_add_u32 v46, s30, v3
  s_sub_u32 s29, s20, 2
  s_and_b32 s29, s29, 3
  s_lshl_b32 s30, s29, 9
  s_add_u32 s30, s30, 147456
  v_add_u32 v44, s30, v2
  s_lshl_b32 s30, s29, 13
  s_add_u32 s30, s30, 65536
  v_add_u32 v47, s30, v3
  s_sub_u32 s29, s20, 3
  s_and_b32 s29, s29, 3
  s_lshl_b32 s30, s29, 9
  s_add_u32 s30, s30, 147456
  v_add_u32 v45, s30, v2
  s_lshl_b32 s30, s29, 13
  s_add_u32 s30, s30, 98304
  v_add_u32 v6, s30, v3
  v_add_u32 v4, 0x10000, v15
  s_waitcnt lgkmcnt(1)
  s_add_u32 m0, s89, 131072
  s_and_b32 s90, s85, 8
  s_add_u32 s90, s90, s85
  s_mul_i32 s90, s90, 36864
  s_add_u32 s90, s90, s94
  buffer_load_dwordx4 v192, s[44:47], s90 offen offset:0 lds
  buffer_load_dwordx4 v193, s[44:47], s90 offen offset:1024 lds
  buffer_load_dwordx4 v194, s[44:47], s90 offen offset:2048 lds
  buffer_load_dwordx4 v195, s[44:47], s90 offen offset:3072 lds
  s_add_u32 s85, s85, 1
  s_and_b32 s85, s85, 15
  s_waitcnt vmcnt(8)
  ds_read_b64_tr_b16 a[240:241], v196 offset:0
  ds_read_b64_tr_b16 a[242:243], v196 offset:2048
  ds_read_b64_tr_b16 a[244:245], v197 offset:0
  ds_read_b64_tr_b16 a[246:247], v197 offset:2048
  ds_read_b64_tr_b16 a[248:249], v198 offset:0
  ds_read_b64_tr_b16 a[250:251], v198 offset:2048
  ds_read_b64_tr_b16 a[252:253], v199 offset:0
  ds_read_b64_tr_b16 a[254:255], v199 offset:2048
  ds_read_b64_tr_b16 v[164:165], v25 offset:32768
  ds_read_b64_tr_b16 v[166:167], v25 offset:34816
  ds_read_b64_tr_b16 v[180:181], v25 offset:36864
  ds_read_b64_tr_b16 v[182:183], v25 offset:38912
  ds_read_b64_tr_b16 v[168:169], v26 offset:32768
  ds_read_b64_tr_b16 v[170:171], v26 offset:34816
  s_waitcnt lgkmcnt(10)
  ds_read_b64_tr_b16 v[184:185], v26 offset:36864
  ds_read_b64_tr_b16 v[186:187], v26 offset:38912
  ds_read_b64_tr_b16 v[172:173], v27 offset:32768
  ds_read_b64_tr_b16 v[174:175], v27 offset:34816
  ds_read_b64_tr_b16 v[188:189], v27 offset:36864
  s_waitcnt lgkmcnt(10)
  ds_read_b64_tr_b16 v[190:191], v27 offset:38912
  ds_read_b64_tr_b16 v[160:161], v24 offset:32768
  ds_read_b64_tr_b16 v[162:163], v24 offset:34816
  ds_read_b64_tr_b16 v[176:177], v24 offset:36864
  ds_read_b64_tr_b16 v[178:179], v24 offset:38912
  s_waitcnt lgkmcnt(12)
  v_mfma_f32_32x32x16_bf16 a[32:47], v[164:167], v[112:115], a[32:47]
  v_mfma_f32_32x32x16_bf16 a[32:47], v[180:183], v[116:119], a[32:47]
  v_mfma_f32_32x32x16_bf16 a[48:63], v[164:167], v[120:123], a[48:63]
  v_mfma_f32_32x32x16_bf16 a[48:63], v[180:183], v[124:127], a[48:63]
  s_add_u32 m0, s55, 0
  s_and_b32 s90, s85, 8
  s_add_u32 s90, s90, s85
  s_mul_i32 s90, s90, 36864
  s_add_u32 s90, s90, s94
  buffer_load_dwordx4 v192, s[44:47], s90 offen offset:0 lds
  buffer_load_dwordx4 v193, s[44:47], s90 offen offset:1024 lds
  buffer_load_dwordx4 v194, s[44:47], s90 offen offset:2048 lds
  buffer_load_dwordx4 v195, s[44:47], s90 offen offset:3072 lds
  s_add_u32 s85, s85, 1
  s_and_b32 s85, s85, 15
  s_waitcnt vmcnt(8)
  ds_read_b64_tr_b16 a[128:129], v196 offset:4096
  ds_read_b64_tr_b16 a[130:131], v196 offset:6144
  ds_read_b64_tr_b16 a[132:133], v197 offset:4096
  s_waitcnt lgkmcnt(8)
  ds_read_b64_tr_b16 a[134:135], v197 offset:6144
  ds_read_b64_tr_b16 a[136:137], v198 offset:4096
  ds_read_b64_tr_b16 a[138:139], v198 offset:6144
  ds_read_b64_tr_b16 a[140:141], v199 offset:4096
  ds_read_b64_tr_b16 a[142:143], v199 offset:6144
  v_mfma_f32_32x32x16_bf16 a[64:79], v[168:171], v[112:115], a[64:79]
  v_mfma_f32_32x32x16_bf16 a[64:79], v[184:187], v[116:119], a[64:79]
  s_nop 5
  v_mfma_f32_32x32x16_bf16 a[80:95], v[168:171], v[120:123], a[80:95]
  v_mfma_f32_32x32x16_bf16 a[80:95], v[184:187], v[124:127], a[80:95]
  ds_write_b128 v15, a[32:35] offset:32768
  ds_write_b128 v15, a[36:39] offset:33792
  s_waitcnt lgkmcnt(8)
  ds_write_b128 v15, a[40:43] offset:34816
  ds_write_b128 v15, a[44:47] offset:35840
  v_mfma_f32_32x32x16_bf16 a[96:111], v[172:175], v[112:115], a[96:111]
  v_mfma_f32_32x32x16_bf16 a[96:111], v[188:191], v[116:119], a[96:111]
  ds_write_b128 v15, a[48:51] offset:36864
  ds_write_b128 v15, a[52:55] offset:37888
  ds_write_b128 v15, a[56:59] offset:38912
  ds_write_b128 v15, a[60:63] offset:39936
  s_waitcnt lgkmcnt(8)
  s_add_u32 m0, s55, 4096
  s_and_b32 s90, s85, 8
  s_add_u32 s90, s90, s85
  s_mul_i32 s90, s90, 36864
  s_add_u32 s90, s90, s94
  buffer_load_dwordx4 v192, s[44:47], s90 offen offset:0 lds
  buffer_load_dwordx4 v193, s[44:47], s90 offen offset:1024 lds
  buffer_load_dwordx4 v194, s[44:47], s90 offen offset:2048 lds
  buffer_load_dwordx4 v195, s[44:47], s90 offen offset:3072 lds
  s_add_u32 s85, s85, 1
  s_and_b32 s85, s85, 15
  s_waitcnt vmcnt(8)
  ds_read_b64_tr_b16 a[144:145], v228 offset:0
  ds_read_b64_tr_b16 a[146:147], v228 offset:2048
  ds_read_b64_tr_b16 a[148:149], v229 offset:0
  ds_read_b64_tr_b16 a[150:151], v229 offset:2048
  ds_read_b64_tr_b16 a[152:153], v230 offset:0
  ds_read_b64_tr_b16 a[154:155], v230 offset:2048
  ds_read_b64_tr_b16 a[156:157], v231 offset:0
  s_waitcnt lgkmcnt(8)
  ds_read_b64_tr_b16 a[158:159], v231 offset:2048
  v_mfma_f32_32x32x16_bf16 a[112:127], v[172:175], v[120:123], a[112:127]
  v_mfma_f32_32x32x16_bf16 a[112:127], v[188:191], v[124:127], a[112:127]
  ds_write_b128 v4, a[64:67] offset:0
  ds_write_b128 v4, a[68:71] offset:1024
  ds_write_b128 v4, a[72:75] offset:2048
  ds_write_b128 v4, a[76:79] offset:3072
  v_mfma_f32_32x32x16_bf16 a[0:15], v[160:163], v[112:115], a[0:15]
  v_mfma_f32_32x32x16_bf16 a[0:15], v[176:179], v[116:119], a[0:15]
  ds_write_b128 v4, a[80:83] offset:4096
  ds_write_b128 v4, a[84:87] offset:5120
  s_waitcnt lgkmcnt(8)
  ds_write_b128 v4, a[88:91] offset:6144
  ds_write_b128 v4, a[92:95] offset:7168
  v_mfma_f32_32x32x16_bf16 a[16:31], v[160:163], v[120:123], a[16:31]
  v_mfma_f32_32x32x16_bf16 a[16:31], v[176:179], v[124:127], a[16:31]
  ds_write_b128 v4, a[96:99] offset:32768
  ds_write_b128 v4, a[100:103] offset:33792
  ds_write_b128 v4, a[104:107] offset:34816
  ds_write_b128 v4, a[108:111] offset:35840
  ds_write_b128 v4, a[112:115] offset:36864
  s_waitcnt lgkmcnt(8)
  ds_write_b128 v4, a[116:119] offset:37888
  ds_write_b128 v4, a[120:123] offset:38912
  ds_write_b128 v4, a[124:127] offset:39936
  s_add_u32 m0, s89, 131072
  s_and_b32 s90, s85, 8
  s_add_u32 s90, s90, s85
  s_mul_i32 s90, s90, 36864
  s_add_u32 s90, s90, s94
  buffer_load_dwordx4 v192, s[44:47], s90 offen offset:0 lds
  buffer_load_dwordx4 v193, s[44:47], s90 offen offset:1024 lds
  buffer_load_dwordx4 v194, s[44:47], s90 offen offset:2048 lds
  buffer_load_dwordx4 v195, s[44:47], s90 offen offset:3072 lds
  s_add_u32 s85, s85, 1
  s_and_b32 s85, s85, 15
  s_waitcnt vmcnt(8)
  ds_read_b64_tr_b16 a[160:161], v196 offset:0
  ds_read_b64_tr_b16 a[162:163], v196 offset:2048
  ds_read_b64_tr_b16 a[164:165], v197 offset:0
  ds_read_b64_tr_b16 a[166:167], v197 offset:2048
  s_waitcnt lgkmcnt(8)
  ds_read_b64_tr_b16 a[168:169], v198 offset:0
  ds_read_b64_tr_b16 a[170:171], v198 offset:2048
  ds_read_b64_tr_b16 a[172:173], v199 offset:0
  ds_read_b64_tr_b16 a[174:175], v199 offset:2048
  s_nop 7
  v_accvgpr_read_b32 v64, a0
  v_accvgpr_read_b32 v65, a1
  v_accvgpr_read_b32 v66, a2
  v_accvgpr_read_b32 v67, a3
  v_accvgpr_read_b32 v68, a4
  v_accvgpr_read_b32 v69, a5
  v_accvgpr_read_b32 v70, a6
  v_accvgpr_read_b32 v71, a7
  v_accvgpr_read_b32 v72, a8
  v_accvgpr_read_b32 v73, a9
  v_accvgpr_read_b32 v74, a10
  v_accvgpr_read_b32 v75, a11
  v_accvgpr_read_b32 v76, a12
  v_accvgpr_read_b32 v77, a13
  v_accvgpr_read_b32 v78, a14
  v_accvgpr_read_b32 v79, a15
  v_accvgpr_read_b32 v80, a16
  v_accvgpr_read_b32 v81, a17
  v_accvgpr_read_b32 v82, a18
  v_accvgpr_read_b32 v83, a19
  v_accvgpr_read_b32 v84, a20
  v_accvgpr_read_b32 v85, a21
  v_accvgpr_read_b32 v86, a22
  v_accvgpr_read_b32 v87, a23
  v_accvgpr_read_b32 v88, a24
  v_accvgpr_read_b32 v89, a25
  v_accvgpr_read_b32 v90, a26
  v_accvgpr_read_b32 v91, a27
  v_accvgpr_read_b32 v92, a28
  v_accvgpr_read_b32 v93, a29
  v_accvgpr_read_b32 v94, a30
  v_accvgpr_read_b32 v95, a31
  s_waitcnt lgkmcnt(8)
  s_barrier
  ds_read_b64 v[200:201], v42 offset:0
  ds_read_b64 v[202:203], v42 offset:256
  ds_read_b64 v[204:205], v43 offset:0
  ds_read_b64 v[206:207], v43 offset:256
  ds_read_b64 v[208:209], v44 offset:0
  ds_read_b64 v[210:211], v44 offset:256
  ds_read_b64 v[212:213], v45 offset:0
  s_waitcnt lgkmcnt(8)
  ds_read_b64 v[214:215], v45 offset:256
  ds_read_b128 v[96:99], v46 offset:0
  ds_read_b128 v[100:103], v46 offset:1024
  ds_read_b128 v[104:107], v46 offset:2048
  ds_read_b128 v[108:111], v46 offset:3072
  ds_read_b128 v[128:131], v47 offset:0
  ds_read_b128 v[132:135], v47 offset:1024
  s_waitcnt lgkmcnt(8)
  ds_read_b128 v[136:139], v47 offset:2048
  ds_read_b128 v[140:143], v47 offset:3072
  ds_read_b128 v[160:163], v6 offset:0
  ds_read_b128 v[164:167], v6 offset:1024
  ds_read_b128 v[168:171], v6 offset:2048
  ds_read_b128 v[172:175], v6 offset:3072
  ds_read_b128 v[112:115], v46 offset:4096
  s_waitcnt lgkmcnt(8)
  ds_read_b128 v[116:119], v46 offset:5120
  ds_read_b128 v[120:123], v46 offset:6144
  ds_read_b128 v[124:127], v46 offset:7168
  ds_read_b128 v[144:147], v47 offset:4096
  ds_read_b128 v[148:151], v47 offset:5120
  ds_read_b128 v[152:155], v47 offset:6144
  ds_read_b128 v[156:159], v47 offset:7168
  s_waitcnt lgkmcnt(8)
  ds_read_b128 v[176:179], v6 offset:4096
  ds_read_b128 v[180:183], v6 offset:5120
  ds_read_b128 v[184:187], v6 offset:6144
  ds_read_b128 v[188:191], v6 offset:7168
  s_add_u32 m0, s55, 0
  s_and_b32 s90, s85, 8
  s_add_u32 s90, s90, s85
  s_mul_i32 s90, s90, 36864
  s_add_u32 s90, s90, s94
  buffer_load_dwordx4 v192, s[44:47], s90 offen offset:0 lds
  buffer_load_dwordx4 v193, s[44:47], s90 offen offset:1024 lds
  buffer_load_dwordx4 v194, s[44:47], s90 offen offset:2048 lds
  buffer_load_dwordx4 v195, s[44:47], s90 offen offset:3072 lds
  s_add_u32 s85, s85, 1
  s_and_b32 s85, s85, 15
  s_waitcnt vmcnt(8)
  ds_read_b64_tr_b16 a[176:177], v196 offset:4096
  ds_read_b64_tr_b16 a[178:179], v196 offset:6144
  ds_read_b64_tr_b16 a[180:181], v197 offset:4096
  s_waitcnt lgkmcnt(8)
  ds_read_b64_tr_b16 a[182:183], v197 offset:6144
  ds_read_b64_tr_b16 a[184:185], v198 offset:4096
  ds_read_b64_tr_b16 a[186:187], v198 offset:6144
  ds_read_b64_tr_b16 a[188:189], v199 offset:4096
  ds_read_b64_tr_b16 a[190:191], v199 offset:6144
  v_max3_f32 v216, v200, v204, v208
  v_max_f32 v216, v216, v212
  v_max3_f32 v217, v202, v206, v210
  v_max_f32 v217, v217, v214
  v_sub_f32 v220, v200, v216
  v_sub_f32 v221, v202, v217
  v_sub_f32 v222, v204, v216
  v_sub_f32 v223, v206, v217
  v_sub_f32 v224, v208, v216
  v_sub_f32 v225, v210, v217
  v_sub_f32 v226, v212, v216
  v_sub_f32 v227, v214, v217
  v_exp_f32 v220, v220
  v_exp_f32 v221, v221
  v_exp_f32 v222, v222
  v_exp_f32 v223, v223
  v_exp_f32 v224, v224
  v_exp_f32 v225, v225
  v_exp_f32 v226, v226
  v_exp_f32 v227, v227
  v_mul_f32 v218, v220, v201
  v_mul_f32 v219, v221, v203
  v_fma_f32 v218, v222, v205, v218
  v_fma_f32 v219, v223, v207, v219
  v_fma_f32 v218, v224, v209, v218
  v_fma_f32 v219, v225, v211, v219
  v_fma_f32 v218, v226, v213, v218
  v_fma_f32 v219, v227, v215, v219
  v_rcp_f32 v218, v218
  v_rcp_f32 v219, v219
  s_nop 0
  v_mul_f32 v220, v220, v218
  v_mul_f32 v221, v221, v219
  v_mul_f32 v222, v222, v218
  v_mul_f32 v223, v223, v219
  v_mul_f32 v224, v224, v218
  v_mul_f32 v225, v225, v219
  v_mul_f32 v226, v226, v218
  v_mul_f32 v227, v227, v219
  v_bfe_u32 v2, v1, 4, 1
  v_lshlrev_b32 v2, 16, v2
  v_and_b32 v3, 15, v1
  v_lshl_add_u32 v2, v3, 4, v2
  v_lshrrev_b32 v3, 5, v1
  v_lshl_add_u32 v2, v3, 8, v2
  s_lshl_b32 s29, s23, 18
  s_lshl_b32 s30, s21, 1
  s_and_b32 s31, s24, 1
  s_add_u32 s30, s30, s31
  s_lshl_b32 s30, s30, 2
  s_add_u32 s30, s30, s20
  s_lshl_b32 s30, s30, 10
  s_add_u32 s29, s29, s30
  s_cmp_lt_u32 s24, 2
  s_cselect_b32 s30, 0x200000, 0
  s_add_u32 s29, s29, s30
  s_add_u32 s30, s29, 131072
  s_waitcnt lgkmcnt(0)
  s_add_u32 m0, s55, 4096
  s_and_b32 s90, s85, 8
  s_add_u32 s90, s90, s85
  s_mul_i32 s90, s90, 36864
  s_add_u32 s90, s90, s94
  buffer_load_dwordx4 v192, s[44:47], s90 offen offset:0 lds
  buffer_load_dwordx4 v193, s[44:47], s90 offen offset:1024 lds
  buffer_load_dwordx4 v194, s[44:47], s90 offen offset:2048 lds
  buffer_load_dwordx4 v195, s[44:47], s90 offen offset:3072 lds
  s_add_u32 s85, s85, 1
  s_and_b32 s85, s85, 15
  s_waitcnt vmcnt(8)
  ds_read_b64_tr_b16 a[0:1], v228 offset:0
  ds_read_b64_tr_b16 a[2:3], v228 offset:2048
  ds_read_b64_tr_b16 a[4:5], v229 offset:0
  ds_read_b64_tr_b16 a[6:7], v229 offset:2048
  ds_read_b64_tr_b16 a[8:9], v230 offset:0
  ds_read_b64_tr_b16 a[10:11], v230 offset:2048
  ds_read_b64_tr_b16 a[12:13], v231 offset:0
  ds_read_b64_tr_b16 a[14:15], v231 offset:2048
  v_pk_mul_f32 v[64:65], v[220:221], v[64:65] op_sel:[0,0] op_sel_hi:[0,1]
  v_pk_mul_f32 v[66:67], v[220:221], v[66:67] op_sel:[0,0] op_sel_hi:[0,1]
  v_pk_mul_f32 v[68:69], v[220:221], v[68:69] op_sel:[0,0] op_sel_hi:[0,1]
  v_pk_mul_f32 v[70:71], v[220:221], v[70:71] op_sel:[0,0] op_sel_hi:[0,1]
  v_pk_mul_f32 v[72:73], v[220:221], v[72:73] op_sel:[0,0] op_sel_hi:[0,1]
  v_pk_mul_f32 v[74:75], v[220:221], v[74:75] op_sel:[0,0] op_sel_hi:[0,1]
  v_pk_mul_f32 v[76:77], v[220:221], v[76:77] op_sel:[0,0] op_sel_hi:[0,1]
  v_pk_mul_f32 v[78:79], v[220:221], v[78:79] op_sel:[0,0] op_sel_hi:[0,1]
  v_pk_fma_f32 v[64:65], v[222:223], v[96:97], v[64:65] op_sel:[0,0,0] op_sel_hi:[0,1,1]
  v_pk_fma_f32 v[66:67], v[222:223], v[98:99], v[66:67] op_sel:[0,0,0] op_sel_hi:[0,1,1]
  v_pk_fma_f32 v[68:69], v[222:223], v[100:101], v[68:69] op_sel:[0,0,0] op_sel_hi:[0,1,1]
  v_pk_fma_f32 v[70:71], v[222:223], v[102:103], v[70:71] op_sel:[0,0,0] op_sel_hi:[0,1,1]
  v_pk_fma_f32 v[72:73], v[222:223], v[104:105], v[72:73] op_sel:[0,0,0] op_sel_hi:[0,1,1]
  v_pk_fma_f32 v[74:75], v[222:223], v[106:107], v[74:75] op_sel:[0,0,0] op_sel_hi:[0,1,1]
  v_pk_fma_f32 v[76:77], v[222:223], v[108:109], v[76:77] op_sel:[0,0,0] op_sel_hi:[0,1,1]
  v_pk_fma_f32 v[78:79], v[222:223], v[110:111], v[78:79] op_sel:[0,0,0] op_sel_hi:[0,1,1]
  s_waitcnt lgkmcnt(0)
  s_add_u32 m0, s89, 131072
  s_and_b32 s90, s85, 8
  s_add_u32 s90, s90, s85
  s_mul_i32 s90, s90, 36864
  s_add_u32 s90, s90, s94
  buffer_load_dwordx4 v192, s[44:47], s90 offen offset:0 lds
  buffer_load_dwordx4 v193, s[44:47], s90 offen offset:1024 lds
  buffer_load_dwordx4 v194, s[44:47], s90 offen offset:2048 lds
  buffer_load_dwordx4 v195, s[44:47], s90 offen offset:3072 lds
  s_add_u32 s85, s85, 1
  s_and_b32 s85, s85, 15
  s_waitcnt vmcnt(8)
  ds_read_b64_tr_b16 a[16:17], v196 offset:0
  ds_read_b64_tr_b16 a[18:19], v196 offset:2048
  ds_read_b64_tr_b16 a[20:21], v197 offset:0
  ds_read_b64_tr_b16 a[22:23], v197 offset:2048
  ds_read_b64_tr_b16 a[24:25], v198 offset:0
  ds_read_b64_tr_b16 a[26:27], v198 offset:2048
  ds_read_b64_tr_b16 a[28:29], v199 offset:0
  ds_read_b64_tr_b16 a[30:31], v199 offset:2048
  v_pk_fma_f32 v[64:65], v[224:225], v[128:129], v[64:65] op_sel:[0,0,0] op_sel_hi:[0,1,1]
  v_pk_fma_f32 v[66:67], v[224:225], v[130:131], v[66:67] op_sel:[0,0,0] op_sel_hi:[0,1,1]
  v_pk_fma_f32 v[68:69], v[224:225], v[132:133], v[68:69] op_sel:[0,0,0] op_sel_hi:[0,1,1]
  v_pk_fma_f32 v[70:71], v[224:225], v[134:135], v[70:71] op_sel:[0,0,0] op_sel_hi:[0,1,1]
  v_pk_fma_f32 v[72:73], v[224:225], v[136:137], v[72:73] op_sel:[0,0,0] op_sel_hi:[0,1,1]
  v_pk_fma_f32 v[74:75], v[224:225], v[138:139], v[74:75] op_sel:[0,0,0] op_sel_hi:[0,1,1]
  v_pk_fma_f32 v[76:77], v[224:225], v[140:141], v[76:77] op_sel:[0,0,0] op_sel_hi:[0,1,1]
  v_pk_fma_f32 v[78:79], v[224:225], v[142:143], v[78:79] op_sel:[0,0,0] op_sel_hi:[0,1,1]
  v_pk_fma_f32 v[64:65], v[226:227], v[160:161], v[64:65] op_sel:[0,0,0] op_sel_hi:[0,1,1]
  v_pk_fma_f32 v[66:67], v[226:227], v[162:163], v[66:67] op_sel:[0,0,0] op_sel_hi:[0,1,1]
  v_pk_fma_f32 v[68:69], v[226:227], v[164:165], v[68:69] op_sel:[0,0,0] op_sel_hi:[0,1,1]
  v_pk_fma_f32 v[70:71], v[226:227], v[166:167], v[70:71] op_sel:[0,0,0] op_sel_hi:[0,1,1]
  v_pk_fma_f32 v[72:73], v[226:227], v[168:169], v[72:73] op_sel:[0,0,0] op_sel_hi:[0,1,1]
  v_pk_fma_f32 v[74:75], v[226:227], v[170:171], v[74:75] op_sel:[0,0,0] op_sel_hi:[0,1,1]
  v_pk_fma_f32 v[76:77], v[226:227], v[172:173], v[76:77] op_sel:[0,0,0] op_sel_hi:[0,1,1]
  v_pk_fma_f32 v[78:79], v[226:227], v[174:175], v[78:79] op_sel:[0,0,0] op_sel_hi:[0,1,1]
  v_cvt_pk_bf16_f32 v232, v64, v65
  v_cvt_pk_bf16_f32 v233, v66, v67
  v_cvt_pk_bf16_f32 v234, v72, v73
  v_cvt_pk_bf16_f32 v235, v74, v75
  v_cvt_pk_bf16_f32 v236, v68, v69
  v_cvt_pk_bf16_f32 v237, v70, v71
  v_cvt_pk_bf16_f32 v238, v76, v77
  v_cvt_pk_bf16_f32 v239, v78, v79
  s_waitcnt lgkmcnt(0)
  s_add_u32 m0, s55, 0
  s_and_b32 s90, s85, 8
  s_add_u32 s90, s90, s85
  s_mul_i32 s90, s90, 36864
  s_add_u32 s90, s90, s94
  buffer_load_dwordx4 v192, s[44:47], s90 offen offset:0 lds
  buffer_load_dwordx4 v193, s[44:47], s90 offen offset:1024 lds
  buffer_load_dwordx4 v194, s[44:47], s90 offen offset:2048 lds
  buffer_load_dwordx4 v195, s[44:47], s90 offen offset:3072 lds
  s_add_u32 s85, s85, 1
  s_and_b32 s85, s85, 15
  s_waitcnt vmcnt(8)
  ds_read_b64_tr_b16 a[32:33], v196 offset:4096
  ds_read_b64_tr_b16 a[34:35], v196 offset:6144
  ds_read_b64_tr_b16 a[36:37], v197 offset:4096
  ds_read_b64_tr_b16 a[38:39], v197 offset:6144
  ds_read_b64_tr_b16 a[40:41], v198 offset:4096
  ds_read_b64_tr_b16 a[42:43], v198 offset:6144
  ds_read_b64_tr_b16 a[44:45], v199 offset:4096
  ds_read_b64_tr_b16 a[46:47], v199 offset:6144
  buffer_store_dwordx4 v[232:235], v2, s[48:51], s29 offen offset:0 sc1
  buffer_store_dwordx4 v[236:239], v2, s[48:51], s29 offen offset:512 sc1
  v_pk_mul_f32 v[80:81], v[220:221], v[80:81] op_sel:[1,0] op_sel_hi:[1,1]
  v_pk_mul_f32 v[82:83], v[220:221], v[82:83] op_sel:[1,0] op_sel_hi:[1,1]
  v_pk_mul_f32 v[84:85], v[220:221], v[84:85] op_sel:[1,0] op_sel_hi:[1,1]
  v_pk_mul_f32 v[86:87], v[220:221], v[86:87] op_sel:[1,0] op_sel_hi:[1,1]
  v_pk_mul_f32 v[88:89], v[220:221], v[88:89] op_sel:[1,0] op_sel_hi:[1,1]
  v_pk_mul_f32 v[90:91], v[220:221], v[90:91] op_sel:[1,0] op_sel_hi:[1,1]
  v_pk_mul_f32 v[92:93], v[220:221], v[92:93] op_sel:[1,0] op_sel_hi:[1,1]
  v_pk_mul_f32 v[94:95], v[220:221], v[94:95] op_sel:[1,0] op_sel_hi:[1,1]
  v_pk_fma_f32 v[80:81], v[222:223], v[112:113], v[80:81] op_sel:[1,0,0] op_sel_hi:[1,1,1]
  v_pk_fma_f32 v[82:83], v[222:223], v[114:115], v[82:83] op_sel:[1,0,0] op_sel_hi:[1,1,1]
  v_pk_fma_f32 v[84:85], v[222:223], v[116:117], v[84:85] op_sel:[1,0,0] op_sel_hi:[1,1,1]
  v_pk_fma_f32 v[86:87], v[222:223], v[118:119], v[86:87] op_sel:[1,0,0] op_sel_hi:[1,1,1]
  v_pk_fma_f32 v[88:89], v[222:223], v[120:121], v[88:89] op_sel:[1,0,0] op_sel_hi:[1,1,1]
  v_pk_fma_f32 v[90:91], v[222:223], v[122:123], v[90:91] op_sel:[1,0,0] op_sel_hi:[1,1,1]
  v_pk_fma_f32 v[92:93], v[222:223], v[124:125], v[92:93] op_sel:[1,0,0] op_sel_hi:[1,1,1]
  v_pk_fma_f32 v[94:95], v[222:223], v[126:127], v[94:95] op_sel:[1,0,0] op_sel_hi:[1,1,1]
  s_waitcnt lgkmcnt(0)
  s_add_u32 m0, s55, 4096
  s_and_b32 s90, s85, 8
  s_add_u32 s90, s90, s85
  s_mul_i32 s90, s90, 36864
  s_add_u32 s90, s90, s94
  buffer_load_dwordx4 v192, s[44:47], s90 offen offset:0 lds
  buffer_load_dwordx4 v193, s[44:47], s90 offen offset:1024 lds
  buffer_load_dwordx4 v194, s[44:47], s90 offen offset:2048 lds
  buffer_load_dwordx4 v195, s[44:47], s90 offen offset:3072 lds
  s_add_u32 s85, s85, 1
  s_and_b32 s85, s85, 15
  s_waitcnt vmcnt(10)
  ds_read_b64_tr_b16 a[48:49], v228 offset:0
  ds_read_b64_tr_b16 a[50:51], v228 offset:2048
  ds_read_b64_tr_b16 a[52:53], v229 offset:0
  ds_read_b64_tr_b16 a[54:55], v229 offset:2048
  ds_read_b64_tr_b16 a[56:57], v230 offset:0
  ds_read_b64_tr_b16 a[58:59], v230 offset:2048
  ds_read_b64_tr_b16 a[60:61], v231 offset:0
  ds_read_b64_tr_b16 a[62:63], v231 offset:2048
  v_pk_fma_f32 v[80:81], v[224:225], v[144:145], v[80:81] op_sel:[1,0,0] op_sel_hi:[1,1,1]
  v_pk_fma_f32 v[82:83], v[224:225], v[146:147], v[82:83] op_sel:[1,0,0] op_sel_hi:[1,1,1]
  v_pk_fma_f32 v[84:85], v[224:225], v[148:149], v[84:85] op_sel:[1,0,0] op_sel_hi:[1,1,1]
  v_pk_fma_f32 v[86:87], v[224:225], v[150:151], v[86:87] op_sel:[1,0,0] op_sel_hi:[1,1,1]
  v_pk_fma_f32 v[88:89], v[224:225], v[152:153], v[88:89] op_sel:[1,0,0] op_sel_hi:[1,1,1]
  v_pk_fma_f32 v[90:91], v[224:225], v[154:155], v[90:91] op_sel:[1,0,0] op_sel_hi:[1,1,1]
  v_pk_fma_f32 v[92:93], v[224:225], v[156:157], v[92:93] op_sel:[1,0,0] op_sel_hi:[1,1,1]
  v_pk_fma_f32 v[94:95], v[224:225], v[158:159], v[94:95] op_sel:[1,0,0] op_sel_hi:[1,1,1]
  v_pk_fma_f32 v[80:81], v[226:227], v[176:177], v[80:81] op_sel:[1,0,0] op_sel_hi:[1,1,1]
  v_pk_fma_f32 v[82:83], v[226:227], v[178:179], v[82:83] op_sel:[1,0,0] op_sel_hi:[1,1,1]
  v_pk_fma_f32 v[84:85], v[226:227], v[180:181], v[84:85] op_sel:[1,0,0] op_sel_hi:[1,1,1]
  v_pk_fma_f32 v[86:87], v[226:227], v[182:183], v[86:87] op_sel:[1,0,0] op_sel_hi:[1,1,1]
  v_pk_fma_f32 v[88:89], v[226:227], v[184:185], v[88:89] op_sel:[1,0,0] op_sel_hi:[1,1,1]
  v_pk_fma_f32 v[90:91], v[226:227], v[186:187], v[90:91] op_sel:[1,0,0] op_sel_hi:[1,1,1]
  v_pk_fma_f32 v[92:93], v[226:227], v[188:189], v[92:93] op_sel:[1,0,0] op_sel_hi:[1,1,1]
  v_pk_fma_f32 v[94:95], v[226:227], v[190:191], v[94:95] op_sel:[1,0,0] op_sel_hi:[1,1,1]
  v_cvt_pk_bf16_f32 v240, v80, v81
  v_cvt_pk_bf16_f32 v241, v82, v83
  v_cvt_pk_bf16_f32 v242, v88, v89
  v_cvt_pk_bf16_f32 v243, v90, v91
  v_cvt_pk_bf16_f32 v244, v84, v85
  v_cvt_pk_bf16_f32 v245, v86, v87
  v_cvt_pk_bf16_f32 v246, v92, v93
  v_cvt_pk_bf16_f32 v247, v94, v95
  buffer_store_dwordx4 v[240:243], v2, s[48:51], s30 offen offset:0 sc1
  buffer_store_dwordx4 v[244:247], v2, s[48:51], s30 offen offset:512 sc1
  s_lshl_b32 s29, s23, 5
  s_add_u32 s29, s29, s25
  s_lshl_b32 s29, s29, 7
  s_add_u32 s29, s29, 0x400000
  v_lshlrev_b32 v31, 24, v1
  v_mov_b32 v10, v192
  v_mov_b32 v16, v196
  v_mov_b32 v20, v248
  v_mov_b32 v24, v228
  v_mov_b32 v11, v193
  v_mov_b32 v17, v197
  v_mov_b32 v21, v249
  v_mov_b32 v25, v229
  v_mov_b32 v12, v194
  v_mov_b32 v18, v198
  v_mov_b32 v22, v250
  v_mov_b32 v26, v230
  v_mov_b32 v13, v195
  v_mov_b32 v19, v199
  v_mov_b32 v23, v251
  v_mov_b32 v27, v231
  v_lshlrev_b32 v14, 4, v1
  s_mov_b32 s32, s14
  s_mov_b32 s33, s15
  s_mov_b32 s34, 589824
  s_lshr_b32 s66, s84, 1
  s_lshl_b32 s66, s66, 5
  s_lshl_b32 s67, s20, 3
  s_add_u32 s66, s66, s67
  s_lshl_b32 s66, s66, 7
  s_add_u32 s66, s66, 0x400000
  v_and_b32 v34, 1, v1
  v_bfe_u32 v35, v1, 1, 1
  v_lshl_add_u32 v34, v35, 2, v34
  v_lshlrev_b32 v34, 7, v34
  s_waitcnt vmcnt(0)
  v_readfirstlane_b32 s64, v32
  s_cmp_eq_u32 s64, 0
  s_cbranch_scc1 LF_epspinC
LF_epokC:
  v_mov_b32 v30, s64
  s_waitcnt lgkmcnt(0)
  ds_read_b64_tr_b16 a[64:65], v16 offset:0
  ds_read_b64_tr_b16 a[66:67], v16 offset:2048
  ds_read_b64_tr_b16 a[68:69], v17 offset:0
  ds_read_b64_tr_b16 a[70:71], v17 offset:2048
  ds_read_b64_tr_b16 a[72:73], v18 offset:0
  ds_read_b64_tr_b16 a[74:75], v18 offset:2048
  ds_read_b64_tr_b16 a[76:77], v19 offset:0
  ds_read_b64_tr_b16 a[78:79], v19 offset:2048
  s_barrier
  s_cmp_lg_u32 s20, 0
  s_cbranch_scc1 LF_nosigC
  buffer_store_dword v30, v31, s[48:51], s29 offen sc1
LF_nosigC:
  s_waitcnt lgkmcnt(0)
  s_add_u32 m0, s89, 131072
  s_and_b32 s90, s85, 8
  s_add_u32 s90, s90, s85
  s_mul_i32 s90, s90, 36864
  s_add_u32 s90, s90, s94
  buffer_load_dwordx4 v10, s[44:47], s90 offen offset:0 lds
  buffer_load_dwordx4 v11, s[44:47], s90 offen offset:1024 lds
  buffer_load_dwordx4 v12, s[44:47], s90 offen offset:2048 lds
  buffer_load_dwordx4 v13, s[44:47], s90 offen offset:3072 lds
  s_add_u32 s85, s85, 1
  s_and_b32 s85, s85, 15
  s_add_u32 m0, s55, 32768
  s_and_b32 s90, s85, 8
  s_add_u32 s90, s90, s85
  s_mul_i32 s90, s90, 36864
  s_add_u32 s90, s90, s94
  buffer_load_dwordx4 v10, s[44:47], s90 offen offset:0 lds
  buffer_load_dwordx4 v11, s[44:47], s90 offen offset:1024 lds
  buffer_load_dwordx4 v12, s[44:47], s90 offen offset:2048 lds
  buffer_load_dwordx4 v13, s[44:47], s90 offen offset:3072 lds
  s_add_u32 s85, s85, 1
  s_and_b32 s85, s85, 15
  s_add_u32 m0, s55, 36864
  s_and_b32 s90, s85, 8
  s_add_u32 s90, s90, s85
  s_mul_i32 s90, s90, 36864
  s_add_u32 s90, s90, s87
  buffer_load_dwordx4 v10, s[44:47], s90 offen offset:0 lds
  buffer_load_dwordx4 v11, s[44:47], s90 offen offset:1024 lds
  buffer_load_dwordx4 v12, s[44:47], s90 offen offset:2048 lds
  buffer_load_dwordx4 v13, s[44:47], s90 offen offset:3072 lds
  s_add_u32 s85, s85, 1
  s_and_b32 s85, s85, 15
  s_add_u32 m0, s55, 65536
  s_and_b32 s90, s85, 8
  s_add_u32 s90, s90, s85
  s_mul_i32 s90, s90, 36864
  s_add_u32 s90, s90, s87
  buffer_load_dwordx4 v10, s[44:47], s90 offen offset:0 lds
  buffer_load_dwordx4 v11, s[44:47], s90 offen offset:1024 lds
  buffer_load_dwordx4 v12, s[44:47], s90 offen offset:2048 lds
  buffer_load_dwordx4 v13, s[44:47], s90 offen offset:3072 lds
  s_add_u32 s85, s85, 1
  s_and_b32 s85, s85, 15
  s_add_u32 m0, s55, 69632
  s_and_b32 s90, s85, 8
  s_add_u32 s90, s90, s85
  s_mul_i32 s90, s90, 36864
  s_add_u32 s90, s90, s87
  buffer_load_dwordx4 v10, s[44:47], s90 offen offset:0 lds
  buffer_load_dwordx4 v11, s[44:47], s90 offen offset:1024 lds
  buffer_load_dwordx4 v12, s[44:47], s90 offen offset:2048 lds
  buffer_load_dwordx4 v13, s[44:47], s90 offen offset:3072 lds
  s_add_u32 s85, s85, 1
  s_and_b32 s85, s85, 15
  s_add_u32 m0, s55, 98304
  s_and_b32 s90, s85, 8
  s_add_u32 s90, s90, s85
  s_mul_i32 s90, s90, 36864
  s_add_u32 s90, s90, s87
  buffer_load_dwordx4 v10, s[44:47], s90 offen offset:0 lds
  buffer_load_dwordx4 v11, s[44:47], s90 offen offset:1024 lds
  buffer_load_dwordx4 v12, s[44:47], s90 offen offset:2048 lds
  buffer_load_dwordx4 v13, s[44:47], s90 offen offset:3072 lds
  s_add_u32 s85, s85, 1
  s_and_b32 s85, s85, 15
  s_add_u32 m0, s55, 102400
  s_and_b32 s90, s85, 8
  s_add_u32 s90, s90, s85
  s_mul_i32 s90, s90, 36864
  s_add_u32 s90, s90, s87
  buffer_load_dwordx4 v10, s[44:47], s90 offen offset:0 lds
  buffer_load_dwordx4 v11, s[44:47], s90 offen offset:1024 lds
  buffer_load_dwordx4 v12, s[44:47], s90 offen offset:2048 lds
  buffer_load_dwordx4 v13, s[44:47], s90 offen offset:3072 lds
  s_add_u32 s85, s85, 1
  s_and_b32 s85, s85, 15
  s_add_u32 m0, s89, 147456
  s_and_b32 s90, s85, 8
  s_add_u32 s90, s90, s85
  s_mul_i32 s90, s90, 36864
  s_add_u32 s90, s90, s87
  buffer_load_dwordx4 v10, s[44:47], s90 offen offset:0 lds
  buffer_load_dwordx4 v11, s[44:47], s90 offen offset:1024 lds
  buffer_load_dwordx4 v12, s[44:47], s90 offen offset:2048 lds
  buffer_load_dwordx4 v13, s[44:47], s90 offen offset:3072 lds
  s_add_u32 s85, s85, 1
  s_and_b32 s85, s85, 15
  s_add_u32 m0, s55, 0
  s_and_b32 s90, s85, 8
  s_add_u32 s90, s90, s85
  s_mul_i32 s90, s90, 36864
  s_add_u32 s90, s90, s87
  buffer_load_dwordx4 v10, s[44:47], s90 offen offset:0 lds
  buffer_load_dwordx4 v11, s[44:47], s90 offen offset:1024 lds
  buffer_load_dwordx4 v12, s[44:47], s90 offen offset:2048 lds
  buffer_load_dwordx4 v13, s[44:47], s90 offen offset:3072 lds
  s_add_u32 s85, s85, 1
  s_and_b32 s85, s85, 15
  ds_read_b64_tr_b16 a[80:81], v16 offset:4096
  ds_read_b64_tr_b16 a[82:83], v16 offset:6144
  ds_read_b64_tr_b16 a[84:85], v17 offset:4096
  ds_read_b64_tr_b16 a[86:87], v17 offset:6144
  ds_read_b64_tr_b16 a[88:89], v18 offset:4096
  ds_read_b64_tr_b16 a[90:91], v18 offset:6144
  ds_read_b64_tr_b16 a[92:93], v19 offset:4096
  ds_read_b64_tr_b16 a[94:95], v19 offset:6144
  v_mov_b32 v224, 0
  v_mov_b32 v225, 0
  v_mov_b32 v226, 0
  v_mov_b32 v227, 0
  v_mov_b32 v228, 0
  v_mov_b32 v229, 0
  v_mov_b32 v230, 0
  v_mov_b32 v231, 0
  v_mov_b32 v232, 0
  v_mov_b32 v233, 0
  v_mov_b32 v234, 0
  v_mov_b32 v235, 0
  v_mov_b32 v236, 0
  v_mov_b32 v237, 0
  v_mov_b32 v238, 0
  v_mov_b32 v239, 0
  v_mov_b32 v240, 0
  v_mov_b32 v241, 0
  v_mov_b32 v242, 0
  v_mov_b32 v243, 0
  v_mov_b32 v244, 0
  v_mov_b32 v245, 0
  v_mov_b32 v246, 0
  v_mov_b32 v247, 0
  v_mov_b32 v248, 0
  v_mov_b32 v249, 0
  v_mov_b32 v250, 0
  v_mov_b32 v251, 0
  v_mov_b32 v252, 0
  v_mov_b32 v253, 0
  v_mov_b32 v254, 0
  v_mov_b32 v255, 0
  s_waitcnt lgkmcnt(0)
  s_add_u32 m0, s55, 4096
  s_and_b32 s90, s85, 8
  s_add_u32 s90, s90, s85
  s_mul_i32 s90, s90, 36864
  s_add_u32 s90, s90, s87
  buffer_load_dwordx4 v10, s[44:47], s90 offen offset:0 lds
  buffer_load_dwordx4 v11, s[44:47], s90 offen offset:1024 lds
  buffer_load_dwordx4 v12, s[44:47], s90 offen offset:2048 lds
  buffer_load_dwordx4 v13, s[44:47], s90 offen offset:3072 lds
  s_add_u32 s85, s85, 1
  s_and_b32 s85, s85, 15
  s_waitcnt vmcnt(36)
  ds_read_b64_tr_b16 a[96:97], v24 offset:0
  ds_read_b64_tr_b16 a[98:99], v24 offset:2048
  ds_read_b64_tr_b16 a[100:101], v25 offset:0
  ds_read_b64_tr_b16 a[102:103], v25 offset:2048
  ds_read_b64_tr_b16 a[104:105], v26 offset:0
  ds_read_b64_tr_b16 a[106:107], v26 offset:2048
  ds_read_b64_tr_b16 a[108:109], v27 offset:0
  ds_read_b64_tr_b16 a[110:111], v27 offset:2048
  buffer_load_dword v33, v34, s[48:51], s66 offen offset:256 sc1
  s_waitcnt lgkmcnt(0)
  s_add_u32 m0, s89, 131072
  s_and_b32 s90, s85, 8
  s_add_u32 s90, s90, s85
  s_mul_i32 s90, s90, 36864
  s_add_u32 s90, s90, s87
  buffer_load_dwordx4 v10, s[44:47], s90 offen offset:0 lds
  buffer_load_dwordx4 v11, s[44:47], s90 offen offset:1024 lds
  buffer_load_dwordx4 v12, s[44:47], s90 offen offset:2048 lds
  buffer_load_dwordx4 v13, s[44:47], s90 offen offset:3072 lds
  s_add_u32 s85, s85, 1
  s_and_b32 s85, s85, 15
  s_waitcnt vmcnt(37)
  ds_read_b64_tr_b16 a[112:113], v16 offset:32768
  ds_read_b64_tr_b16 a[114:115], v16 offset:34816
  ds_read_b64_tr_b16 a[116:117], v17 offset:32768
  ds_read_b64_tr_b16 a[118:119], v17 offset:34816
  ds_read_b64_tr_b16 a[120:121], v18 offset:32768
  ds_read_b64_tr_b16 a[122:123], v18 offset:34816
  ds_read_b64_tr_b16 a[124:125], v19 offset:32768
  ds_read_b64_tr_b16 a[126:127], v19 offset:34816
  s_waitcnt lgkmcnt(0)
  s_add_u32 m0, s55, 32768
  s_and_b32 s90, s85, 8
  s_add_u32 s90, s90, s85
  s_mul_i32 s90, s90, 36864
  s_add_u32 s90, s90, s87
  buffer_load_dwordx4 v10, s[44:47], s90 offen offset:0 lds
  buffer_load_dwordx4 v11, s[44:47], s90 offen offset:1024 lds
  buffer_load_dwordx4 v12, s[44:47], s90 offen offset:2048 lds
  buffer_load_dwordx4 v13, s[44:47], s90 offen offset:3072 lds
  s_add_u32 s85, s85, 1
  s_and_b32 s85, s85, 15
  s_waitcnt vmcnt(37)
  ds_read_b64_tr_b16 v[64:65], v16 offset:36864
  ds_read_b64_tr_b16 v[66:67], v16 offset:38912
  ds_read_b64_tr_b16 v[68:69], v17 offset:36864
  ds_read_b64_tr_b16 v[70:71], v17 offset:38912
  ds_read_b64_tr_b16 v[72:73], v18 offset:36864
  ds_read_b64_tr_b16 v[74:75], v18 offset:38912
  ds_read_b64_tr_b16 v[76:77], v19 offset:36864
  ds_read_b64_tr_b16 v[78:79], v19 offset:38912
  s_waitcnt lgkmcnt(0)
  s_add_u32 m0, s55, 36864
  s_and_b32 s90, s85, 8
  s_add_u32 s90, s90, s85
  s_mul_i32 s90, s90, 36864
  s_add_u32 s90, s90, s87
  buffer_load_dwordx4 v10, s[44:47], s90 offen offset:0 lds
  buffer_load_dwordx4 v11, s[44:47], s90 offen offset:1024 lds
  buffer_load_dwordx4 v12, s[44:47], s90 offen offset:2048 lds
  buffer_load_dwordx4 v13, s[44:47], s90 offen offset:3072 lds
  s_add_u32 s85, s85, 1
  s_and_b32 s85, s85, 15
  s_waitcnt vmcnt(37)
  ds_read_b64_tr_b16 v[80:81], v20 offset:0
  ds_read_b64_tr_b16 v[82:83], v20 offset:2048
  ds_read_b64_tr_b16 v[84:85], v21 offset:0
  ds_read_b64_tr_b16 v[86:87], v21 offset:2048
  ds_read_b64_tr_b16 v[88:89], v22 offset:0
  ds_read_b64_tr_b16 v[90:91], v22 offset:2048
  ds_read_b64_tr_b16 v[92:93], v23 offset:0
  ds_read_b64_tr_b16 v[94:95], v23 offset:2048
  s_waitcnt lgkmcnt(0)
  s_add_u32 m0, s55, 65536
  s_and_b32 s90, s85, 8
  s_add_u32 s90, s90, s85
  s_mul_i32 s90, s90, 36864
  s_add_u32 s90, s90, s87
  buffer_load_dwordx4 v10, s[44:47], s90 offen offset:0 lds
  buffer_load_dwordx4 v11, s[44:47], s90 offen offset:1024 lds
  buffer_load_dwordx4 v12, s[44:47], s90 offen offset:2048 lds
  buffer_load_dwordx4 v13, s[44:47], s90 offen offset:3072 lds
  s_add_u32 s85, s85, 1
  s_and_b32 s85, s85, 15
  s_waitcnt vmcnt(37)
  ds_read_b64_tr_b16 v[96:97], v20 offset:4096
  ds_read_b64_tr_b16 v[98:99], v20 offset:6144
  ds_read_b64_tr_b16 v[100:101], v21 offset:4096
  ds_read_b64_tr_b16 v[102:103], v21 offset:6144
  ds_read_b64_tr_b16 v[104:105], v22 offset:4096
  ds_read_b64_tr_b16 v[106:107], v22 offset:6144
  ds_read_b64_tr_b16 v[108:109], v23 offset:4096
  ds_read_b64_tr_b16 v[110:111], v23 offset:6144
  s_waitcnt vmcnt(16)
  v_cmp_ne_u32 vcc, s64, v33
  s_cmp_eq_u64 vcc, 0
  s_cbranch_scc0 LF_spinE
LF_goE:
  s_lshl_b32 s92, s86, 10
  s_add_u32 s92, s92, s95
  s_add_u32 s91, s92, 65536
  buffer_load_dwordx4 v[160:163], v14, s[48:51], s92 offen sc1
  buffer_load_dwordx4 v[164:167], v14, s[48:51], s91 offen sc1
  s_add_u32 s86, s86, 1
  s_and_b32 s86, s86, 15
  s_lshl_b32 s92, s86, 10
  s_add_u32 s92, s92, s95
  s_add_u32 s91, s92, 65536
  buffer_load_dwordx4 v[168:171], v14, s[48:51], s92 offen sc1
  buffer_load_dwordx4 v[172:175], v14, s[48:51], s91 offen sc1
  s_add_u32 s86, s86, 1
  s_and_b32 s86, s86, 15
  s_waitcnt lgkmcnt(0)
  s_add_u32 m0, s55, 69632
  s_and_b32 s90, s85, 8
  s_add_u32 s90, s90, s85
  s_mul_i32 s90, s90, 36864
  s_add_u32 s90, s90, s87
  buffer_load_dwordx4 v10, s[44:47], s90 offen offset:0 lds
  buffer_load_dwordx4 v11, s[44:47], s90 offen offset:1024 lds
  buffer_load_dwordx4 v12, s[44:47], s90 offen offset:2048 lds
  buffer_load_dwordx4 v13, s[44:47], s90 offen offset:3072 lds
  s_add_u32 s85, s85, 1
  s_and_b32 s85, s85, 15
  ds_read_b64_tr_b16 v[112:113], v20 offset:32768
  ds_read_b64_tr_b16 v[114:115], v20 offset:34816
  ds_read_b64_tr_b16 v[116:117], v21 offset:32768
  ds_read_b64_tr_b16 v[118:119], v21 offset:34816
  ds_read_b64_tr_b16 v[120:121], v22 offset:32768
  ds_read_b64_tr_b16 v[122:123], v22 offset:34816
  ds_read_b64_tr_b16 v[124:125], v23 offset:32768
  ds_read_b64_tr_b16 v[126:127], v23 offset:34816
  s_lshl_b32 s92, s86, 10
  s_add_u32 s92, s92, s95
  s_add_u32 s91, s92, 65536
  buffer_load_dwordx4 v[176:179], v14, s[48:51], s92 offen sc1
  buffer_load_dwordx4 v[180:183], v14, s[48:51], s91 offen sc1
  s_add_u32 s86, s86, 1
  s_and_b32 s86, s86, 15
  s_lshl_b32 s92, s86, 10
  s_add_u32 s92, s92, s95
  s_add_u32 s91, s92, 65536
  buffer_load_dwordx4 v[184:187], v14, s[48:51], s92 offen sc1
  buffer_load_dwordx4 v[188:191], v14, s[48:51], s91 offen sc1
  s_add_u32 s86, s86, 1
  s_and_b32 s86, s86, 15
  s_waitcnt lgkmcnt(0)
  s_add_u32 m0, s55, 98304
  s_and_b32 s90, s85, 8
  s_add_u32 s90, s90, s85
  s_mul_i32 s90, s90, 36864
  s_add_u32 s90, s90, s87
  buffer_load_dwordx4 v10, s[44:47], s90 offen offset:0 lds
  buffer_load_dwordx4 v11, s[44:47], s90 offen offset:1024 lds
  buffer_load_dwordx4 v12, s[44:47], s90 offen offset:2048 lds
  buffer_load_dwordx4 v13, s[44:47], s90 offen offset:3072 lds
  s_add_u32 s85, s85, 1
  s_and_b32 s85, s85, 15
  ds_read_b64_tr_b16 v[128:129], v20 offset:36864
  ds_read_b64_tr_b16 v[130:131], v20 offset:38912
  ds_read_b64_tr_b16 v[132:133], v21 offset:36864
  ds_read_b64_tr_b16 v[134:135], v21 offset:38912
  ds_read_b64_tr_b16 v[136:137], v22 offset:36864
  ds_read_b64_tr_b16 v[138:139], v22 offset:38912
  ds_read_b64_tr_b16 v[140:141], v23 offset:36864
  ds_read_b64_tr_b16 v[142:143], v23 offset:38912
  s_lshl_b32 s92, s86, 10
  s_add_u32 s92, s92, s95
  s_add_u32 s91, s92, 65536
  buffer_load_dwordx4 v[192:195], v14, s[48:51], s92 offen sc1
  buffer_load_dwordx4 v[196:199], v14, s[48:51], s91 offen sc1
  s_add_u32 s86, s86, 1
  s_and_b32 s86, s86, 15
  s_lshl_b32 s92, s86, 10
  s_add_u32 s92, s92, s95
  s_add_u32 s91, s92, 65536
  buffer_load_dwordx4 v[200:203], v14, s[48:51], s92 offen sc1
  buffer_load_dwordx4 v[204:207], v14, s[48:51], s91 offen sc1
  s_add_u32 s86, s86, 1
  s_and_b32 s86, s86, 15
  s_waitcnt lgkmcnt(0)
  s_add_u32 m0, s55, 102400
  s_and_b32 s90, s85, 8
  s_add_u32 s90, s90, s85
  s_mul_i32 s90, s90, 36864
  s_add_u32 s90, s90, s87
  buffer_load_dwordx4 v10, s[44:47], s90 offen offset:0 lds
  buffer_load_dwordx4 v11, s[44:47], s90 offen offset:1024 lds
  buffer_load_dwordx4 v12, s[44:47], s90 offen offset:2048 lds
  buffer_load_dwordx4 v13, s[44:47], s90 offen offset:3072 lds
  s_add_u32 s85, s85, 1
  s_and_b32 s85, s85, 15
  ds_read_b64_tr_b16 v[144:145], v24 offset:16384
  ds_read_b64_tr_b16 v[146:147], v24 offset:18432
  ds_read_b64_tr_b16 v[148:149], v25 offset:16384
  ds_read_b64_tr_b16 v[150:151], v25 offset:18432
  ds_read_b64_tr_b16 v[152:153], v26 offset:16384
  ds_read_b64_tr_b16 v[154:155], v26 offset:18432
  ds_read_b64_tr_b16 v[156:157], v27 offset:16384
  ds_read_b64_tr_b16 v[158:159], v27 offset:18432
  s_lshl_b32 s92, s86, 10
  s_add_u32 s92, s92, s95
  s_add_u32 s91, s92, 65536
  buffer_load_dwordx4 v[208:211], v14, s[48:51], s92 offen sc1
  buffer_load_dwordx4 v[212:215], v14, s[48:51], s91 offen sc1
  s_add_u32 s86, s86, 1
  s_and_b32 s86, s86, 15
  s_lshl_b32 s92, s86, 10
  s_add_u32 s92, s92, s95
  s_add_u32 s91, s92, 65536
  buffer_load_dwordx4 v[216:219], v14, s[48:51], s92 offen sc1
  buffer_load_dwordx4 v[220:223], v14, s[48:51], s91 offen sc1
  s_add_u32 s86, s86, 1
  s_and_b32 s86, s86, 15
  s_waitcnt lgkmcnt(0)
  s_add_u32 m0, s89, 147456
  s_and_b32 s90, s85, 8
  s_add_u32 s90, s90, s85
  s_mul_i32 s90, s90, 36864
  s_add_u32 s90, s90, s87
  buffer_load_dwordx4 v10, s[44:47], s90 offen offset:0 lds
  buffer_load_dwordx4 v11, s[44:47], s90 offen offset:1024 lds
  buffer_load_dwordx4 v12, s[44:47], s90 offen offset:2048 lds
  buffer_load_dwordx4 v13, s[44:47], s90 offen offset:3072 lds
  s_add_u32 s85, s85, 1
  s_and_b32 s85, s85, 15
  s_waitcnt vmcnt(30)
  v_mfma_f32_16x16x32_bf16 v[224:227], a[192:195], v[160:163], v[224:227]
  buffer_load_dword v33, v34, s[48:51], s66 offen sc1
  v_mfma_f32_16x16x32_bf16 v[228:231], a[192:195], v[164:167], v[228:231]
  v_mfma_f32_16x16x32_bf16 v[232:235], a[196:199], v[160:163], v[232:235]
  v_mfma_f32_16x16x32_bf16 v[236:239], a[196:199], v[164:167], v[236:239]
  v_mfma_f32_16x16x32_bf16 v[240:243], a[200:203], v[160:163], v[240:243]
  v_mfma_f32_16x16x32_bf16 v[244:247], a[200:203], v[164:167], v[244:247]
  v_mfma_f32_16x16x32_bf16 v[248:251], a[204:207], v[160:163], v[248:251]
  v_mfma_f32_16x16x32_bf16 v[252:255], a[204:207], v[164:167], v[252:255]
  s_waitcnt vmcnt(29)
  v_mfma_f32_16x16x32_bf16 v[224:227], a[208:211], v[168:171], v[224:227]
  s_lshl_b32 s92, s86, 10
  v_mfma_f32_16x16x32_bf16 v[228:231], a[208:211], v[172:175], v[228:231]
  s_add_u32 s92, s92, s95
  v_mfma_f32_16x16x32_bf16 v[232:235], a[212:215], v[168:171], v[232:235]
  s_add_u32 s91, s92, 65536
  v_mfma_f32_16x16x32_bf16 v[236:239], a[212:215], v[172:175], v[236:239]
  buffer_load_dwordx4 v[160:163], v14, s[48:51], s92 offen sc1
  v_mfma_f32_16x16x32_bf16 v[240:243], a[216:219], v[168:171], v[240:243]
  buffer_load_dwordx4 v[164:167], v14, s[48:51], s91 offen sc1
  v_mfma_f32_16x16x32_bf16 v[244:247], a[216:219], v[172:175], v[244:247]
  s_add_u32 s86, s86, 1
  v_mfma_f32_16x16x32_bf16 v[248:251], a[220:223], v[168:171], v[248:251]
  s_and_b32 s86, s86, 15
  v_mfma_f32_16x16x32_bf16 v[252:255], a[220:223], v[172:175], v[252:255]
  s_waitcnt vmcnt(25)
  v_mfma_f32_16x16x32_bf16 v[224:227], a[224:227], v[176:179], v[224:227]
  s_lshl_b32 s92, s86, 10
  s_add_u32 s92, s92, s95
  v_mfma_f32_16x16x32_bf16 v[228:231], a[224:227], v[180:183], v[228:231]
  s_add_u32 s91, s92, 65536
  buffer_load_dwordx4 v[168:171], v14, s[48:51], s92 offen sc1
  v_mfma_f32_16x16x32_bf16 v[232:235], a[228:231], v[176:179], v[232:235]
  buffer_load_dwordx4 v[172:175], v14, s[48:51], s91 offen sc1
  s_add_u32 s86, s86, 1
  v_mfma_f32_16x16x32_bf16 v[236:239], a[228:231], v[180:183], v[236:239]
  s_and_b32 s86, s86, 15
  v_mfma_f32_16x16x32_bf16 v[240:243], a[232:235], v[176:179], v[240:243]
  ds_read_b64_tr_b16 a[192:193], v16 offset:0
  ds_read_b64_tr_b16 a[194:195], v16 offset:2048
  v_mfma_f32_16x16x32_bf16 v[244:247], a[232:235], v[180:183], v[244:247]
  ds_read_b64_tr_b16 a[196:197], v17 offset:0
  ds_read_b64_tr_b16 a[198:199], v17 offset:2048
  v_mfma_f32_16x16x32_bf16 v[248:251], a[236:239], v[176:179], v[248:251]
  ds_read_b64_tr_b16 a[200:201], v18 offset:0
  ds_read_b64_tr_b16 a[202:203], v18 offset:2048
  v_mfma_f32_16x16x32_bf16 v[252:255], a[236:239], v[180:183], v[252:255]
  ds_read_b64_tr_b16 a[204:205], v19 offset:0
  ds_read_b64_tr_b16 a[206:207], v19 offset:2048
  s_waitcnt vmcnt(25)
  s_waitcnt lgkmcnt(0)
  v_mfma_f32_16x16x32_bf16 v[224:227], a[240:243], v[184:187], v[224:227]
  s_lshl_b32 s92, s86, 10
  s_add_u32 s92, s92, s95
  v_mfma_f32_16x16x32_bf16 v[228:231], a[240:243], v[188:191], v[228:231]
  s_add_u32 s91, s92, 65536
  buffer_load_dwordx4 v[176:179], v14, s[48:51], s92 offen sc1
  v_mfma_f32_16x16x32_bf16 v[232:235], a[244:247], v[184:187], v[232:235]
  buffer_load_dwordx4 v[180:183], v14, s[48:51], s91 offen sc1
  s_add_u32 s86, s86, 1
  v_mfma_f32_16x16x32_bf16 v[236:239], a[244:247], v[188:191], v[236:239]
  s_and_b32 s86, s86, 15
  v_mfma_f32_16x16x32_bf16 v[240:243], a[248:251], v[184:187], v[240:243]
  ds_read_b64_tr_b16 a[208:209], v16 offset:4096
  ds_read_b64_tr_b16 a[210:211], v16 offset:6144
  v_mfma_f32_16x16x32_bf16 v[244:247], a[248:251], v[188:191], v[244:247]
  ds_read_b64_tr_b16 a[212:213], v17 offset:4096
  ds_read_b64_tr_b16 a[214:215], v17 offset:6144
  v_mfma_f32_16x16x32_bf16 v[248:251], a[252:255], v[184:187], v[248:251]
  ds_read_b64_tr_b16 a[216:217], v18 offset:4096
  ds_read_b64_tr_b16 a[218:219], v18 offset:6144
  v_mfma_f32_16x16x32_bf16 v[252:255], a[252:255], v[188:191], v[252:255]
  ds_read_b64_tr_b16 a[220:221], v19 offset:4096
  ds_read_b64_tr_b16 a[222:223], v19 offset:6144
  s_waitcnt vmcnt(21)
  s_waitcnt lgkmcnt(0)
  v_mfma_f32_16x16x32_bf16 v[224:227], a[128:131], v[192:195], v[224:227]
  s_lshl_b32 s92, s86, 10
  s_add_u32 s92, s92, s95
  v_mfma_f32_16x16x32_bf16 v[228:231], a[128:131], v[196:199], v[228:231]
  s_add_u32 s91, s92, 65536
  buffer_load_dwordx4 v[184:187], v14, s[48:51], s92 offen sc1
  v_mfma_f32_16x16x32_bf16 v[232:235], a[132:135], v[192:195], v[232:235]
  buffer_load_dwordx4 v[188:191], v14, s[48:51], s91 offen sc1
  s_add_u32 s86, s86, 1
  v_mfma_f32_16x16x32_bf16 v[236:239], a[132:135], v[196:199], v[236:239]
  s_and_b32 s86, s86, 15
  v_mfma_f32_16x16x32_bf16 v[240:243], a[136:139], v[192:195], v[240:243]
  ds_read_b64_tr_b16 a[224:225], v24 offset:0
  ds_read_b64_tr_b16 a[226:227], v24 offset:2048
  v_mfma_f32_16x16x32_bf16 v[244:247], a[136:139], v[196:199], v[244:247]
  ds_read_b64_tr_b16 a[228:229], v25 offset:0
  ds_read_b64_tr_b16 a[230:231], v25 offset:2048
  v_mfma_f32_16x16x32_bf16 v[248:251], a[140:143], v[192:195], v[248:251]
  ds_read_b64_tr_b16 a[232:233], v26 offset:0
  ds_read_b64_tr_b16 a[234:235], v26 offset:2048
  v_mfma_f32_16x16x32_bf16 v[252:255], a[140:143], v[196:199], v[252:255]
  ds_read_b64_tr_b16 a[236:237], v27 offset:0
  ds_read_b64_tr_b16 a[238:239], v27 offset:2048
  s_waitcnt vmcnt(21)
  s_waitcnt lgkmcnt(0)
  v_mfma_f32_16x16x32_bf16 v[224:227], a[144:147], v[200:203], v[224:227]
  s_lshl_b32 s92, s86, 10
  s_add_u32 s92, s92, s95
  v_mfma_f32_16x16x32_bf16 v[228:231], a[144:147], v[204:207], v[228:231]
  s_add_u32 s91, s92, 65536
  buffer_load_dwordx4 v[192:195], v14, s[48:51], s92 offen sc1
  v_mfma_f32_16x16x32_bf16 v[232:235], a[148:151], v[200:203], v[232:235]
  buffer_load_dwordx4 v[196:199], v14, s[48:51], s91 offen sc1
  s_add_u32 s86, s86, 1
  v_mfma_f32_16x16x32_bf16 v[236:239], a[148:151], v[204:207], v[236:239]
  s_and_b32 s86, s86, 15
  v_mfma_f32_16x16x32_bf16 v[240:243], a[152:155], v[200:203], v[240:243]
  ds_read_b64_tr_b16 a[240:241], v16 offset:32768
  ds_read_b64_tr_b16 a[242:243], v16 offset:34816
  v_mfma_f32_16x16x32_bf16 v[244:247], a[152:155], v[204:207], v[244:247]
  ds_read_b64_tr_b16 a[244:245], v17 offset:32768
  ds_read_b64_tr_b16 a[246:247], v17 offset:34816
  v_mfma_f32_16x16x32_bf16 v[248:251], a[156:159], v[200:203], v[248:251]
  ds_read_b64_tr_b16 a[248:249], v18 offset:32768
  ds_read_b64_tr_b16 a[250:251], v18 offset:34816
  v_mfma_f32_16x16x32_bf16 v[252:255], a[156:159], v[204:207], v[252:255]
  ds_read_b64_tr_b16 a[252:253], v19 offset:32768
  ds_read_b64_tr_b16 a[254:255], v19 offset:34816
  s_waitcnt vmcnt(17)
  s_waitcnt lgkmcnt(0)
  v_mfma_f32_16x16x32_bf16 v[224:227], a[160:163], v[208:211], v[224:227]
  s_lshl_b32 s92, s86, 10
  s_add_u32 s92, s92, s95
  v_mfma_f32_16x16x32_bf16 v[228:231], a[160:163], v[212:215], v[228:231]
  s_add_u32 s91, s92, 65536
  buffer_load_dwordx4 v[200:203], v14, s[48:51], s92 offen sc1
  v_mfma_f32_16x16x32_bf16 v[232:235], a[164:167], v[208:211], v[232:235]
  buffer_load_dwordx4 v[204:207], v14, s[48:51], s91 offen sc1
  s_add_u32 s86, s86, 1
  v_mfma_f32_16x16x32_bf16 v[236:239], a[164:167], v[212:215], v[236:239]
  s_and_b32 s86, s86, 15
  v_mfma_f32_16x16x32_bf16 v[240:243], a[168:171], v[208:211], v[240:243]
  ds_read_b64_tr_b16 a[128:129], v16 offset:36864
  ds_read_b64_tr_b16 a[130:131], v16 offset:38912
  v_mfma_f32_16x16x32_bf16 v[244:247], a[168:171], v[212:215], v[244:247]
  ds_read_b64_tr_b16 a[132:133], v17 offset:36864
  ds_read_b64_tr_b16 a[134:135], v17 offset:38912
  v_mfma_f32_16x16x32_bf16 v[248:251], a[172:175], v[208:211], v[248:251]
  ds_read_b64_tr_b16 a[136:137], v18 offset:36864
  ds_read_b64_tr_b16 a[138:139], v18 offset:38912
  v_mfma_f32_16x16x32_bf16 v[252:255], a[172:175], v[212:215], v[252:255]
  ds_read_b64_tr_b16 a[140:141], v19 offset:36864
  ds_read_b64_tr_b16 a[142:143], v19 offset:38912
  s_waitcnt vmcnt(17)
  s_waitcnt lgkmcnt(0)
  v_mfma_f32_16x16x32_bf16 v[224:227], a[176:179], v[216:219], v[224:227]
  s_lshl_b32 s92, s86, 10
  s_add_u32 s92, s92, s95
  v_mfma_f32_16x16x32_bf16 v[228:231], a[176:179], v[220:223], v[228:231]
  s_add_u32 s91, s92, 65536
  buffer_load_dwordx4 v[208:211], v14, s[48:51], s92 offen sc1
  v_mfma_f32_16x16x32_bf16 v[232:235], a[180:183], v[216:219], v[232:235]
  buffer_load_dwordx4 v[212:215], v14, s[48:51], s91 offen sc1
  s_add_u32 s86, s86, 1
  v_mfma_f32_16x16x32_bf16 v[236:239], a[180:183], v[220:223], v[236:239]
  s_and_b32 s86, s86, 15
  v_mfma_f32_16x16x32_bf16 v[240:243], a[184:187], v[216:219], v[240:243]
  ds_read_b64_tr_b16 a[144:145], v20 offset:0
  ds_read_b64_tr_b16 a[146:147], v20 offset:2048
  v_mfma_f32_16x16x32_bf16 v[244:247], a[184:187], v[220:223], v[244:247]
  ds_read_b64_tr_b16 a[148:149], v21 offset:0
  ds_read_b64_tr_b16 a[150:151], v21 offset:2048
  v_mfma_f32_16x16x32_bf16 v[248:251], a[188:191], v[216:219], v[248:251]
  ds_read_b64_tr_b16 a[152:153], v22 offset:0
  ds_read_b64_tr_b16 a[154:155], v22 offset:2048
  v_mfma_f32_16x16x32_bf16 v[252:255], a[188:191], v[220:223], v[252:255]
  ds_read_b64_tr_b16 a[156:157], v23 offset:0
  ds_read_b64_tr_b16 a[158:159], v23 offset:2048
  s_waitcnt vmcnt(12)
  s_waitcnt lgkmcnt(0)
  v_mfma_f32_16x16x32_bf16 v[224:227], a[0:3], v[160:163], v[224:227]
  s_lshl_b32 s92, s86, 10
  s_add_u32 s92, s92, s95
  v_mfma_f32_16x16x32_bf16 v[228:231], a[0:3], v[164:167], v[228:231]
  s_add_u32 s91, s92, 65536
  buffer_load_dwordx4 v[216:219], v14, s[48:51], s92 offen sc1
  v_mfma_f32_16x16x32_bf16 v[232:235], a[4:7], v[160:163], v[232:235]
  buffer_load_dwordx4 v[220:223], v14, s[48:51], s91 offen sc1
  s_add_u32 s86, s86, 1
  v_mfma_f32_16x16x32_bf16 v[236:239], a[4:7], v[164:167], v[236:239]
  s_and_b32 s86, s86, 15
  v_mfma_f32_16x16x32_bf16 v[240:243], a[8:11], v[160:163], v[240:243]
  ds_read_b64_tr_b16 a[160:161], v20 offset:4096
  ds_read_b64_tr_b16 a[162:163], v20 offset:6144
  v_mfma_f32_16x16x32_bf16 v[244:247], a[8:11], v[164:167], v[244:247]
  ds_read_b64_tr_b16 a[164:165], v21 offset:4096
  ds_read_b64_tr_b16 a[166:167], v21 offset:6144
  v_mfma_f32_16x16x32_bf16 v[248:251], a[12:15], v[160:163], v[248:251]
  ds_read_b64_tr_b16 a[168:169], v22 offset:4096
  ds_read_b64_tr_b16 a[170:171], v22 offset:6144
  v_mfma_f32_16x16x32_bf16 v[252:255], a[12:15], v[164:167], v[252:255]
  ds_read_b64_tr_b16 a[172:173], v23 offset:4096
  ds_read_b64_tr_b16 a[174:175], v23 offset:6144
  s_waitcnt vmcnt(12)
  v_cmp_ne_u32 vcc, s64, v33
  s_cmp_eq_u64 vcc, 0
  s_cbranch_scc0 LF_spinL
LF_goL:
  s_waitcnt lgkmcnt(0)
  v_mfma_f32_16x16x32_bf16 v[224:227], a[16:19], v[168:171], v[224:227]
  s_lshl_b32 s92, s86, 10
  s_add_u32 s92, s92, s88
  v_mfma_f32_16x16x32_bf16 v[228:231], a[16:19], v[172:175], v[228:231]
  s_add_u32 s91, s92, 65536
  buffer_load_dwordx4 v[160:163], v14, s[48:51], s92 offen sc1
  v_mfma_f32_16x16x32_bf16 v[232:235], a[20:23], v[168:171], v[232:235]
  buffer_load_dwordx4 v[164:167], v14, s[48:51], s91 offen sc1
  s_add_u32 s86, s86, 1
  v_mfma_f32_16x16x32_bf16 v[236:239], a[20:23], v[172:175], v[236:239]
  s_and_b32 s86, s86, 15
  v_mfma_f32_16x16x32_bf16 v[240:243], a[24:27], v[168:171], v[240:243]
  ds_read_b64_tr_b16 a[176:177], v20 offset:32768
  ds_read_b64_tr_b16 a[178:179], v20 offset:34816
  v_mfma_f32_16x16x32_bf16 v[244:247], a[24:27], v[172:175], v[244:247]
  ds_read_b64_tr_b16 a[180:181], v21 offset:32768
  ds_read_b64_tr_b16 a[182:183], v21 offset:34816
  v_mfma_f32_16x16x32_bf16 v[248:251], a[28:31], v[168:171], v[248:251]
  ds_read_b64_tr_b16 a[184:185], v22 offset:32768
  ds_read_b64_tr_b16 a[186:187], v22 offset:34816
  v_mfma_f32_16x16x32_bf16 v[252:255], a[28:31], v[172:175], v[252:255]
  ds_read_b64_tr_b16 a[188:189], v23 offset:32768
  ds_read_b64_tr_b16 a[190:191], v23 offset:34816
  s_waitcnt vmcnt(12)
  s_waitcnt lgkmcnt(0)
  v_mfma_f32_16x16x32_bf16 v[224:227], a[32:35], v[176:179], v[224:227]
  s_lshl_b32 s92, s86, 10
  s_add_u32 s92, s92, s88
  v_mfma_f32_16x16x32_bf16 v[228:231], a[32:35], v[180:183], v[228:231]
  s_add_u32 s91, s92, 65536
  buffer_load_dwordx4 v[168:171], v14, s[48:51], s92 offen sc1
  v_mfma_f32_16x16x32_bf16 v[232:235], a[36:39], v[176:179], v[232:235]
  buffer_load_dwordx4 v[172:175], v14, s[48:51], s91 offen sc1
  s_add_u32 s86, s86, 1
  v_mfma_f32_16x16x32_bf16 v[236:239], a[36:39], v[180:183], v[236:239]
  s_and_b32 s86, s86, 15
  v_mfma_f32_16x16x32_bf16 v[240:243], a[40:43], v[176:179], v[240:243]
  ds_read_b64_tr_b16 a[0:1], v20 offset:36864
  ds_read_b64_tr_b16 a[2:3], v20 offset:38912
  v_mfma_f32_16x16x32_bf16 v[244:247], a[40:43], v[180:183], v[244:247]
  ds_read_b64_tr_b16 a[4:5], v21 offset:36864
  ds_read_b64_tr_b16 a[6:7], v21 offset:38912
  v_mfma_f32_16x16x32_bf16 v[248:251], a[44:47], v[176:179], v[248:251]
  ds_read_b64_tr_b16 a[8:9], v22 offset:36864
  ds_read_b64_tr_b16 a[10:11], v22 offset:38912
  v_mfma_f32_16x16x32_bf16 v[252:255], a[44:47], v[180:183], v[252:255]
  ds_read_b64_tr_b16 a[12:13], v23 offset:36864
  ds_read_b64_tr_b16 a[14:15], v23 offset:38912
  s_waitcnt vmcnt(12)
  s_waitcnt lgkmcnt(0)
  v_mfma_f32_16x16x32_bf16 v[224:227], a[48:51], v[184:187], v[224:227]
  s_lshl_b32 s92, s86, 10
  s_add_u32 s92, s92, s88
  v_mfma_f32_16x16x32_bf16 v[228:231], a[48:51], v[188:191], v[228:231]
  s_add_u32 s91, s92, 65536
  buffer_load_dwordx4 v[176:179], v14, s[48:51], s92 offen sc1
  v_mfma_f32_16x16x32_bf16 v[232:235], a[52:55], v[184:187], v[232:235]
  buffer_load_dwordx4 v[180:183], v14, s[48:51], s91 offen sc1
  s_add_u32 s86, s86, 1
  v_mfma_f32_16x16x32_bf16 v[236:239], a[52:55], v[188:191], v[236:239]
  s_and_b32 s86, s86, 15
  v_mfma_f32_16x16x32_bf16 v[240:243], a[56:59], v[184:187], v[240:243]
  ds_read_b64_tr_b16 a[16:17], v24 offset:16384
  ds_read_b64_tr_b16 a[18:19], v24 offset:18432
  v_mfma_f32_16x16x32_bf16 v[244:247], a[56:59], v[188:191], v[244:247]
  ds_read_b64_tr_b16 a[20:21], v25 offset:16384
  ds_read_b64_tr_b16 a[22:23], v25 offset:18432
  v_mfma_f32_16x16x32_bf16 v[248:251], a[60:63], v[184:187], v[248:251]
  ds_read_b64_tr_b16 a[24:25], v26 offset:16384
  ds_read_b64_tr_b16 a[26:27], v26 offset:18432
  v_mfma_f32_16x16x32_bf16 v[252:255], a[60:63], v[188:191], v[252:255]
  ds_read_b64_tr_b16 a[28:29], v27 offset:16384
  ds_read_b64_tr_b16 a[30:31], v27 offset:18432
  s_waitcnt vmcnt(12)
  v_mfma_f32_16x16x32_bf16 v[224:227], a[64:67], v[192:195], v[224:227]
  s_lshl_b32 s92, s86, 10
  v_mfma_f32_16x16x32_bf16 v[228:231], a[64:67], v[196:199], v[228:231]
  s_add_u32 s92, s92, s88
  v_mfma_f32_16x16x32_bf16 v[232:235], a[68:71], v[192:195], v[232:235]
  s_add_u32 s91, s92, 65536
  v_mfma_f32_16x16x32_bf16 v[236:239], a[68:71], v[196:199], v[236:239]
  buffer_load_dwordx4 v[184:187], v14, s[48:51], s92 offen sc1
  v_mfma_f32_16x16x32_bf16 v[240:243], a[72:75], v[192:195], v[240:243]
  buffer_load_dwordx4 v[188:191], v14, s[48:51], s91 offen sc1
  v_mfma_f32_16x16x32_bf16 v[244:247], a[72:75], v[196:199], v[244:247]
  s_add_u32 s86, s86, 1
  v_mfma_f32_16x16x32_bf16 v[248:251], a[76:79], v[192:195], v[248:251]
  s_and_b32 s86, s86, 15
  v_mfma_f32_16x16x32_bf16 v[252:255], a[76:79], v[196:199], v[252:255]
  s_waitcnt vmcnt(12)
  v_mfma_f32_16x16x32_bf16 v[224:227], a[80:83], v[200:203], v[224:227]
  s_lshl_b32 s92, s86, 10
  v_mfma_f32_16x16x32_bf16 v[228:231], a[80:83], v[204:207], v[228:231]
  s_add_u32 s92, s92, s88
  v_mfma_f32_16x16x32_bf16 v[232:235], a[84:87], v[200:203], v[232:235]
  s_add_u32 s91, s92, 65536
  v_mfma_f32_16x16x32_bf16 v[236:239], a[84:87], v[204:207], v[236:239]
  buffer_load_dwordx4 v[192:195], v14, s[48:51], s92 offen sc1
  v_mfma_f32_16x16x32_bf16 v[240:243], a[88:91], v[200:203], v[240:243]
  buffer_load_dwordx4 v[196:199], v14, s[48:51], s91 offen sc1
  v_mfma_f32_16x16x32_bf16 v[244:247], a[88:91], v[204:207], v[244:247]
  s_add_u32 s86, s86, 1
  v_mfma_f32_16x16x32_bf16 v[248:251], a[92:95], v[200:203], v[248:251]
  s_and_b32 s86, s86, 15
  v_mfma_f32_16x16x32_bf16 v[252:255], a[92:95], v[204:207], v[252:255]
  s_waitcnt vmcnt(12)
  v_mfma_f32_16x16x32_bf16 v[224:227], a[96:99], v[208:211], v[224:227]
  s_lshl_b32 s92, s86, 10
  v_mfma_f32_16x16x32_bf16 v[228:231], a[96:99], v[212:215], v[228:231]
  s_add_u32 s92, s92, s88
  v_mfma_f32_16x16x32_bf16 v[232:235], a[100:103], v[208:211], v[232:235]
  s_add_u32 s91, s92, 65536
  v_mfma_f32_16x16x32_bf16 v[236:239], a[100:103], v[212:215], v[236:239]
  buffer_load_dwordx4 v[200:203], v14, s[48:51], s92 offen sc1
  v_mfma_f32_16x16x32_bf16 v[240:243], a[104:107], v[208:211], v[240:243]
  buffer_load_dwordx4 v[204:207], v14, s[48:51], s91 offen sc1
  v_mfma_f32_16x16x32_bf16 v[244:247], a[104:107], v[212:215], v[244:247]
  s_add_u32 s86, s86, 1
  v_mfma_f32_16x16x32_bf16 v[248:251], a[108:111], v[208:211], v[248:251]
  s_and_b32 s86, s86, 15
  v_mfma_f32_16x16x32_bf16 v[252:255], a[108:111], v[212:215], v[252:255]
  s_waitcnt vmcnt(12)
  v_mfma_f32_16x16x32_bf16 v[224:227], a[112:115], v[216:219], v[224:227]
  s_lshl_b32 s92, s86, 10
  v_mfma_f32_16x16x32_bf16 v[228:231], a[112:115], v[220:223], v[228:231]
  s_add_u32 s92, s92, s88
  v_mfma_f32_16x16x32_bf16 v[232:235], a[116:119], v[216:219], v[232:235]
  s_add_u32 s91, s92, 65536
  v_mfma_f32_16x16x32_bf16 v[236:239], a[116:119], v[220:223], v[236:239]
  buffer_load_dwordx4 v[208:211], v14, s[48:51], s92 offen sc1
  v_mfma_f32_16x16x32_bf16 v[240:243], a[120:123], v[216:219], v[240:243]
  buffer_load_dwordx4 v[212:215], v14, s[48:51], s91 offen sc1
  v_mfma_f32_16x16x32_bf16 v[244:247], a[120:123], v[220:223], v[244:247]
  s_add_u32 s86, s86, 1
  v_mfma_f32_16x16x32_bf16 v[248:251], a[124:127], v[216:219], v[248:251]
  s_and_b32 s86, s86, 15
  v_mfma_f32_16x16x32_bf16 v[252:255], a[124:127], v[220:223], v[252:255]
  s_waitcnt vmcnt(12)
  v_mfma_f32_16x16x32_bf16 v[224:227], v[64:67], v[160:163], v[224:227]
  s_lshl_b32 s92, s86, 10
  v_mfma_f32_16x16x32_bf16 v[228:231], v[64:67], v[164:167], v[228:231]
  s_add_u32 s92, s92, s88
  v_mfma_f32_16x16x32_bf16 v[232:235], v[68:71], v[160:163], v[232:235]
  s_add_u32 s91, s92, 65536
  v_mfma_f32_16x16x32_bf16 v[236:239], v[68:71], v[164:167], v[236:239]
  buffer_load_dwordx4 v[216:219], v14, s[48:51], s92 offen sc1
  v_mfma_f32_16x16x32_bf16 v[240:243], v[72:75], v[160:163], v[240:243]
  buffer_load_dwordx4 v[220:223], v14, s[48:51], s91 offen sc1
  v_mfma_f32_16x16x32_bf16 v[244:247], v[72:75], v[164:167], v[244:247]
  s_add_u32 s86, s86, 1
  v_mfma_f32_16x16x32_bf16 v[248:251], v[76:79], v[160:163], v[248:251]
  s_and_b32 s86, s86, 15
  v_mfma_f32_16x16x32_bf16 v[252:255], v[76:79], v[164:167], v[252:255]
  s_waitcnt vmcnt(12)
  v_mfma_f32_16x16x32_bf16 v[224:227], v[80:83], v[168:171], v[224:227]
  s_lshl_b32 s92, s86, 10
  v_mfma_f32_16x16x32_bf16 v[228:231], v[80:83], v[172:175], v[228:231]
  s_add_u32 s92, s92, s88
  v_mfma_f32_16x16x32_bf16 v[232:235], v[84:87], v[168:171], v[232:235]
  s_add_u32 s91, s92, 65536
  v_mfma_f32_16x16x32_bf16 v[236:239], v[84:87], v[172:175], v[236:239]
  buffer_load_dwordx4 v[160:163], v14, s[48:51], s92 offen sc1
  v_mfma_f32_16x16x32_bf16 v[240:243], v[88:91], v[168:171], v[240:243]
  buffer_load_dwordx4 v[164:167], v14, s[48:51], s91 offen sc1
  v_mfma_f32_16x16x32_bf16 v[244:247], v[88:91], v[172:175], v[244:247]
  s_add_u32 s86, s86, 1
  v_mfma_f32_16x16x32_bf16 v[248:251], v[92:95], v[168:171], v[248:251]
  s_and_b32 s86, s86, 15
  v_mfma_f32_16x16x32_bf16 v[252:255], v[92:95], v[172:175], v[252:255]
  s_waitcnt vmcnt(12)
  v_mfma_f32_16x16x32_bf16 v[224:227], v[96:99], v[176:179], v[224:227]
  s_lshl_b32 s92, s86, 10
  v_mfma_f32_16x16x32_bf16 v[228:231], v[96:99], v[180:183], v[228:231]
  s_add_u32 s92, s92, s88
  v_mfma_f32_16x16x32_bf16 v[232:235], v[100:103], v[176:179], v[232:235]
  s_add_u32 s91, s92, 65536
  v_mfma_f32_16x16x32_bf16 v[236:239], v[100:103], v[180:183], v[236:239]
  buffer_load_dwordx4 v[168:171], v14, s[48:51], s92 offen sc1
  v_mfma_f32_16x16x32_bf16 v[240:243], v[104:107], v[176:179], v[240:243]
  buffer_load_dwordx4 v[172:175], v14, s[48:51], s91 offen sc1
  v_mfma_f32_16x16x32_bf16 v[244:247], v[104:107], v[180:183], v[244:247]
  s_add_u32 s86, s86, 1
  v_mfma_f32_16x16x32_bf16 v[248:251], v[108:111], v[176:179], v[248:251]
  s_and_b32 s86, s86, 15
  v_mfma_f32_16x16x32_bf16 v[252:255], v[108:111], v[180:183], v[252:255]
  s_waitcnt vmcnt(12)
  v_mfma_f32_16x16x32_bf16 v[224:227], v[112:115], v[184:187], v[224:227]
  s_lshl_b32 s92, s86, 10
  v_mfma_f32_16x16x32_bf16 v[228:231], v[112:115], v[188:191], v[228:231]
  s_add_u32 s92, s92, s88
  v_mfma_f32_16x16x32_bf16 v[232:235], v[116:119], v[184:187], v[232:235]
  s_add_u32 s91, s92, 65536
  v_mfma_f32_16x16x32_bf16 v[236:239], v[116:119], v[188:191], v[236:239]
  buffer_load_dwordx4 v[176:179], v14, s[48:51], s92 offen sc1
  v_mfma_f32_16x16x32_bf16 v[240:243], v[120:123], v[184:187], v[240:243]
  buffer_load_dwordx4 v[180:183], v14, s[48:51], s91 offen sc1
  v_mfma_f32_16x16x32_bf16 v[244:247], v[120:123], v[188:191], v[244:247]
  s_add_u32 s86, s86, 1
  v_mfma_f32_16x16x32_bf16 v[248:251], v[124:127], v[184:187], v[248:251]
  s_and_b32 s86, s86, 15
  v_mfma_f32_16x16x32_bf16 v[252:255], v[124:127], v[188:191], v[252:255]
  s_waitcnt vmcnt(12)
  v_mfma_f32_16x16x32_bf16 v[224:227], v[128:131], v[192:195], v[224:227]
  s_lshl_b32 s92, s86, 10
  v_mfma_f32_16x16x32_bf16 v[228:231], v[128:131], v[196:199], v[228:231]
  s_add_u32 s92, s92, s88
  v_mfma_f32_16x16x32_bf16 v[232:235], v[132:135], v[192:195], v[232:235]
  s_add_u32 s91, s92, 65536
  v_mfma_f32_16x16x32_bf16 v[236:239], v[132:135], v[196:199], v[236:239]
  buffer_load_dwordx4 v[184:187], v14, s[48:51], s92 offen sc1
  v_mfma_f32_16x16x32_bf16 v[240:243], v[136:139], v[192:195], v[240:243]
  buffer_load_dwordx4 v[188:191], v14, s[48:51], s91 offen sc1
  v_mfma_f32_16x16x32_bf16 v[244:247], v[136:139], v[196:199], v[244:247]
  s_add_u32 s86, s86, 1
  v_mfma_f32_16x16x32_bf16 v[248:251], v[140:143], v[192:195], v[248:251]
  s_and_b32 s86, s86, 15
  v_mfma_f32_16x16x32_bf16 v[252:255], v[140:143], v[196:199], v[252:255]
  s_waitcnt vmcnt(12)
  v_mfma_f32_16x16x32_bf16 v[224:227], v[144:147], v[200:203], v[224:227]
  s_lshl_b32 s92, s86, 10
  v_mfma_f32_16x16x32_bf16 v[228:231], v[144:147], v[204:207], v[228:231]
  s_add_u32 s92, s92, s88
  v_mfma_f32_16x16x32_bf16 v[232:235], v[148:151], v[200:203], v[232:235]
  s_add_u32 s91, s92, 65536
  v_mfma_f32_16x16x32_bf16 v[236:239], v[148:151], v[204:207], v[236:239]
  buffer_load_dwordx4 v[192:195], v14, s[48:51], s92 offen sc1
  v_mfma_f32_16x16x32_bf16 v[240:243], v[152:155], v[200:203], v[240:243]
  buffer_load_dwordx4 v[196:199], v14, s[48:51], s91 offen sc1
  v_mfma_f32_16x16x32_bf16 v[244:247], v[152:155], v[204:207], v[244:247]
  s_add_u32 s86, s86, 1
  v_mfma_f32_16x16x32_bf16 v[248:251], v[156:159], v[200:203], v[248:251]
  s_and_b32 s86, s86, 15
  v_mfma_f32_16x16x32_bf16 v[252:255], v[156:159], v[204:207], v[252:255]
  s_waitcnt vmcnt(12)
  v_mfma_f32_16x16x32_bf16 v[224:227], a[192:195], v[208:211], v[224:227]
  s_lshl_b32 s92, s86, 10
  v_mfma_f32_16x16x32_bf16 v[228:231], a[192:195], v[212:215], v[228:231]
  s_add_u32 s92, s92, s88
  v_mfma_f32_16x16x32_bf16 v[232:235], a[196:199], v[208:211], v[232:235]
  s_add_u32 s91, s92, 65536
  v_mfma_f32_16x16x32_bf16 v[236:239], a[196:199], v[212:215], v[236:239]
  buffer_load_dwordx4 v[200:203], v14, s[48:51], s92 offen sc1
  v_mfma_f32_16x16x32_bf16 v[240:243], a[200:203], v[208:211], v[240:243]
  buffer_load_dwordx4 v[204:207], v14, s[48:51], s91 offen sc1
  v_mfma_f32_16x16x32_bf16 v[244:247], a[200:203], v[212:215], v[244:247]
  s_add_u32 s86, s86, 1
  v_mfma_f32_16x16x32_bf16 v[248:251], a[204:207], v[208:211], v[248:251]
  s_and_b32 s86, s86, 15
  v_mfma_f32_16x16x32_bf16 v[252:255], a[204:207], v[212:215], v[252:255]
  s_waitcnt vmcnt(12)
  v_mfma_f32_16x16x32_bf16 v[224:227], a[208:211], v[216:219], v[224:227]
  s_lshl_b32 s92, s86, 10
  v_mfma_f32_16x16x32_bf16 v[228:231], a[208:211], v[220:223], v[228:231]
  s_add_u32 s92, s92, s88
  v_mfma_f32_16x16x32_bf16 v[232:235], a[212:215], v[216:219], v[232:235]
  s_add_u32 s91, s92, 65536
  v_mfma_f32_16x16x32_bf16 v[236:239], a[212:215], v[220:223], v[236:239]
  buffer_load_dwordx4 v[208:211], v14, s[48:51], s92 offen sc1
  v_mfma_f32_16x16x32_bf16 v[240:243], a[216:219], v[216:219], v[240:243]
  buffer_load_dwordx4 v[212:215], v14, s[48:51], s91 offen sc1
  v_mfma_f32_16x16x32_bf16 v[244:247], a[216:219], v[220:223], v[244:247]
  s_add_u32 s86, s86, 1
  v_mfma_f32_16x16x32_bf16 v[248:251], a[220:223], v[216:219], v[248:251]
  s_and_b32 s86, s86, 15
  v_mfma_f32_16x16x32_bf16 v[252:255], a[220:223], v[220:223], v[252:255]
  s_waitcnt vmcnt(12)
  v_mfma_f32_16x16x32_bf16 v[224:227], a[224:227], v[160:163], v[224:227]
  s_lshl_b32 s92, s86, 10
  v_mfma_f32_16x16x32_bf16 v[228:231], a[224:227], v[164:167], v[228:231]
  s_add_u32 s92, s92, s88
  v_mfma_f32_16x16x32_bf16 v[232:235], a[228:231], v[160:163], v[232:235]
  s_add_u32 s91, s92, 65536
  v_mfma_f32_16x16x32_bf16 v[236:239], a[228:231], v[164:167], v[236:239]
  buffer_load_dwordx4 v[216:219], v14, s[48:51], s92 offen sc1
  v_mfma_f32_16x16x32_bf16 v[240:243], a[232:235], v[160:163], v[240:243]
  buffer_load_dwordx4 v[220:223], v14, s[48:51], s91 offen sc1
  v_mfma_f32_16x16x32_bf16 v[244:247], a[232:235], v[164:167], v[244:247]
  s_add_u32 s86, s86, 1
  v_mfma_f32_16x16x32_bf16 v[248:251], a[236:239], v[160:163], v[248:251]
  s_and_b32 s86, s86, 15
  v_mfma_f32_16x16x32_bf16 v[252:255], a[236:239], v[164:167], v[252:255]
  s_waitcnt vmcnt(12)
  v_mfma_f32_16x16x32_bf16 v[224:227], a[240:243], v[168:171], v[224:227]
  v_mfma_f32_16x16x32_bf16 v[228:231], a[240:243], v[172:175], v[228:231]
  v_mfma_f32_16x16x32_bf16 v[232:235], a[244:247], v[168:171], v[232:235]
  v_mfma_f32_16x16x32_bf16 v[236:239], a[244:247], v[172:175], v[236:239]
  v_mfma_f32_16x16x32_bf16 v[240:243], a[248:251], v[168:171], v[240:243]
  v_mfma_f32_16x16x32_bf16 v[244:247], a[248:251], v[172:175], v[244:247]
  v_mfma_f32_16x16x32_bf16 v[248:251], a[252:255], v[168:171], v[248:251]
  v_mfma_f32_16x16x32_bf16 v[252:255], a[252:255], v[172:175], v[252:255]
  s_waitcnt vmcnt(10)
  v_mfma_f32_16x16x32_bf16 v[224:227], a[128:131], v[176:179], v[224:227]
  v_mfma_f32_16x16x32_bf16 v[228:231], a[128:131], v[180:183], v[228:231]
  v_mfma_f32_16x16x32_bf16 v[232:235], a[132:135], v[176:179], v[232:235]
  v_mfma_f32_16x16x32_bf16 v[236:239], a[132:135], v[180:183], v[236:239]
  v_mfma_f32_16x16x32_bf16 v[240:243], a[136:139], v[176:179], v[240:243]
  v_mfma_f32_16x16x32_bf16 v[244:247], a[136:139], v[180:183], v[244:247]
  v_mfma_f32_16x16x32_bf16 v[248:251], a[140:143], v[176:179], v[248:251]
  v_mfma_f32_16x16x32_bf16 v[252:255], a[140:143], v[180:183], v[252:255]
  s_waitcnt vmcnt(8)
  v_mfma_f32_16x16x32_bf16 v[224:227], a[144:147], v[184:187], v[224:227]
  v_mfma_f32_16x16x32_bf16 v[228:231], a[144:147], v[188:191], v[228:231]
  v_mfma_f32_16x16x32_bf16 v[232:235], a[148:151], v[184:187], v[232:235]
  v_mfma_f32_16x16x32_bf16 v[236:239], a[148:151], v[188:191], v[236:239]
  v_mfma_f32_16x16x32_bf16 v[240:243], a[152:155], v[184:187], v[240:243]
  v_mfma_f32_16x16x32_bf16 v[244:247], a[152:155], v[188:191], v[244:247]
  v_mfma_f32_16x16x32_bf16 v[248:251], a[156:159], v[184:187], v[248:251]
  v_mfma_f32_16x16x32_bf16 v[252:255], a[156:159], v[188:191], v[252:255]
  s_waitcnt vmcnt(6)
  v_mfma_f32_16x16x32_bf16 v[224:227], a[160:163], v[192:195], v[224:227]
  v_mfma_f32_16x16x32_bf16 v[228:231], a[160:163], v[196:199], v[228:231]
  v_mfma_f32_16x16x32_bf16 v[232:235], a[164:167], v[192:195], v[232:235]
  v_mfma_f32_16x16x32_bf16 v[236:239], a[164:167], v[196:199], v[236:239]
  v_mfma_f32_16x16x32_bf16 v[240:243], a[168:171], v[192:195], v[240:243]
  v_mfma_f32_16x16x32_bf16 v[244:247], a[168:171], v[196:199], v[244:247]
  v_mfma_f32_16x16x32_bf16 v[248:251], a[172:175], v[192:195], v[248:251]
  v_mfma_f32_16x16x32_bf16 v[252:255], a[172:175], v[196:199], v[252:255]
  s_waitcnt vmcnt(4)
  v_mfma_f32_16x16x32_bf16 v[224:227], a[176:179], v[200:203], v[224:227]
  v_mfma_f32_16x16x32_bf16 v[228:231], a[176:179], v[204:207], v[228:231]
  v_mfma_f32_16x16x32_bf16 v[232:235], a[180:183], v[200:203], v[232:235]
  v_mfma_f32_16x16x32_bf16 v[236:239], a[180:183], v[204:207], v[236:239]
  v_mfma_f32_16x16x32_bf16 v[240:243], a[184:187], v[200:203], v[240:243]
  v_mfma_f32_16x16x32_bf16 v[244:247], a[184:187], v[204:207], v[244:247]
  v_mfma_f32_16x16x32_bf16 v[248:251], a[188:191], v[200:203], v[248:251]
  v_mfma_f32_16x16x32_bf16 v[252:255], a[188:191], v[204:207], v[252:255]
  s_waitcnt vmcnt(2)
  v_mfma_f32_16x16x32_bf16 v[224:227], a[0:3], v[208:211], v[224:227]
  v_mfma_f32_16x16x32_bf16 v[228:231], a[0:3], v[212:215], v[228:231]
  v_mfma_f32_16x16x32_bf16 v[232:235], a[4:7], v[208:211], v[232:235]
  v_mfma_f32_16x16x32_bf16 v[236:239], a[4:7], v[212:215], v[236:239]
  v_mfma_f32_16x16x32_bf16 v[240:243], a[8:11], v[208:211], v[240:243]
  v_mfma_f32_16x16x32_bf16 v[244:247], a[8:11], v[212:215], v[244:247]
  v_mfma_f32_16x16x32_bf16 v[248:251], a[12:15], v[208:211], v[248:251]
  v_mfma_f32_16x16x32_bf16 v[252:255], a[12:15], v[212:215], v[252:255]
  s_waitcnt vmcnt(0)
  s_waitcnt lgkmcnt(0)
  v_mfma_f32_16x16x32_bf16 v[224:227], a[16:19], v[216:219], v[224:227]
  v_mfma_f32_16x16x32_bf16 v[228:231], a[16:19], v[220:223], v[228:231]
  v_mfma_f32_16x16x32_bf16 v[232:235], a[20:23], v[216:219], v[232:235]
  v_mfma_f32_16x16x32_bf16 v[236:239], a[20:23], v[220:223], v[236:239]
  v_mfma_f32_16x16x32_bf16 v[240:243], a[24:27], v[216:219], v[240:243]
  v_mfma_f32_16x16x32_bf16 v[244:247], a[24:27], v[220:223], v[244:247]
  v_mfma_f32_16x16x32_bf16 v[248:251], a[28:31], v[216:219], v[248:251]
  v_mfma_f32_16x16x32_bf16 v[252:255], a[28:31], v[220:223], v[252:255]
  v_add_u32 v2, s55, v14
  s_lshl_b32 s60, s20, 11
  v_add_u32 v3, s60, v14
  s_mul_i32 s60, s84, 36864
  s_lshl_b32 s61, s83, 7
  s_add_u32 s60, s60, s61
  s_lshl_b32 s61, s20, 5
  s_add_u32 s60, s60, s61
  s_add_u32 s61, s60, 18432
  s_nop 1
  ds_write_b128 v2, v[224:227] offset:0
  ds_write_b128 v2, v[228:231] offset:1024
  ds_write_b128 v2, v[232:235] offset:2048
  ds_write_b128 v2, v[236:239] offset:3072
  ds_write_b128 v2, v[240:243] offset:4096
  ds_write_b128 v2, v[244:247] offset:5120
  ds_write_b128 v2, v[248:251] offset:6144
  ds_write_b128 v2, v[252:255] offset:7168
  v_and_b32 v2, 15, v1
  v_mul_u32_u24 v2, 1152, v2
  v_lshrrev_b32 v5, 4, v1
  v_lshl_add_u32 v2, v5, 3, v2
  s_waitcnt lgkmcnt(0)
  s_barrier
  ds_read_b128 v[96:99], v3 offset:0
  ds_read_b128 v[100:103], v3 offset:8192
  ds_read_b128 v[104:107], v3 offset:16384
  ds_read_b128 v[108:111], v3 offset:24576
  ds_read_b128 v[112:115], v3 offset:1024
  ds_read_b128 v[116:119], v3 offset:9216
  ds_read_b128 v[120:123], v3 offset:17408
  ds_read_b128 v[124:127], v3 offset:25600
  s_waitcnt lgkmcnt(0)
  v_add_f32 v96, v96, v104
  v_add_f32 v97, v97, v105
  v_add_f32 v98, v98, v106
  v_add_f32 v99, v99, v107
  v_add_f32 v100, v100, v108
  v_add_f32 v101, v101, v109
  v_add_f32 v102, v102, v110
  v_add_f32 v103, v103, v111
  v_add_f32 v96, v96, v100
  v_add_f32 v97, v97, v101
  v_add_f32 v98, v98, v102
  v_add_f32 v99, v99, v103
  v_cvt_pk_bf16_f32 v96, v96, v97
  v_cvt_pk_bf16_f32 v97, v98, v99
  buffer_store_dwordx2 v[96:97], v2, s[32:35], s60 offen
  v_add_f32 v112, v112, v120
  v_add_f32 v113, v113, v121
  v_add_f32 v114, v114, v122
  v_add_f32 v115, v115, v123
  v_add_f32 v116, v116, v124
  v_add_f32 v117, v117, v125
  v_add_f32 v118, v118, v126
  v_add_f32 v119, v119, v127
  v_add_f32 v112, v112, v116
  v_add_f32 v113, v113, v117
  v_add_f32 v114, v114, v118
  v_add_f32 v115, v115, v119
  v_cvt_pk_bf16_f32 v112, v112, v113
  v_cvt_pk_bf16_f32 v113, v114, v115
  buffer_store_dwordx2 v[112:113], v2, s[32:35], s61 offen
L1_fin:
L1_done:
  s_endpgm
L1_ptail:
  s_waitcnt lgkmcnt(7)
  v_mfma_f32_32x32x16_bf16 v[80:95], v[128:131], a[128:131], 0
  v_exp_f32 v48, v48
  v_exp_f32 v49, v49
  v_mfma_f32_32x32x16_bf16 v[96:111], v[128:131], a[160:163], 0
  v_exp_f32 v50, v50
  v_exp_f32 v51, v51
  v_cvt_pk_bf16_f32 v112, v48, v49
  s_waitcnt lgkmcnt(6)
  v_mfma_f32_32x32x16_bf16 v[80:95], v[132:135], a[132:135], v[80:95]
  v_exp_f32 v52, v52
  v_exp_f32 v53, v53
  v_mfma_f32_32x32x16_bf16 v[96:111], v[132:135], a[164:167], v[96:111]
  v_cvt_pk_bf16_f32 v113, v50, v51
  v_exp_f32 v54, v54
  v_exp_f32 v55, v55
  s_waitcnt lgkmcnt(5)
  v_mfma_f32_32x32x16_bf16 v[80:95], v[136:139], a[136:139], v[80:95]
  v_cvt_pk_bf16_f32 v114, v52, v53
  v_exp_f32 v56, v56
  v_exp_f32 v57, v57
  v_mfma_f32_32x32x16_bf16 v[96:111], v[136:139], a[168:171], v[96:111]
  v_cvt_pk_bf16_f32 v115, v54, v55
  v_exp_f32 v58, v58
  s_waitcnt lgkmcnt(0)
  v_mfma_f32_32x32x16_bf16 v[80:95], v[140:143], a[140:143], v[80:95]
  v_exp_f32 v59, v59
  v_cvt_pk_bf16_f32 v116, v56, v57
  v_exp_f32 v60, v60
  v_mfma_f32_32x32x16_bf16 v[96:111], v[140:143], a[172:175], v[96:111]
  v_exp_f32 v61, v61
  v_cvt_pk_bf16_f32 v117, v58, v59
  v_exp_f32 v62, v62
  v_mfma_f32_32x32x16_bf16 v[80:95], v[144:147], a[144:147], v[80:95]
  v_exp_f32 v63, v63
  v_cvt_pk_bf16_f32 v118, v60, v61
  v_exp_f32 v64, v64
  v_exp_f32 v65, v65
  v_mfma_f32_32x32x16_bf16 v[96:111], v[144:147], a[176:179], v[96:111]
  v_cvt_pk_bf16_f32 v119, v62, v63
  v_exp_f32 v66, v66
  v_exp_f32 v67, v67
  v_mfma_f32_32x32x16_bf16 v[80:95], v[148:151], a[148:151], v[80:95]
  v_cvt_pk_bf16_f32 v120, v64, v65
  v_exp_f32 v68, v68
  v_exp_f32 v69, v69
  v_mfma_f32_32x32x16_bf16 v[96:111], v[148:151], a[180:183], v[96:111]
  v_cvt_pk_bf16_f32 v121, v66, v67
  v_exp_f32 v70, v70
  v_exp_f32 v71, v71
  v_cvt_pk_bf16_f32 v122, v68, v69
  v_mfma_f32_32x32x16_bf16 v[80:95], v[152:155], a[152:155], v[80:95]
  v_exp_f32 v72, v72
  v_exp_f32 v73, v73
  v_cvt_pk_bf16_f32 v123, v70, v71
  v_mfma_f32_32x32x16_bf16 v[96:111], v[152:155], a[184:187], v[96:111]
  v_exp_f32 v74, v74
  v_exp_f32 v75, v75
  v_cvt_pk_bf16_f32 v124, v72, v73
  v_mfma_f32_32x32x16_bf16 v[80:95], v[156:159], a[156:159], v[80:95]
  v_exp_f32 v76, v76
  v_exp_f32 v77, v77
  v_cvt_pk_bf16_f32 v125, v74, v75
  v_exp_f32 v78, v78
  v_mfma_f32_32x32x16_bf16 v[96:111], v[156:159], a[188:191], v[96:111]
  v_exp_f32 v79, v79
  v_cvt_pk_bf16_f32 v126, v76, v77
  s_nop 0
  v_cvt_pk_bf16_f32 v127, v78, v79
  s_waitcnt vmcnt(9)
  ds_read_b64_tr_b16 v[160:161], v24 offset:0
  ds_read_b64_tr_b16 v[162:163], v24 offset:2048
  ds_read_b64_tr_b16 v[164:165], v25 offset:0
  ds_read_b64_tr_b16 v[166:167], v25 offset:2048
  ds_read_b64_tr_b16 v[168:169], v26 offset:0
  ds_read_b64_tr_b16 v[170:171], v26 offset:2048
  ds_read_b64_tr_b16 v[172:173], v27 offset:0
  ds_read_b64_tr_b16 v[174:175], v27 offset:2048
  ds_read_b64_tr_b16 v[176:177], v24 offset:4096
  ds_read_b64_tr_b16 v[178:179], v24 offset:6144
  ds_read_b64_tr_b16 v[180:181], v25 offset:4096
  ds_read_b64_tr_b16 v[182:183], v25 offset:6144
  ds_read_b64_tr_b16 v[184:185], v26 offset:4096
  ds_read_b64_tr_b16 v[186:187], v26 offset:6144
  ds_read_b64_tr_b16 v[188:189], v27 offset:4096
  v_add_f32 v34, v34, v48
  v_add_f32 v35, v35, v64
  v_add_f32 v34, v34, v49
  v_add_f32 v35, v35, v65
  v_add_f32 v34, v34, v50
  v_add_f32 v35, v35, v66
  v_add_f32 v34, v34, v51
  v_add_f32 v35, v35, v67
  s_waitcnt lgkmcnt(13)
  ds_read_b64_tr_b16 v[190:191], v27 offset:6144
  v_mfma_f32_32x32x16_bf16 a[0:15], v[160:163], v[112:115], a[0:15]
  v_add_f32 v34, v34, v52
  v_add_f32 v35, v35, v68
  v_mfma_f32_32x32x16_bf16 a[16:31], v[160:163], v[120:123], a[16:31]
  v_add_f32 v34, v34, v53
  v_add_f32 v35, v35, v69
  v_add_f32 v34, v34, v54
  s_waitcnt lgkmcnt(12)
  v_mfma_f32_32x32x16_bf16 a[32:47], v[164:167], v[112:115], a[32:47]
  v_add_f32 v35, v35, v70
  v_add_f32 v34, v34, v55
  v_mfma_f32_32x32x16_bf16 a[48:63], v[164:167], v[120:123], a[48:63]
  v_add_f32 v35, v35, v71
  v_add_f32 v34, v34, v56
  s_waitcnt lgkmcnt(10)
  v_mfma_f32_32x32x16_bf16 a[64:79], v[168:171], v[112:115], a[64:79]
  v_add_f32 v35, v35, v72
  v_add_f32 v34, v34, v57
  v_mfma_f32_32x32x16_bf16 a[80:95], v[168:171], v[120:123], a[80:95]
  v_add_f32 v35, v35, v73
  v_add_f32 v34, v34, v58
  v_add_f32 v35, v35, v74
  s_waitcnt lgkmcnt(0)
  v_mfma_f32_32x32x16_bf16 a[96:111], v[172:175], v[112:115], a[96:111]
  v_add_f32 v34, v34, v59
  v_add_f32 v35, v35, v75
  v_mfma_f32_32x32x16_bf16 a[112:127], v[172:175], v[120:123], a[112:127]
  v_add_f32 v34, v34, v60
  v_add_f32 v35, v35, v76
  v_add_f32 v34, v34, v61
  v_add_f32 v35, v35, v77
  v_add_f32 v34, v34, v62
  v_add_f32 v35, v35, v78
  v_mfma_f32_32x32x16_bf16 a[0:15], v[176:179], v[116:119], a[0:15]
  v_add_f32 v34, v34, v63
  v_add_f32 v35, v35, v79
  v_fma_f32 v80, v80, s65, -v30
  v_fma_f32 v81, v81, s65, -v30
  v_fma_f32 v82, v82, s65, -v30
  v_fma_f32 v83, v83, s65, -v30
  v_mfma_f32_32x32x16_bf16 a[16:31], v[176:179], v[124:127], a[16:31]
  v_fma_f32 v84, v84, s65, -v30
  v_fma_f32 v85, v85, s65, -v30
  v_fma_f32 v86, v86, s65, -v30
  v_fma_f32 v87, v87, s65, -v30
  v_fma_f32 v88, v88, s65, -v30
  v_fma_f32 v89, v89, s65, -v30
  v_fma_f32 v90, v90, s65, -v30
  v_mfma_f32_32x32x16_bf16 a[32:47], v[180:183], v[116:119], a[32:47]
  v_fma_f32 v91, v91, s65, -v30
  v_fma_f32 v92, v92, s65, -v30
  v_fma_f32 v93, v93, s65, -v30
  v_fma_f32 v94, v94, s65, -v30
  v_fma_f32 v95, v95, s65, -v30
  v_fma_f32 v96, v96, s65, -v31
  v_mfma_f32_32x32x16_bf16 a[48:63], v[180:183], v[124:127], a[48:63]
  v_fma_f32 v97, v97, s65, -v31
  v_fma_f32 v98, v98, s65, -v31
  v_fma_f32 v99, v99, s65, -v31
  v_fma_f32 v100, v100, s65, -v31
  v_fma_f32 v101, v101, s65, -v31
  v_fma_f32 v102, v102, s65, -v31
  v_mfma_f32_32x32x16_bf16 a[64:79], v[184:187], v[116:119], a[64:79]
  v_fma_f32 v103, v103, s65, -v31
  v_fma_f32 v104, v104, s65, -v31
  v_fma_f32 v105, v105, s65, -v31
  v_fma_f32 v106, v106, s65, -v31
  v_fma_f32 v107, v107, s65, -v31
  v_fma_f32 v108, v108, s65, -v31
  v_mfma_f32_32x32x16_bf16 a[80:95], v[184:187], v[124:127], a[80:95]
  v_fma_f32 v109, v109, s65, -v31
  v_fma_f32 v110, v110, s65, -v31
  v_fma_f32 v111, v111, s65, -v31
  v_max3_f32 v36, v80, v81, v82
  v_max3_f32 v36, v36, v83, v84
  v_max3_f32 v36, v36, v85, v86
  v_max3_f32 v36, v36, v87, v88
  v_mfma_f32_32x32x16_bf16 a[96:111], v[188:191], v[116:119], a[96:111]
  v_max3_f32 v36, v36, v89, v90
  v_max3_f32 v36, v36, v91, v92
  v_max3_f32 v36, v36, v93, v94
  v_max_f32 v36, v36, v95
  v_max3_f32 v37, v96, v97, v98
  v_max3_f32 v37, v37, v99, v100
  v_mfma_f32_32x32x16_bf16 a[112:127], v[188:191], v[124:127], a[112:127]
  v_max3_f32 v37, v37, v101, v102
  v_max3_f32 v37, v37, v103, v104
  v_max3_f32 v37, v37, v105, v106
  v_max3_f32 v37, v37, v107, v108
  v_max3_f32 v37, v37, v109, v110
  v_max_f32 v37, v37, v111
  v_cmp_lt_f32 vcc, s66, v36
  v_cmp_lt_f32 s[60:61], s66, v37
  s_or_b64 s[60:61], s[60:61], vcc
  s_cbranch_scc1 L1_rareT0P
L1_backT0P:
  s_barrier
  v_exp_f32 v80, v80
  v_exp_f32 v81, v81
  v_exp_f32 v82, v82
  v_exp_f32 v83, v83
  v_cvt_pk_bf16_f32 v112, v80, v81
  v_exp_f32 v84, v84
  v_exp_f32 v85, v85
  v_cvt_pk_bf16_f32 v113, v82, v83
  v_exp_f32 v86, v86
  v_exp_f32 v87, v87
  v_cvt_pk_bf16_f32 v114, v84, v85
  v_exp_f32 v88, v88
  v_exp_f32 v89, v89
  v_cvt_pk_bf16_f32 v115, v86, v87
  v_exp_f32 v90, v90
  v_exp_f32 v91, v91
  v_cvt_pk_bf16_f32 v116, v88, v89
  v_exp_f32 v92, v92
  v_exp_f32 v93, v93
  v_cvt_pk_bf16_f32 v117, v90, v91
  v_exp_f32 v94, v94
  v_exp_f32 v95, v95
  v_cvt_pk_bf16_f32 v118, v92, v93
  v_exp_f32 v96, v96
  v_exp_f32 v97, v97
  v_cvt_pk_bf16_f32 v119, v94, v95
  v_exp_f32 v98, v98
  v_exp_f32 v99, v99
  v_cvt_pk_bf16_f32 v120, v96, v97
  v_exp_f32 v100, v100
  v_exp_f32 v101, v101
  v_cvt_pk_bf16_f32 v121, v98, v99
  v_exp_f32 v102, v102
  v_exp_f32 v103, v103
  v_cvt_pk_bf16_f32 v122, v100, v101
  v_exp_f32 v104, v104
  v_exp_f32 v105, v105
  v_cvt_pk_bf16_f32 v123, v102, v103
  v_exp_f32 v106, v106
  v_exp_f32 v107, v107
  v_cvt_pk_bf16_f32 v124, v104, v105
  v_exp_f32 v108, v108
  v_exp_f32 v109, v109
  v_cvt_pk_bf16_f32 v125, v106, v107
  v_exp_f32 v110, v110
  v_exp_f32 v111, v111
  v_cvt_pk_bf16_f32 v126, v108, v109
  s_nop 0
  v_cvt_pk_bf16_f32 v127, v110, v111
  v_add_f32 v34, v34, v80
  v_add_f32 v35, v35, v96
  v_add_f32 v34, v34, v81
  v_add_f32 v35, v35, v97
  v_add_f32 v34, v34, v82
  v_add_f32 v35, v35, v98
  v_add_f32 v34, v34, v83
  v_add_f32 v35, v35, v99
  v_add_f32 v34, v34, v84
  v_add_f32 v35, v35, v100
  v_add_f32 v34, v34, v85
  v_add_f32 v35, v35, v101
  v_add_f32 v34, v34, v86
  v_add_f32 v35, v35, v102
  v_add_f32 v34, v34, v87
  v_add_f32 v35, v35, v103
  v_add_f32 v34, v34, v88
  v_add_f32 v35, v35, v104
  v_add_f32 v34, v34, v89
  v_add_f32 v35, v35, v105
  v_add_f32 v34, v34, v90
  v_add_f32 v35, v35, v106
  v_add_f32 v34, v34, v91
  v_add_f32 v35, v35, v107
  v_add_f32 v34, v34, v92
  v_add_f32 v35, v35, v108
  v_add_f32 v34, v34, v93
  v_add_f32 v35, v35, v109
  v_add_f32 v34, v34, v94
  v_add_f32 v35, v35, v110
  v_add_f32 v34, v34, v95
  v_add_f32 v35, v35, v111
  v_mov_b32 v38, v34
  v_mov_b32 v39, v35
  v_mov_b32 v40, v30
  v_mov_b32 v41, v31
  s_lshl_b32 s29, s20, 9
  s_add_u32 s29, s29, 147456
  v_permlane32_swap_b32 v38, v39
  v_permlane32_swap_b32 v40, v41
  v_add_f32 v41, v38, v39
  v_lshlrev_b32 v2, 3, v1
  v_add_u32 v3, s29, v2
  ds_write_b64 v3, v[40:41]
  v_and_b32 v2, 31, v1
  v_lshlrev_b32 v2, 3, v2
  v_lshlrev_b32 v3, 4, v1
  s_sub_u32 s29, s20, 0
  s_and_b32 s29, s29, 3
  s_lshl_b32 s30, s29, 9
  s_add_u32 s30, s30, 147456
  v_add_u32 v42, s30, v2
  s_sub_u32 s29, s20, 1
  s_and_b32 s29, s29, 3
  s_lshl_b32 s30, s29, 9
  s_add_u32 s30, s30, 147456
  v_add_u32 v43, s30, v2
  s_lshl_b32 s30, s29, 13
  s_add_u32 s30, s30, 32768
  v_add_u32 v46, s30, v3
  s_sub_u32 s29, s20, 2
  s_and_b32 s29, s29, 3
  s_lshl_b32 s30, s29, 9
  s_add_u32 s30, s30, 147456
  v_add_u32 v44, s30, v2
  s_lshl_b32 s30, s29, 13
  s_add_u32 s30, s30, 65536
  v_add_u32 v47, s30, v3
  s_sub_u32 s29, s20, 3
  s_and_b32 s29, s29, 3
  s_lshl_b32 s30, s29, 9
  s_add_u32 s30, s30, 147456
  v_add_u32 v45, s30, v2
  s_lshl_b32 s30, s29, 13
  s_add_u32 s30, s30, 98304
  v_add_u32 v6, s30, v3
  v_add_u32 v4, 0x10000, v15
  s_waitcnt vmcnt(0)
  ds_read_b64_tr_b16 v[164:165], v25 offset:32768
  ds_read_b64_tr_b16 v[166:167], v25 offset:34816
  ds_read_b64_tr_b16 v[180:181], v25 offset:36864
  ds_read_b64_tr_b16 v[182:183], v25 offset:38912
  ds_read_b64_tr_b16 v[168:169], v26 offset:32768
  ds_read_b64_tr_b16 v[170:171], v26 offset:34816
  ds_read_b64_tr_b16 v[184:185], v26 offset:36864
  ds_read_b64_tr_b16 v[186:187], v26 offset:38912
  ds_read_b64_tr_b16 v[172:173], v27 offset:32768
  ds_read_b64_tr_b16 v[174:175], v27 offset:34816
  ds_read_b64_tr_b16 v[188:189], v27 offset:36864
  ds_read_b64_tr_b16 v[190:191], v27 offset:38912
  ds_read_b64_tr_b16 v[160:161], v24 offset:32768
  ds_read_b64_tr_b16 v[162:163], v24 offset:34816
  s_waitcnt lgkmcnt(10)
  ds_read_b64_tr_b16 v[176:177], v24 offset:36864
  ds_read_b64_tr_b16 v[178:179], v24 offset:38912
  v_mfma_f32_32x32x16_bf16 a[32:47], v[164:167], v[112:115], a[32:47]
  v_mfma_f32_32x32x16_bf16 a[32:47], v[180:183], v[116:119], a[32:47]
  v_mfma_f32_32x32x16_bf16 a[48:63], v[164:167], v[120:123], a[48:63]
  v_mfma_f32_32x32x16_bf16 a[48:63], v[180:183], v[124:127], a[48:63]
  s_waitcnt lgkmcnt(8)
  v_mfma_f32_32x32x16_bf16 a[64:79], v[168:171], v[112:115], a[64:79]
  v_mfma_f32_32x32x16_bf16 a[64:79], v[184:187], v[116:119], a[64:79]
  s_nop 5
  v_mfma_f32_32x32x16_bf16 a[80:95], v[168:171], v[120:123], a[80:95]
  v_mfma_f32_32x32x16_bf16 a[80:95], v[184:187], v[124:127], a[80:95]
  ds_write_b128 v15, a[32:35] offset:32768
  ds_write_b128 v15, a[36:39] offset:33792
  ds_write_b128 v15, a[40:43] offset:34816
  ds_write_b128 v15, a[44:47] offset:35840
  s_waitcnt lgkmcnt(8)
  v_mfma_f32_32x32x16_bf16 a[96:111], v[172:175], v[112:115], a[96:111]
  v_mfma_f32_32x32x16_bf16 a[96:111], v[188:191], v[116:119], a[96:111]
  ds_write_b128 v15, a[48:51] offset:36864
  ds_write_b128 v15, a[52:55] offset:37888
  ds_write_b128 v15, a[56:59] offset:38912
  ds_write_b128 v15, a[60:63] offset:39936
  v_mfma_f32_32x32x16_bf16 a[112:127], v[172:175], v[120:123], a[112:127]
  v_mfma_f32_32x32x16_bf16 a[112:127], v[188:191], v[124:127], a[112:127]
  ds_write_b128 v4, a[64:67] offset:0
  ds_write_b128 v4, a[68:71] offset:1024
  ds_write_b128 v4, a[72:75] offset:2048
  s_waitcnt lgkmcnt(8)
  ds_write_b128 v4, a[76:79] offset:3072
  v_mfma_f32_32x32x16_bf16 a[0:15], v[160:163], v[112:115], a[0:15]
  v_mfma_f32_32x32x16_bf16 a[0:15], v[176:179], v[116:119], a[0:15]
  ds_write_b128 v4, a[80:83] offset:4096
  ds_write_b128 v4, a[84:87] offset:5120
  ds_write_b128 v4, a[88:91] offset:6144
  ds_write_b128 v4, a[92:95] offset:7168
  v_mfma_f32_32x32x16_bf16 a[16:31], v[160:163], v[120:123], a[16:31]
  v_mfma_f32_32x32x16_bf16 a[16:31], v[176:179], v[124:127], a[16:31]
  ds_write_b128 v4, a[96:99] offset:32768
  ds_write_b128 v4, a[100:103] offset:33792
  s_waitcnt lgkmcnt(8)
  ds_write_b128 v4, a[104:107] offset:34816
  ds_write_b128 v4, a[108:111] offset:35840
  ds_write_b128 v4, a[112:115] offset:36864
  ds_write_b128 v4, a[116:119] offset:37888
  ds_write_b128 v4, a[120:123] offset:38912
  ds_write_b128 v4, a[124:127] offset:39936
  s_nop 7
  v_accvgpr_read_b32 v64, a0
  v_accvgpr_read_b32 v65, a1
  v_accvgpr_read_b32 v66, a2
  v_accvgpr_read_b32 v67, a3
  v_accvgpr_read_b32 v68, a4
  v_accvgpr_read_b32 v69, a5
  v_accvgpr_read_b32 v70, a6
  v_accvgpr_read_b32 v71, a7
  v_accvgpr_read_b32 v72, a8
  v_accvgpr_read_b32 v73, a9
  v_accvgpr_read_b32 v74, a10
  v_accvgpr_read_b32 v75, a11
  v_accvgpr_read_b32 v76, a12
  v_accvgpr_read_b32 v77, a13
  v_accvgpr_read_b32 v78, a14
  v_accvgpr_read_b32 v79, a15
  v_accvgpr_read_b32 v80, a16
  v_accvgpr_read_b32 v81, a17
  v_accvgpr_read_b32 v82, a18
  v_accvgpr_read_b32 v83, a19
  v_accvgpr_read_b32 v84, a20
  v_accvgpr_read_b32 v85, a21
  v_accvgpr_read_b32 v86, a22
  v_accvgpr_read_b32 v87, a23
  v_accvgpr_read_b32 v88, a24
  v_accvgpr_read_b32 v89, a25
  v_accvgpr_read_b32 v90, a26
  v_accvgpr_read_b32 v91, a27
  v_accvgpr_read_b32 v92, a28
  v_accvgpr_read_b32 v93, a29
  v_accvgpr_read_b32 v94, a30
  v_accvgpr_read_b32 v95, a31
  s_waitcnt lgkmcnt(0)
  s_barrier
  ds_read_b64 v[200:201], v42 offset:0
  ds_read_b64 v[202:203], v42 offset:256
  ds_read_b64 v[204:205], v43 offset:0
  ds_read_b64 v[206:207], v43 offset:256
  ds_read_b64 v[208:209], v44 offset:0
  ds_read_b64 v[210:211], v44 offset:256
  ds_read_b64 v[212:213], v45 offset:0
  ds_read_b64 v[214:215], v45 offset:256
  ds_read_b128 v[96:99], v46 offset:0
  ds_read_b128 v[100:103], v46 offset:1024
  ds_read_b128 v[104:107], v46 offset:2048
  ds_read_b128 v[108:111], v46 offset:3072
  ds_read_b128 v[128:131], v47 offset:0
  ds_read_b128 v[132:135], v47 offset:1024
  ds_read_b128 v[136:139], v47 offset:2048
  s_waitcnt lgkmcnt(8)
  ds_read_b128 v[140:143], v47 offset:3072
  ds_read_b128 v[160:163], v6 offset:0
  ds_read_b128 v[164:167], v6 offset:1024
  ds_read_b128 v[168:171], v6 offset:2048
  ds_read_b128 v[172:175], v6 offset:3072
  ds_read_b128 v[112:115], v46 offset:4096
  ds_read_b128 v[116:119], v46 offset:5120
  s_waitcnt lgkmcnt(8)
  ds_read_b128 v[120:123], v46 offset:6144
  ds_read_b128 v[124:127], v46 offset:7168
  ds_read_b128 v[144:147], v47 offset:4096
  ds_read_b128 v[148:151], v47 offset:5120
  ds_read_b128 v[152:155], v47 offset:6144
  ds_read_b128 v[156:159], v47 offset:7168
  ds_read_b128 v[176:179], v6 offset:4096
  s_waitcnt lgkmcnt(8)
  ds_read_b128 v[180:183], v6 offset:5120
  ds_read_b128 v[184:187], v6 offset:6144
  ds_read_b128 v[188:191], v6 offset:7168
  v_max3_f32 v216, v200, v204, v208
  v_max_f32 v216, v216, v212
  v_max3_f32 v217, v202, v206, v210
  v_max_f32 v217, v217, v214
  v_sub_f32 v220, v200, v216
  v_sub_f32 v221, v202, v217
  v_sub_f32 v222, v204, v216
  v_sub_f32 v223, v206, v217
  v_sub_f32 v224, v208, v216
  v_sub_f32 v225, v210, v217
  v_sub_f32 v226, v212, v216
  v_sub_f32 v227, v214, v217
  v_exp_f32 v220, v220
  v_exp_f32 v221, v221
  v_exp_f32 v222, v222
  v_exp_f32 v223, v223
  v_exp_f32 v224, v224
  v_exp_f32 v225, v225
  v_exp_f32 v226, v226
  v_exp_f32 v227, v227
  v_mul_f32 v218, v220, v201
  v_mul_f32 v219, v221, v203
  v_fma_f32 v218, v222, v205, v218
  v_fma_f32 v219, v223, v207, v219
  v_fma_f32 v218, v224, v209, v218
  v_fma_f32 v219, v225, v211, v219
  v_fma_f32 v218, v226, v213, v218
  v_fma_f32 v219, v227, v215, v219
  v_rcp_f32 v218, v218
  v_rcp_f32 v219, v219
  s_nop 0
  v_mul_f32 v220, v220, v218
  v_mul_f32 v221, v221, v219
  v_mul_f32 v222, v222, v218
  v_mul_f32 v223, v223, v219
  v_mul_f32 v224, v224, v218
  v_mul_f32 v225, v225, v219
  v_mul_f32 v226, v226, v218
  v_mul_f32 v227, v227, v219
  v_bfe_u32 v2, v1, 4, 1
  v_lshlrev_b32 v2, 16, v2
  v_and_b32 v3, 15, v1
  v_lshl_add_u32 v2, v3, 4, v2
  v_lshrrev_b32 v3, 5, v1
  v_lshl_add_u32 v2, v3, 8, v2
  s_lshl_b32 s29, s23, 18
  s_lshl_b32 s30, s21, 1
  s_and_b32 s31, s24, 1
  s_add_u32 s30, s30, s31
  s_lshl_b32 s30, s30, 2
  s_add_u32 s30, s30, s20
  s_lshl_b32 s30, s30, 10
  s_add_u32 s29, s29, s30
  s_cmp_lt_u32 s24, 2
  s_cselect_b32 s30, 0x200000, 0
  s_add_u32 s29, s29, s30
  s_add_u32 s30, s29, 131072
  v_pk_mul_f32 v[64:65], v[220:221], v[64:65] op_sel:[0,0] op_sel_hi:[0,1]
  v_pk_mul_f32 v[66:67], v[220:221], v[66:67] op_sel:[0,0] op_sel_hi:[0,1]
  v_pk_mul_f32 v[68:69], v[220:221], v[68:69] op_sel:[0,0] op_sel_hi:[0,1]
  v_pk_mul_f32 v[70:71], v[220:221], v[70:71] op_sel:[0,0] op_sel_hi:[0,1]
  v_pk_mul_f32 v[72:73], v[220:221], v[72:73] op_sel:[0,0] op_sel_hi:[0,1]
  v_pk_mul_f32 v[74:75], v[220:221], v[74:75] op_sel:[0,0] op_sel_hi:[0,1]
  v_pk_mul_f32 v[76:77], v[220:221], v[76:77] op_sel:[0,0] op_sel_hi:[0,1]
  v_pk_mul_f32 v[78:79], v[220:221], v[78:79] op_sel:[0,0] op_sel_hi:[0,1]
  v_pk_fma_f32 v[64:65], v[222:223], v[96:97], v[64:65] op_sel:[0,0,0] op_sel_hi:[0,1,1]
  v_pk_fma_f32 v[66:67], v[222:223], v[98:99], v[66:67] op_sel:[0,0,0] op_sel_hi:[0,1,1]
  v_pk_fma_f32 v[68:69], v[222:223], v[100:101], v[68:69] op_sel:[0,0,0] op_sel_hi:[0,1,1]
  v_pk_fma_f32 v[70:71], v[222:223], v[102:103], v[70:71] op_sel:[0,0,0] op_sel_hi:[0,1,1]
  v_pk_fma_f32 v[72:73], v[222:223], v[104:105], v[72:73] op_sel:[0,0,0] op_sel_hi:[0,1,1]
  v_pk_fma_f32 v[74:75], v[222:223], v[106:107], v[74:75] op_sel:[0,0,0] op_sel_hi:[0,1,1]
  v_pk_fma_f32 v[76:77], v[222:223], v[108:109], v[76:77] op_sel:[0,0,0] op_sel_hi:[0,1,1]
  v_pk_fma_f32 v[78:79], v[222:223], v[110:111], v[78:79] op_sel:[0,0,0] op_sel_hi:[0,1,1]
  v_pk_fma_f32 v[64:65], v[224:225], v[128:129], v[64:65] op_sel:[0,0,0] op_sel_hi:[0,1,1]
  v_pk_fma_f32 v[66:67], v[224:225], v[130:131], v[66:67] op_sel:[0,0,0] op_sel_hi:[0,1,1]
  v_pk_fma_f32 v[68:69], v[224:225], v[132:133], v[68:69] op_sel:[0,0,0] op_sel_hi:[0,1,1]
  v_pk_fma_f32 v[70:71], v[224:225], v[134:135], v[70:71] op_sel:[0,0,0] op_sel_hi:[0,1,1]
  v_pk_fma_f32 v[72:73], v[224:225], v[136:137], v[72:73] op_sel:[0,0,0] op_sel_hi:[0,1,1]
  v_pk_fma_f32 v[74:75], v[224:225], v[138:139], v[74:75] op_sel:[0,0,0] op_sel_hi:[0,1,1]
  v_pk_fma_f32 v[76:77], v[224:225], v[140:141], v[76:77] op_sel:[0,0,0] op_sel_hi:[0,1,1]
  v_pk_fma_f32 v[78:79], v[224:225], v[142:143], v[78:79] op_sel:[0,0,0] op_sel_hi:[0,1,1]
  v_pk_fma_f32 v[64:65], v[226:227], v[160:161], v[64:65] op_sel:[0,0,0] op_sel_hi:[0,1,1]
  v_pk_fma_f32 v[66:67], v[226:227], v[162:163], v[66:67] op_sel:[0,0,0] op_sel_hi:[0,1,1]
  v_pk_fma_f32 v[68:69], v[226:227], v[164:165], v[68:69] op_sel:[0,0,0] op_sel_hi:[0,1,1]
  v_pk_fma_f32 v[70:71], v[226:227], v[166:167], v[70:71] op_sel:[0,0,0] op_sel_hi:[0,1,1]
  v_pk_fma_f32 v[72:73], v[226:227], v[168:169], v[72:73] op_sel:[0,0,0] op_sel_hi:[0,1,1]
  v_pk_fma_f32 v[74:75], v[226:227], v[170:171], v[74:75] op_sel:[0,0,0] op_sel_hi:[0,1,1]
  v_pk_fma_f32 v[76:77], v[226:227], v[172:173], v[76:77] op_sel:[0,0,0] op_sel_hi:[0,1,1]
  v_pk_fma_f32 v[78:79], v[226:227], v[174:175], v[78:79] op_sel:[0,0,0] op_sel_hi:[0,1,1]
  v_cvt_pk_bf16_f32 v232, v64, v65
  v_cvt_pk_bf16_f32 v233, v66, v67
  v_cvt_pk_bf16_f32 v234, v72, v73
  v_cvt_pk_bf16_f32 v235, v74, v75
  v_cvt_pk_bf16_f32 v236, v68, v69
  v_cvt_pk_bf16_f32 v237, v70, v71
  v_cvt_pk_bf16_f32 v238, v76, v77
  v_cvt_pk_bf16_f32 v239, v78, v79
  buffer_store_dwordx4 v[232:235], v2, s[48:51], s29 offen offset:0 sc1
  buffer_store_dwordx4 v[236:239], v2, s[48:51], s29 offen offset:512 sc1
  s_waitcnt lgkmcnt(0)
  v_pk_mul_f32 v[80:81], v[220:221], v[80:81] op_sel:[1,0] op_sel_hi:[1,1]
  v_pk_mul_f32 v[82:83], v[220:221], v[82:83] op_sel:[1,0] op_sel_hi:[1,1]
  v_pk_mul_f32 v[84:85], v[220:221], v[84:85] op_sel:[1,0] op_sel_hi:[1,1]
  v_pk_mul_f32 v[86:87], v[220:221], v[86:87] op_sel:[1,0] op_sel_hi:[1,1]
  v_pk_mul_f32 v[88:89], v[220:221], v[88:89] op_sel:[1,0] op_sel_hi:[1,1]
  v_pk_mul_f32 v[90:91], v[220:221], v[90:91] op_sel:[1,0] op_sel_hi:[1,1]
  v_pk_mul_f32 v[92:93], v[220:221], v[92:93] op_sel:[1,0] op_sel_hi:[1,1]
  v_pk_mul_f32 v[94:95], v[220:221], v[94:95] op_sel:[1,0] op_sel_hi:[1,1]
  v_pk_fma_f32 v[80:81], v[222:223], v[112:113], v[80:81] op_sel:[1,0,0] op_sel_hi:[1,1,1]
  v_pk_fma_f32 v[82:83], v[222:223], v[114:115], v[82:83] op_sel:[1,0,0] op_sel_hi:[1,1,1]
  v_pk_fma_f32 v[84:85], v[222:223], v[116:117], v[84:85] op_sel:[1,0,0] op_sel_hi:[1,1,1]
  v_pk_fma_f32 v[86:87], v[222:223], v[118:119], v[86:87] op_sel:[1,0,0] op_sel_hi:[1,1,1]
  v_pk_fma_f32 v[88:89], v[222:223], v[120:121], v[88:89] op_sel:[1,0,0] op_sel_hi:[1,1,1]
  v_pk_fma_f32 v[90:91], v[222:223], v[122:123], v[90:91] op_sel:[1,0,0] op_sel_hi:[1,1,1]
  v_pk_fma_f32 v[92:93], v[222:223], v[124:125], v[92:93] op_sel:[1,0,0] op_sel_hi:[1,1,1]
  v_pk_fma_f32 v[94:95], v[222:223], v[126:127], v[94:95] op_sel:[1,0,0] op_sel_hi:[1,1,1]
  v_pk_fma_f32 v[80:81], v[224:225], v[144:145], v[80:81] op_sel:[1,0,0] op_sel_hi:[1,1,1]
  v_pk_fma_f32 v[82:83], v[224:225], v[146:147], v[82:83] op_sel:[1,0,0] op_sel_hi:[1,1,1]
  v_pk_fma_f32 v[84:85], v[224:225], v[148:149], v[84:85] op_sel:[1,0,0] op_sel_hi:[1,1,1]
  v_pk_fma_f32 v[86:87], v[224:225], v[150:151], v[86:87] op_sel:[1,0,0] op_sel_hi:[1,1,1]
  v_pk_fma_f32 v[88:89], v[224:225], v[152:153], v[88:89] op_sel:[1,0,0] op_sel_hi:[1,1,1]
  v_pk_fma_f32 v[90:91], v[224:225], v[154:155], v[90:91] op_sel:[1,0,0] op_sel_hi:[1,1,1]
  v_pk_fma_f32 v[92:93], v[224:225], v[156:157], v[92:93] op_sel:[1,0,0] op_sel_hi:[1,1,1]
  v_pk_fma_f32 v[94:95], v[224:225], v[158:159], v[94:95] op_sel:[1,0,0] op_sel_hi:[1,1,1]
  v_pk_fma_f32 v[80:81], v[226:227], v[176:177], v[80:81] op_sel:[1,0,0] op_sel_hi:[1,1,1]
  v_pk_fma_f32 v[82:83], v[226:227], v[178:179], v[82:83] op_sel:[1,0,0] op_sel_hi:[1,1,1]
  v_pk_fma_f32 v[84:85], v[226:227], v[180:181], v[84:85] op_sel:[1,0,0] op_sel_hi:[1,1,1]
  v_pk_fma_f32 v[86:87], v[226:227], v[182:183], v[86:87] op_sel:[1,0,0] op_sel_hi:[1,1,1]
  v_pk_fma_f32 v[88:89], v[226:227], v[184:185], v[88:89] op_sel:[1,0,0] op_sel_hi:[1,1,1]
  v_pk_fma_f32 v[90:91], v[226:227], v[186:187], v[90:91] op_sel:[1,0,0] op_sel_hi:[1,1,1]
  v_pk_fma_f32 v[92:93], v[226:227], v[188:189], v[92:93] op_sel:[1,0,0] op_sel_hi:[1,1,1]
  v_pk_fma_f32 v[94:95], v[226:227], v[190:191], v[94:95] op_sel:[1,0,0] op_sel_hi:[1,1,1]
  v_cvt_pk_bf16_f32 v240, v80, v81
  v_cvt_pk_bf16_f32 v241, v82, v83
  v_cvt_pk_bf16_f32 v242, v88, v89
  v_cvt_pk_bf16_f32 v243, v90, v91
  v_cvt_pk_bf16_f32 v244, v84, v85
  v_cvt_pk_bf16_f32 v245, v86, v87
  v_cvt_pk_bf16_f32 v246, v92, v93
  v_cvt_pk_bf16_f32 v247, v94, v95
  buffer_store_dwordx4 v[240:243], v2, s[48:51], s30 offen offset:0 sc1
  buffer_store_dwordx4 v[244:247], v2, s[48:51], s30 offen offset:512 sc1
  s_lshl_b32 s29, s23, 5
  s_add_u32 s29, s29, s25
  s_lshl_b32 s29, s29, 7
  s_add_u32 s29, s29, 0x400000
  v_lshlrev_b32 v31, 24, v1
  v_mov_b32 v10, v192
  v_mov_b32 v16, v196
  v_mov_b32 v20, v248
  v_mov_b32 v24, v228
  v_mov_b32 v11, v193
  v_mov_b32 v17, v197
  v_mov_b32 v21, v249
  v_mov_b32 v25, v229
  v_mov_b32 v12, v194
  v_mov_b32 v18, v198
  v_mov_b32 v22, v250
  v_mov_b32 v26, v230
  v_mov_b32 v13, v195
  v_mov_b32 v19, v199
  v_mov_b32 v23, v251
  v_mov_b32 v27, v231
  v_lshlrev_b32 v14, 4, v1
  s_mov_b32 s32, s14
  s_mov_b32 s33, s15
  s_mov_b32 s34, 589824
  s_lshr_b32 s66, s84, 1
  s_lshl_b32 s66, s66, 5
  s_lshl_b32 s67, s20, 3
  s_add_u32 s66, s66, s67
  s_lshl_b32 s66, s66, 7
  s_add_u32 s66, s66, 0x400000
  v_and_b32 v34, 1, v1
  v_bfe_u32 v35, v1, 1, 1
  v_lshl_add_u32 v34, v35, 2, v34
  v_lshlrev_b32 v34, 7, v34
  s_waitcnt vmcnt(0)
  v_readfirstlane_b32 s64, v32
  s_cmp_eq_u32 s64, 0
  s_cbranch_scc1 LF_epspinP
LF_epokP:
  v_mov_b32 v30, s64
  s_barrier
  s_cmp_lg_u32 s20, 0
  s_cbranch_scc1 LF_nosigP
  buffer_store_dword v30, v31, s[48:51], s29 offen sc1
LF_nosigP:
  s_branch L1_fin
L1_codeend:
LF_spinE:
  s_mov_b32 s68, 0x200000
LF_spinE2:
  s_sleep 4
  buffer_load_dword v33, v34, s[48:51], s66 offen offset:256 sc1
  s_waitcnt vmcnt(0)
  v_cmp_ne_u32 vcc, s64, v33
  s_cmp_eq_u64 vcc, 0
  s_cbranch_scc1 LF_goE
  s_sub_u32 s68, s68, 1
  s_cmp_lg_u32 s68, 0
  s_cbranch_scc1 LF_spinE2
  s_branch LF_goE
LF_spinL:
  s_mov_b32 s68, 0x200000
LF_spinL2:
  s_sleep 4
  buffer_load_dword v33, v34, s[48:51], s66 offen offset:0 sc1
  s_waitcnt vmcnt(0)
  v_cmp_ne_u32 vcc, s64, v33
  s_cmp_eq_u64 vcc, 0
  s_cbranch_scc1 LF_goL
  s_sub_u32 s68, s68, 1
  s_cmp_lg_u32 s68, 0
  s_cbranch_scc1 LF_spinL2
  s_branch LF_goL
LF_epspinP:
  s_mov_b32 s68, 0x200000
  v_mov_b32 v33, 0
LF_epspin2P:
  s_sleep 8
  buffer_load_dword v32, v33, s[40:43], 0 offen sc1
  s_waitcnt vmcnt(0)
  v_readfirstlane_b32 s64, v32
  s_cmp_lg_u32 s64, 0
  s_cbranch_scc1 LF_epokP
  s_sub_u32 s68, s68, 1
  s_cmp_lg_u32 s68, 0
  s_cbranch_scc1 LF_epspin2P
  s_branch LF_epokP
LF_epspinC:
  s_mov_b32 s68, 0x200000
  v_mov_b32 v33, 0
LF_epspin2C:
  s_sleep 8
  buffer_load_dword v32, v33, s[40:43], 0 offen sc1
  s_waitcnt vmcnt(0)
  v_readfirstlane_b32 s64, v32
  s_cmp_lg_u32 s64, 0
  s_cbranch_scc1 LF_epokC
  s_sub_u32 s68, s68, 1
  s_cmp_lg_u32 s68, 0
  s_cbranch_scc1 LF_epspin2C
  s_branch LF_epokC
L1_rareS0:
  v_mov_b32 v38, v36
  v_mov_b32 v39, v37
  s_nop 1
  v_permlane32_swap_b32 v38, v39
  v_max_f32 v38, v38, v39
  v_mov_b32 v39, v38
  s_nop 1
  v_permlane32_swap_b32 v38, v39
  v_max_f32 v38, 0, v38
  v_sub_f32 v40, 0, v38
  v_exp_f32 v40, v40
  v_add_f32 v30, v30, v38
  v_mul_f32 v34, v34, v40
  v_max_f32 v39, 0, v39
  v_sub_f32 v41, 0, v39
  v_exp_f32 v41, v41
  v_add_f32 v31, v31, v39
  v_mul_f32 v35, v35, v41
  v_sub_f32 v80, v80, v38
  v_sub_f32 v81, v81, v38
  v_sub_f32 v82, v82, v38
  v_sub_f32 v83, v83, v38
  v_sub_f32 v84, v84, v38
  v_sub_f32 v85, v85, v38
  v_sub_f32 v86, v86, v38
  v_sub_f32 v87, v87, v38
  v_sub_f32 v88, v88, v38
  v_sub_f32 v89, v89, v38
  v_sub_f32 v90, v90, v38
  v_sub_f32 v91, v91, v38
  v_sub_f32 v92, v92, v38
  v_sub_f32 v93, v93, v38
  v_sub_f32 v94, v94, v38
  v_sub_f32 v95, v95, v38
  v_sub_f32 v96, v96, v39
  v_sub_f32 v97, v97, v39
  v_sub_f32 v98, v98, v39
  v_sub_f32 v99, v99, v39
  v_sub_f32 v100, v100, v39
  v_sub_f32 v101, v101, v39
  v_sub_f32 v102, v102, v39
  v_sub_f32 v103, v103, v39
  v_sub_f32 v104, v104, v39
  v_sub_f32 v105, v105, v39
  v_sub_f32 v106, v106, v39
  v_sub_f32 v107, v107, v39
  v_sub_f32 v108, v108, v39
  v_sub_f32 v109, v109, v39
  v_sub_f32 v110, v110, v39
  v_sub_f32 v111, v111, v39
  v_accvgpr_read_b32 v42, a0
  v_accvgpr_read_b32 v43, a1
  v_accvgpr_read_b32 v44, a2
  v_accvgpr_read_b32 v45, a3
  v_mul_f32 v42, v40, v42
  v_mul_f32 v43, v40, v43
  v_mul_f32 v44, v40, v44
  v_mul_f32 v45, v40, v45
  v_accvgpr_write_b32 a0, v42
  v_accvgpr_write_b32 a1, v43
  v_accvgpr_write_b32 a2, v44
  v_accvgpr_write_b32 a3, v45
  v_accvgpr_read_b32 v42, a4
  v_accvgpr_read_b32 v43, a5
  v_accvgpr_read_b32 v44, a6
  v_accvgpr_read_b32 v45, a7
  v_mul_f32 v42, v40, v42
  v_mul_f32 v43, v40, v43
  v_mul_f32 v44, v40, v44
  v_mul_f32 v45, v40, v45
  v_accvgpr_write_b32 a4, v42
  v_accvgpr_write_b32 a5, v43
  v_accvgpr_write_b32 a6, v44
  v_accvgpr_write_b32 a7, v45
  v_accvgpr_read_b32 v42, a8
  v_accvgpr_read_b32 v43, a9
  v_accvgpr_read_b32 v44, a10
  v_accvgpr_read_b32 v45, a11
  v_mul_f32 v42, v40, v42
  v_mul_f32 v43, v40, v43
  v_mul_f32 v44, v40, v44
  v_mul_f32 v45, v40, v45
  v_accvgpr_write_b32 a8, v42
  v_accvgpr_write_b32 a9, v43
  v_accvgpr_write_b32 a10, v44
  v_accvgpr_write_b32 a11, v45
  v_accvgpr_read_b32 v42, a12
  v_accvgpr_read_b32 v43, a13
  v_accvgpr_read_b32 v44, a14
  v_accvgpr_read_b32 v45, a15
  v_mul_f32 v42, v40, v42
  v_mul_f32 v43, v40, v43
  v_mul_f32 v44, v40, v44
  v_mul_f32 v45, v40, v45
  v_accvgpr_write_b32 a12, v42
  v_accvgpr_write_b32 a13, v43
  v_accvgpr_write_b32 a14, v44
  v_accvgpr_write_b32 a15, v45
  v_accvgpr_read_b32 v42, a16
  v_accvgpr_read_b32 v43, a17
  v_accvgpr_read_b32 v44, a18
  v_accvgpr_read_b32 v45, a19
  v_mul_f32 v42, v41, v42
  v_mul_f32 v43, v41, v43
  v_mul_f32 v44, v41, v44
  v_mul_f32 v45, v41, v45
  v_accvgpr_write_b32 a16, v42
  v_accvgpr_write_b32 a17, v43
  v_accvgpr_write_b32 a18, v44
  v_accvgpr_write_b32 a19, v45
  v_accvgpr_read_b32 v42, a20
  v_accvgpr_read_b32 v43, a21
  v_accvgpr_read_b32 v44, a22
  v_accvgpr_read_b32 v45, a23
  v_mul_f32 v42, v41, v42
  v_mul_f32 v43, v41, v43
  v_mul_f32 v44, v41, v44
  v_mul_f32 v45, v41, v45
  v_accvgpr_write_b32 a20, v42
  v_accvgpr_write_b32 a21, v43
  v_accvgpr_write_b32 a22, v44
  v_accvgpr_write_b32 a23, v45
  v_accvgpr_read_b32 v42, a24
  v_accvgpr_read_b32 v43, a25
  v_accvgpr_read_b32 v44, a26
  v_accvgpr_read_b32 v45, a27
  v_mul_f32 v42, v41, v42
  v_mul_f32 v43, v41, v43
  v_mul_f32 v44, v41, v44
  v_mul_f32 v45, v41, v45
  v_accvgpr_write_b32 a24, v42
  v_accvgpr_write_b32 a25, v43
  v_accvgpr_write_b32 a26, v44
  v_accvgpr_write_b32 a27, v45
  v_accvgpr_read_b32 v42, a28
  v_accvgpr_read_b32 v43, a29
  v_accvgpr_read_b32 v44, a30
  v_accvgpr_read_b32 v45, a31
  v_mul_f32 v42, v41, v42
  v_mul_f32 v43, v41, v43
  v_mul_f32 v44, v41, v44
  v_mul_f32 v45, v41, v45
  v_accvgpr_write_b32 a28, v42
  v_accvgpr_write_b32 a29, v43
  v_accvgpr_write_b32 a30, v44
  v_accvgpr_write_b32 a31, v45
  v_accvgpr_read_b32 v42, a32
  v_accvgpr_read_b32 v43, a33
  v_accvgpr_read_b32 v44, a34
  v_accvgpr_read_b32 v45, a35
  v_mul_f32 v42, v40, v42
  v_mul_f32 v43, v40, v43
  v_mul_f32 v44, v40, v44
  v_mul_f32 v45, v40, v45
  v_accvgpr_write_b32 a32, v42
  v_accvgpr_write_b32 a33, v43
  v_accvgpr_write_b32 a34, v44
  v_accvgpr_write_b32 a35, v45
  v_accvgpr_read_b32 v42, a36
  v_accvgpr_read_b32 v43, a37
  v_accvgpr_read_b32 v44, a38
  v_accvgpr_read_b32 v45, a39
  v_mul_f32 v42, v40, v42
  v_mul_f32 v43, v40, v43
  v_mul_f32 v44, v40, v44
  v_mul_f32 v45, v40, v45
  v_accvgpr_write_b32 a36, v42
  v_accvgpr_write_b32 a37, v43
  v_accvgpr_write_b32 a38, v44
  v_accvgpr_write_b32 a39, v45
  v_accvgpr_read_b32 v42, a40
  v_accvgpr_read_b32 v43, a41
  v_accvgpr_read_b32 v44, a42
  v_accvgpr_read_b32 v45, a43
  v_mul_f32 v42, v40, v42
  v_mul_f32 v43, v40, v43
  v_mul_f32 v44, v40, v44
  v_mul_f32 v45, v40, v45
  v_accvgpr_write_b32 a40, v42
  v_accvgpr_write_b32 a41, v43
  v_accvgpr_write_b32 a42, v44
  v_accvgpr_write_b32 a43, v45
  v_accvgpr_read_b32 v42, a44
  v_accvgpr_read_b32 v43, a45
  v_accvgpr_read_b32 v44, a46
  v_accvgpr_read_b32 v45, a47
  v_mul_f32 v42, v40, v42
  v_mul_f32 v43, v40, v43
  v_mul_f32 v44, v40, v44
  v_mul_f32 v45, v40, v45
  v_accvgpr_write_b32 a44, v42
  v_accvgpr_write_b32 a45, v43
  v_accvgpr_write_b32 a46, v44
  v_accvgpr_write_b32 a47, v45
  v_accvgpr_read_b32 v42, a48
  v_accvgpr_read_b32 v43, a49
  v_accvgpr_read_b32 v44, a50
  v_accvgpr_read_b32 v45, a51
  v_mul_f32 v42, v41, v42
  v_mul_f32 v43, v41, v43
  v_mul_f32 v44, v41, v44
  v_mul_f32 v45, v41, v45
  v_accvgpr_write_b32 a48, v42
  v_accvgpr_write_b32 a49, v43
  v_accvgpr_write_b32 a50, v44
  v_accvgpr_write_b32 a51, v45
  v_accvgpr_read_b32 v42, a52
  v_accvgpr_read_b32 v43, a53
  v_accvgpr_read_b32 v44, a54
  v_accvgpr_read_b32 v45, a55
  v_mul_f32 v42, v41, v42
  v_mul_f32 v43, v41, v43
  v_mul_f32 v44, v41, v44
  v_mul_f32 v45, v41, v45
  v_accvgpr_write_b32 a52, v42
  v_accvgpr_write_b32 a53, v43
  v_accvgpr_write_b32 a54, v44
  v_accvgpr_write_b32 a55, v45
  v_accvgpr_read_b32 v42, a56
  v_accvgpr_read_b32 v43, a57
  v_accvgpr_read_b32 v44, a58
  v_accvgpr_read_b32 v45, a59
  v_mul_f32 v42, v41, v42
  v_mul_f32 v43, v41, v43
  v_mul_f32 v44, v41, v44
  v_mul_f32 v45, v41, v45
  v_accvgpr_write_b32 a56, v42
  v_accvgpr_write_b32 a57, v43
  v_accvgpr_write_b32 a58, v44
  v_accvgpr_write_b32 a59, v45
  v_accvgpr_read_b32 v42, a60
  v_accvgpr_read_b32 v43, a61
  v_accvgpr_read_b32 v44, a62
  v_accvgpr_read_b32 v45, a63
  v_mul_f32 v42, v41, v42
  v_mul_f32 v43, v41, v43
  v_mul_f32 v44, v41, v44
  v_mul_f32 v45, v41, v45
  v_accvgpr_write_b32 a60, v42
  v_accvgpr_write_b32 a61, v43
  v_accvgpr_write_b32 a62, v44
  v_accvgpr_write_b32 a63, v45
  v_accvgpr_read_b32 v42, a64
  v_accvgpr_read_b32 v43, a65
  v_accvgpr_read_b32 v44, a66
  v_accvgpr_read_b32 v45, a67
  v_mul_f32 v42, v40, v42
  v_mul_f32 v43, v40, v43
  v_mul_f32 v44, v40, v44
  v_mul_f32 v45, v40, v45
  v_accvgpr_write_b32 a64, v42
  v_accvgpr_write_b32 a65, v43
  v_accvgpr_write_b32 a66, v44
  v_accvgpr_write_b32 a67, v45
  v_accvgpr_read_b32 v42, a68
  v_accvgpr_read_b32 v43, a69
  v_accvgpr_read_b32 v44, a70
  v_accvgpr_read_b32 v45, a71
  v_mul_f32 v42, v40, v42
  v_mul_f32 v43, v40, v43
  v_mul_f32 v44, v40, v44
  v_mul_f32 v45, v40, v45
  v_accvgpr_write_b32 a68, v42
  v_accvgpr_write_b32 a69, v43
  v_accvgpr_write_b32 a70, v44
  v_accvgpr_write_b32 a71, v45
  v_accvgpr_read_b32 v42, a72
  v_accvgpr_read_b32 v43, a73
  v_accvgpr_read_b32 v44, a74
  v_accvgpr_read_b32 v45, a75
  v_mul_f32 v42, v40, v42
  v_mul_f32 v43, v40, v43
  v_mul_f32 v44, v40, v44
  v_mul_f32 v45, v40, v45
  v_accvgpr_write_b32 a72, v42
  v_accvgpr_write_b32 a73, v43
  v_accvgpr_write_b32 a74, v44
  v_accvgpr_write_b32 a75, v45
  v_accvgpr_read_b32 v42, a76
  v_accvgpr_read_b32 v43, a77
  v_accvgpr_read_b32 v44, a78
  v_accvgpr_read_b32 v45, a79
  v_mul_f32 v42, v40, v42
  v_mul_f32 v43, v40, v43
  v_mul_f32 v44, v40, v44
  v_mul_f32 v45, v40, v45
  v_accvgpr_write_b32 a76, v42
  v_accvgpr_write_b32 a77, v43
  v_accvgpr_write_b32 a78, v44
  v_accvgpr_write_b32 a79, v45
  v_accvgpr_read_b32 v42, a80
  v_accvgpr_read_b32 v43, a81
  v_accvgpr_read_b32 v44, a82
  v_accvgpr_read_b32 v45, a83
  v_mul_f32 v42, v41, v42
  v_mul_f32 v43, v41, v43
  v_mul_f32 v44, v41, v44
  v_mul_f32 v45, v41, v45
  v_accvgpr_write_b32 a80, v42
  v_accvgpr_write_b32 a81, v43
  v_accvgpr_write_b32 a82, v44
  v_accvgpr_write_b32 a83, v45
  v_accvgpr_read_b32 v42, a84
  v_accvgpr_read_b32 v43, a85
  v_accvgpr_read_b32 v44, a86
  v_accvgpr_read_b32 v45, a87
  v_mul_f32 v42, v41, v42
  v_mul_f32 v43, v41, v43
  v_mul_f32 v44, v41, v44
  v_mul_f32 v45, v41, v45
  v_accvgpr_write_b32 a84, v42
  v_accvgpr_write_b32 a85, v43
  v_accvgpr_write_b32 a86, v44
  v_accvgpr_write_b32 a87, v45
  v_accvgpr_read_b32 v42, a88
  v_accvgpr_read_b32 v43, a89
  v_accvgpr_read_b32 v44, a90
  v_accvgpr_read_b32 v45, a91
  v_mul_f32 v42, v41, v42
  v_mul_f32 v43, v41, v43
  v_mul_f32 v44, v41, v44
  v_mul_f32 v45, v41, v45
  v_accvgpr_write_b32 a88, v42
  v_accvgpr_write_b32 a89, v43
  v_accvgpr_write_b32 a90, v44
  v_accvgpr_write_b32 a91, v45
  v_accvgpr_read_b32 v42, a92
  v_accvgpr_read_b32 v43, a93
  v_accvgpr_read_b32 v44, a94
  v_accvgpr_read_b32 v45, a95
  v_mul_f32 v42, v41, v42
  v_mul_f32 v43, v41, v43
  v_mul_f32 v44, v41, v44
  v_mul_f32 v45, v41, v45
  v_accvgpr_write_b32 a92, v42
  v_accvgpr_write_b32 a93, v43
  v_accvgpr_write_b32 a94, v44
  v_accvgpr_write_b32 a95, v45
  v_accvgpr_read_b32 v42, a96
  v_accvgpr_read_b32 v43, a97
  v_accvgpr_read_b32 v44, a98
  v_accvgpr_read_b32 v45, a99
  v_mul_f32 v42, v40, v42
  v_mul_f32 v43, v40, v43
  v_mul_f32 v44, v40, v44
  v_mul_f32 v45, v40, v45
  v_accvgpr_write_b32 a96, v42
  v_accvgpr_write_b32 a97, v43
  v_accvgpr_write_b32 a98, v44
  v_accvgpr_write_b32 a99, v45
  v_accvgpr_read_b32 v42, a100
  v_accvgpr_read_b32 v43, a101
  v_accvgpr_read_b32 v44, a102
  v_accvgpr_read_b32 v45, a103
  v_mul_f32 v42, v40, v42
  v_mul_f32 v43, v40, v43
  v_mul_f32 v44, v40, v44
  v_mul_f32 v45, v40, v45
  v_accvgpr_write_b32 a100, v42
  v_accvgpr_write_b32 a101, v43
  v_accvgpr_write_b32 a102, v44
  v_accvgpr_write_b32 a103, v45
  v_accvgpr_read_b32 v42, a104
  v_accvgpr_read_b32 v43, a105
  v_accvgpr_read_b32 v44, a106
  v_accvgpr_read_b32 v45, a107
  v_mul_f32 v42, v40, v42
  v_mul_f32 v43, v40, v43
  v_mul_f32 v44, v40, v44
  v_mul_f32 v45, v40, v45
  v_accvgpr_write_b32 a104, v42
  v_accvgpr_write_b32 a105, v43
  v_accvgpr_write_b32 a106, v44
  v_accvgpr_write_b32 a107, v45
  v_accvgpr_read_b32 v42, a108
  v_accvgpr_read_b32 v43, a109
  v_accvgpr_read_b32 v44, a110
  v_accvgpr_read_b32 v45, a111
  v_mul_f32 v42, v40, v42
  v_mul_f32 v43, v40, v43
  v_mul_f32 v44, v40, v44
  v_mul_f32 v45, v40, v45
  v_accvgpr_write_b32 a108, v42
  v_accvgpr_write_b32 a109, v43
  v_accvgpr_write_b32 a110, v44
  v_accvgpr_write_b32 a111, v45
  v_accvgpr_read_b32 v42, a112
  v_accvgpr_read_b32 v43, a113
  v_accvgpr_read_b32 v44, a114
  v_accvgpr_read_b32 v45, a115
  v_mul_f32 v42, v41, v42
  v_mul_f32 v43, v41, v43
  v_mul_f32 v44, v41, v44
  v_mul_f32 v45, v41, v45
  v_accvgpr_write_b32 a112, v42
  v_accvgpr_write_b32 a113, v43
  v_accvgpr_write_b32 a114, v44
  v_accvgpr_write_b32 a115, v45
  v_accvgpr_read_b32 v42, a116
  v_accvgpr_read_b32 v43, a117
  v_accvgpr_read_b32 v44, a118
  v_accvgpr_read_b32 v45, a119
  v_mul_f32 v42, v41, v42
  v_mul_f32 v43, v41, v43
  v_mul_f32 v44, v41, v44
  v_mul_f32 v45, v41, v45
  v_accvgpr_write_b32 a116, v42
  v_accvgpr_write_b32 a117, v43
  v_accvgpr_write_b32 a118, v44
  v_accvgpr_write_b32 a119, v45
  v_accvgpr_read_b32 v42, a120
  v_accvgpr_read_b32 v43, a121
  v_accvgpr_read_b32 v44, a122
  v_accvgpr_read_b32 v45, a123
  v_mul_f32 v42, v41, v42
  v_mul_f32 v43, v41, v43
  v_mul_f32 v44, v41, v44
  v_mul_f32 v45, v41, v45
  v_accvgpr_write_b32 a120, v42
  v_accvgpr_write_b32 a121, v43
  v_accvgpr_write_b32 a122, v44
  v_accvgpr_write_b32 a123, v45
  v_accvgpr_read_b32 v42, a124
  v_accvgpr_read_b32 v43, a125
  v_accvgpr_read_b32 v44, a126
  v_accvgpr_read_b32 v45, a127
  v_mul_f32 v42, v41, v42
  v_mul_f32 v43, v41, v43
  v_mul_f32 v44, v41, v44
  v_mul_f32 v45, v41, v45
  v_accvgpr_write_b32 a124, v42
  v_accvgpr_write_b32 a125, v43
  v_accvgpr_write_b32 a126, v44
  v_accvgpr_write_b32 a127, v45
  s_branch L1_backS0
L1_rare1:
  v_mov_b32 v38, v36
  v_mov_b32 v39, v37
  s_nop 1
  v_permlane32_swap_b32 v38, v39
  v_max_f32 v38, v38, v39
  v_mov_b32 v39, v38
  s_nop 1
  v_permlane32_swap_b32 v38, v39
  v_max_f32 v38, 0, v38
  v_sub_f32 v40, 0, v38
  v_exp_f32 v40, v40
  v_add_f32 v30, v30, v38
  v_mul_f32 v34, v34, v40
  v_max_f32 v39, 0, v39
  v_sub_f32 v41, 0, v39
  v_exp_f32 v41, v41
  v_add_f32 v31, v31, v39
  v_mul_f32 v35, v35, v41
  v_sub_f32 v48, v48, v38
  v_sub_f32 v49, v49, v38
  v_sub_f32 v50, v50, v38
  v_sub_f32 v51, v51, v38
  v_sub_f32 v52, v52, v38
  v_sub_f32 v53, v53, v38
  v_sub_f32 v54, v54, v38
  v_sub_f32 v55, v55, v38
  v_sub_f32 v56, v56, v38
  v_sub_f32 v57, v57, v38
  v_sub_f32 v58, v58, v38
  v_sub_f32 v59, v59, v38
  v_sub_f32 v60, v60, v38
  v_sub_f32 v61, v61, v38
  v_sub_f32 v62, v62, v38
  v_sub_f32 v63, v63, v38
  v_sub_f32 v64, v64, v39
  v_sub_f32 v65, v65, v39
  v_sub_f32 v66, v66, v39
  v_sub_f32 v67, v67, v39
  v_sub_f32 v68, v68, v39
  v_sub_f32 v69, v69, v39
  v_sub_f32 v70, v70, v39
  v_sub_f32 v71, v71, v39
  v_sub_f32 v72, v72, v39
  v_sub_f32 v73, v73, v39
  v_sub_f32 v74, v74, v39
  v_sub_f32 v75, v75, v39
  v_sub_f32 v76, v76, v39
  v_sub_f32 v77, v77, v39
  v_sub_f32 v78, v78, v39
  v_sub_f32 v79, v79, v39
  v_accvgpr_read_b32 v42, a0
  v_accvgpr_read_b32 v43, a1
  v_accvgpr_read_b32 v44, a2
  v_accvgpr_read_b32 v45, a3
  v_mul_f32 v42, v40, v42
  v_mul_f32 v43, v40, v43
  v_mul_f32 v44, v40, v44
  v_mul_f32 v45, v40, v45
  v_accvgpr_write_b32 a0, v42
  v_accvgpr_write_b32 a1, v43
  v_accvgpr_write_b32 a2, v44
  v_accvgpr_write_b32 a3, v45
  v_accvgpr_read_b32 v42, a4
  v_accvgpr_read_b32 v43, a5
  v_accvgpr_read_b32 v44, a6
  v_accvgpr_read_b32 v45, a7
  v_mul_f32 v42, v40, v42
  v_mul_f32 v43, v40, v43
  v_mul_f32 v44, v40, v44
  v_mul_f32 v45, v40, v45
  v_accvgpr_write_b32 a4, v42
  v_accvgpr_write_b32 a5, v43
  v_accvgpr_write_b32 a6, v44
  v_accvgpr_write_b32 a7, v45
  v_accvgpr_read_b32 v42, a8
  v_accvgpr_read_b32 v43, a9
  v_accvgpr_read_b32 v44, a10
  v_accvgpr_read_b32 v45, a11
  v_mul_f32 v42, v40, v42
  v_mul_f32 v43, v40, v43
  v_mul_f32 v44, v40, v44
  v_mul_f32 v45, v40, v45
  v_accvgpr_write_b32 a8, v42
  v_accvgpr_write_b32 a9, v43
  v_accvgpr_write_b32 a10, v44
  v_accvgpr_write_b32 a11, v45
  v_accvgpr_read_b32 v42, a12
  v_accvgpr_read_b32 v43, a13
  v_accvgpr_read_b32 v44, a14
  v_accvgpr_read_b32 v45, a15
  v_mul_f32 v42, v40, v42
  v_mul_f32 v43, v40, v43
  v_mul_f32 v44, v40, v44
  v_mul_f32 v45, v40, v45
  v_accvgpr_write_b32 a12, v42
  v_accvgpr_write_b32 a13, v43
  v_accvgpr_write_b32 a14, v44
  v_accvgpr_write_b32 a15, v45
  v_accvgpr_read_b32 v42, a16
  v_accvgpr_read_b32 v43, a17
  v_accvgpr_read_b32 v44, a18
  v_accvgpr_read_b32 v45, a19
  v_mul_f32 v42, v41, v42
  v_mul_f32 v43, v41, v43
  v_mul_f32 v44, v41, v44
  v_mul_f32 v45, v41, v45
  v_accvgpr_write_b32 a16, v42
  v_accvgpr_write_b32 a17, v43
  v_accvgpr_write_b32 a18, v44
  v_accvgpr_write_b32 a19, v45
  v_accvgpr_read_b32 v42, a20
  v_accvgpr_read_b32 v43, a21
  v_accvgpr_read_b32 v44, a22
  v_accvgpr_read_b32 v45, a23
  v_mul_f32 v42, v41, v42
  v_mul_f32 v43, v41, v43
  v_mul_f32 v44, v41, v44
  v_mul_f32 v45, v41, v45
  v_accvgpr_write_b32 a20, v42
  v_accvgpr_write_b32 a21, v43
  v_accvgpr_write_b32 a22, v44
  v_accvgpr_write_b32 a23, v45
  v_accvgpr_read_b32 v42, a24
  v_accvgpr_read_b32 v43, a25
  v_accvgpr_read_b32 v44, a26
  v_accvgpr_read_b32 v45, a27
  v_mul_f32 v42, v41, v42
  v_mul_f32 v43, v41, v43
  v_mul_f32 v44, v41, v44
  v_mul_f32 v45, v41, v45
  v_accvgpr_write_b32 a24, v42
  v_accvgpr_write_b32 a25, v43
  v_accvgpr_write_b32 a26, v44
  v_accvgpr_write_b32 a27, v45
  v_accvgpr_read_b32 v42, a28
  v_accvgpr_read_b32 v43, a29
  v_accvgpr_read_b32 v44, a30
  v_accvgpr_read_b32 v45, a31
  v_mul_f32 v42, v41, v42
  v_mul_f32 v43, v41, v43
  v_mul_f32 v44, v41, v44
  v_mul_f32 v45, v41, v45
  v_accvgpr_write_b32 a28, v42
  v_accvgpr_write_b32 a29, v43
  v_accvgpr_write_b32 a30, v44
  v_accvgpr_write_b32 a31, v45
  v_accvgpr_read_b32 v42, a32
  v_accvgpr_read_b32 v43, a33
  v_accvgpr_read_b32 v44, a34
  v_accvgpr_read_b32 v45, a35
  v_mul_f32 v42, v40, v42
  v_mul_f32 v43, v40, v43
  v_mul_f32 v44, v40, v44
  v_mul_f32 v45, v40, v45
  v_accvgpr_write_b32 a32, v42
  v_accvgpr_write_b32 a33, v43
  v_accvgpr_write_b32 a34, v44
  v_accvgpr_write_b32 a35, v45
  v_accvgpr_read_b32 v42, a36
  v_accvgpr_read_b32 v43, a37
  v_accvgpr_read_b32 v44, a38
  v_accvgpr_read_b32 v45, a39
  v_mul_f32 v42, v40, v42
  v_mul_f32 v43, v40, v43
  v_mul_f32 v44, v40, v44
  v_mul_f32 v45, v40, v45
  v_accvgpr_write_b32 a36, v42
  v_accvgpr_write_b32 a37, v43
  v_accvgpr_write_b32 a38, v44
  v_accvgpr_write_b32 a39, v45
  v_accvgpr_read_b32 v42, a40
  v_accvgpr_read_b32 v43, a41
  v_accvgpr_read_b32 v44, a42
  v_accvgpr_read_b32 v45, a43
  v_mul_f32 v42, v40, v42
  v_mul_f32 v43, v40, v43
  v_mul_f32 v44, v40, v44
  v_mul_f32 v45, v40, v45
  v_accvgpr_write_b32 a40, v42
  v_accvgpr_write_b32 a41, v43
  v_accvgpr_write_b32 a42, v44
  v_accvgpr_write_b32 a43, v45
  v_accvgpr_read_b32 v42, a44
  v_accvgpr_read_b32 v43, a45
  v_accvgpr_read_b32 v44, a46
  v_accvgpr_read_b32 v45, a47
  v_mul_f32 v42, v40, v42
  v_mul_f32 v43, v40, v43
  v_mul_f32 v44, v40, v44
  v_mul_f32 v45, v40, v45
  v_accvgpr_write_b32 a44, v42
  v_accvgpr_write_b32 a45, v43
  v_accvgpr_write_b32 a46, v44
  v_accvgpr_write_b32 a47, v45
  v_accvgpr_read_b32 v42, a48
  v_accvgpr_read_b32 v43, a49
  v_accvgpr_read_b32 v44, a50
  v_accvgpr_read_b32 v45, a51
  v_mul_f32 v42, v41, v42
  v_mul_f32 v43, v41, v43
  v_mul_f32 v44, v41, v44
  v_mul_f32 v45, v41, v45
  v_accvgpr_write_b32 a48, v42
  v_accvgpr_write_b32 a49, v43
  v_accvgpr_write_b32 a50, v44
  v_accvgpr_write_b32 a51, v45
  v_accvgpr_read_b32 v42, a52
  v_accvgpr_read_b32 v43, a53
  v_accvgpr_read_b32 v44, a54
  v_accvgpr_read_b32 v45, a55
  v_mul_f32 v42, v41, v42
  v_mul_f32 v43, v41, v43
  v_mul_f32 v44, v41, v44
  v_mul_f32 v45, v41, v45
  v_accvgpr_write_b32 a52, v42
  v_accvgpr_write_b32 a53, v43
  v_accvgpr_write_b32 a54, v44
  v_accvgpr_write_b32 a55, v45
  v_accvgpr_read_b32 v42, a56
  v_accvgpr_read_b32 v43, a57
  v_accvgpr_read_b32 v44, a58
  v_accvgpr_read_b32 v45, a59
  v_mul_f32 v42, v41, v42
  v_mul_f32 v43, v41, v43
  v_mul_f32 v44, v41, v44
  v_mul_f32 v45, v41, v45
  v_accvgpr_write_b32 a56, v42
  v_accvgpr_write_b32 a57, v43
  v_accvgpr_write_b32 a58, v44
  v_accvgpr_write_b32 a59, v45
  v_accvgpr_read_b32 v42, a60
  v_accvgpr_read_b32 v43, a61
  v_accvgpr_read_b32 v44, a62
  v_accvgpr_read_b32 v45, a63
  v_mul_f32 v42, v41, v42
  v_mul_f32 v43, v41, v43
  v_mul_f32 v44, v41, v44
  v_mul_f32 v45, v41, v45
  v_accvgpr_write_b32 a60, v42
  v_accvgpr_write_b32 a61, v43
  v_accvgpr_write_b32 a62, v44
  v_accvgpr_write_b32 a63, v45
  v_accvgpr_read_b32 v42, a64
  v_accvgpr_read_b32 v43, a65
  v_accvgpr_read_b32 v44, a66
  v_accvgpr_read_b32 v45, a67
  v_mul_f32 v42, v40, v42
  v_mul_f32 v43, v40, v43
  v_mul_f32 v44, v40, v44
  v_mul_f32 v45, v40, v45
  v_accvgpr_write_b32 a64, v42
  v_accvgpr_write_b32 a65, v43
  v_accvgpr_write_b32 a66, v44
  v_accvgpr_write_b32 a67, v45
  v_accvgpr_read_b32 v42, a68
  v_accvgpr_read_b32 v43, a69
  v_accvgpr_read_b32 v44, a70
  v_accvgpr_read_b32 v45, a71
  v_mul_f32 v42, v40, v42
  v_mul_f32 v43, v40, v43
  v_mul_f32 v44, v40, v44
  v_mul_f32 v45, v40, v45
  v_accvgpr_write_b32 a68, v42
  v_accvgpr_write_b32 a69, v43
  v_accvgpr_write_b32 a70, v44
  v_accvgpr_write_b32 a71, v45
  v_accvgpr_read_b32 v42, a72
  v_accvgpr_read_b32 v43, a73
  v_accvgpr_read_b32 v44, a74
  v_accvgpr_read_b32 v45, a75
  v_mul_f32 v42, v40, v42
  v_mul_f32 v43, v40, v43
  v_mul_f32 v44, v40, v44
  v_mul_f32 v45, v40, v45
  v_accvgpr_write_b32 a72, v42
  v_accvgpr_write_b32 a73, v43
  v_accvgpr_write_b32 a74, v44
  v_accvgpr_write_b32 a75, v45
  v_accvgpr_read_b32 v42, a76
  v_accvgpr_read_b32 v43, a77
  v_accvgpr_read_b32 v44, a78
  v_accvgpr_read_b32 v45, a79
  v_mul_f32 v42, v40, v42
  v_mul_f32 v43, v40, v43
  v_mul_f32 v44, v40, v44
  v_mul_f32 v45, v40, v45
  v_accvgpr_write_b32 a76, v42
  v_accvgpr_write_b32 a77, v43
  v_accvgpr_write_b32 a78, v44
  v_accvgpr_write_b32 a79, v45
  v_accvgpr_read_b32 v42, a80
  v_accvgpr_read_b32 v43, a81
  v_accvgpr_read_b32 v44, a82
  v_accvgpr_read_b32 v45, a83
  v_mul_f32 v42, v41, v42
  v_mul_f32 v43, v41, v43
  v_mul_f32 v44, v41, v44
  v_mul_f32 v45, v41, v45
  v_accvgpr_write_b32 a80, v42
  v_accvgpr_write_b32 a81, v43
  v_accvgpr_write_b32 a82, v44
  v_accvgpr_write_b32 a83, v45
  v_accvgpr_read_b32 v42, a84
  v_accvgpr_read_b32 v43, a85
  v_accvgpr_read_b32 v44, a86
  v_accvgpr_read_b32 v45, a87
  v_mul_f32 v42, v41, v42
  v_mul_f32 v43, v41, v43
  v_mul_f32 v44, v41, v44
  v_mul_f32 v45, v41, v45
  v_accvgpr_write_b32 a84, v42
  v_accvgpr_write_b32 a85, v43
  v_accvgpr_write_b32 a86, v44
  v_accvgpr_write_b32 a87, v45
  v_accvgpr_read_b32 v42, a88
  v_accvgpr_read_b32 v43, a89
  v_accvgpr_read_b32 v44, a90
  v_accvgpr_read_b32 v45, a91
  v_mul_f32 v42, v41, v42
  v_mul_f32 v43, v41, v43
  v_mul_f32 v44, v41, v44
  v_mul_f32 v45, v41, v45
  v_accvgpr_write_b32 a88, v42
  v_accvgpr_write_b32 a89, v43
  v_accvgpr_write_b32 a90, v44
  v_accvgpr_write_b32 a91, v45
  v_accvgpr_read_b32 v42, a92
  v_accvgpr_read_b32 v43, a93
  v_accvgpr_read_b32 v44, a94
  v_accvgpr_read_b32 v45, a95
  v_mul_f32 v42, v41, v42
  v_mul_f32 v43, v41, v43
  v_mul_f32 v44, v41, v44
  v_mul_f32 v45, v41, v45
  v_accvgpr_write_b32 a92, v42
  v_accvgpr_write_b32 a93, v43
  v_accvgpr_write_b32 a94, v44
  v_accvgpr_write_b32 a95, v45
  v_accvgpr_read_b32 v42, a96
  v_accvgpr_read_b32 v43, a97
  v_accvgpr_read_b32 v44, a98
  v_accvgpr_read_b32 v45, a99
  v_mul_f32 v42, v40, v42
  v_mul_f32 v43, v40, v43
  v_mul_f32 v44, v40, v44
  v_mul_f32 v45, v40, v45
  v_accvgpr_write_b32 a96, v42
  v_accvgpr_write_b32 a97, v43
  v_accvgpr_write_b32 a98, v44
  v_accvgpr_write_b32 a99, v45
  v_accvgpr_read_b32 v42, a100
  v_accvgpr_read_b32 v43, a101
  v_accvgpr_read_b32 v44, a102
  v_accvgpr_read_b32 v45, a103
  v_mul_f32 v42, v40, v42
  v_mul_f32 v43, v40, v43
  v_mul_f32 v44, v40, v44
  v_mul_f32 v45, v40, v45
  v_accvgpr_write_b32 a100, v42
  v_accvgpr_write_b32 a101, v43
  v_accvgpr_write_b32 a102, v44
  v_accvgpr_write_b32 a103, v45
  v_accvgpr_read_b32 v42, a104
  v_accvgpr_read_b32 v43, a105
  v_accvgpr_read_b32 v44, a106
  v_accvgpr_read_b32 v45, a107
  v_mul_f32 v42, v40, v42
  v_mul_f32 v43, v40, v43
  v_mul_f32 v44, v40, v44
  v_mul_f32 v45, v40, v45
  v_accvgpr_write_b32 a104, v42
  v_accvgpr_write_b32 a105, v43
  v_accvgpr_write_b32 a106, v44
  v_accvgpr_write_b32 a107, v45
  v_accvgpr_read_b32 v42, a108
  v_accvgpr_read_b32 v43, a109
  v_accvgpr_read_b32 v44, a110
  v_accvgpr_read_b32 v45, a111
  v_mul_f32 v42, v40, v42
  v_mul_f32 v43, v40, v43
  v_mul_f32 v44, v40, v44
  v_mul_f32 v45, v40, v45
  v_accvgpr_write_b32 a108, v42
  v_accvgpr_write_b32 a109, v43
  v_accvgpr_write_b32 a110, v44
  v_accvgpr_write_b32 a111, v45
  v_accvgpr_read_b32 v42, a112
  v_accvgpr_read_b32 v43, a113
  v_accvgpr_read_b32 v44, a114
  v_accvgpr_read_b32 v45, a115
  v_mul_f32 v42, v41, v42
  v_mul_f32 v43, v41, v43
  v_mul_f32 v44, v41, v44
  v_mul_f32 v45, v41, v45
  v_accvgpr_write_b32 a112, v42
  v_accvgpr_write_b32 a113, v43
  v_accvgpr_write_b32 a114, v44
  v_accvgpr_write_b32 a115, v45
  v_accvgpr_read_b32 v42, a116
  v_accvgpr_read_b32 v43, a117
  v_accvgpr_read_b32 v44, a118
  v_accvgpr_read_b32 v45, a119
  v_mul_f32 v42, v41, v42
  v_mul_f32 v43, v41, v43
  v_mul_f32 v44, v41, v44
  v_mul_f32 v45, v41, v45
  v_accvgpr_write_b32 a116, v42
  v_accvgpr_write_b32 a117, v43
  v_accvgpr_write_b32 a118, v44
  v_accvgpr_write_b32 a119, v45
  v_accvgpr_read_b32 v42, a120
  v_accvgpr_read_b32 v43, a121
  v_accvgpr_read_b32 v44, a122
  v_accvgpr_read_b32 v45, a123
  v_mul_f32 v42, v41, v42
  v_mul_f32 v43, v41, v43
  v_mul_f32 v44, v41, v44
  v_mul_f32 v45, v41, v45
  v_accvgpr_write_b32 a120, v42
  v_accvgpr_write_b32 a121, v43
  v_accvgpr_write_b32 a122, v44
  v_accvgpr_write_b32 a123, v45
  v_accvgpr_read_b32 v42, a124
  v_accvgpr_read_b32 v43, a125
  v_accvgpr_read_b32 v44, a126
  v_accvgpr_read_b32 v45, a127
  v_mul_f32 v42, v41, v42
  v_mul_f32 v43, v41, v43
  v_mul_f32 v44, v41, v44
  v_mul_f32 v45, v41, v45
  v_accvgpr_write_b32 a124, v42
  v_accvgpr_write_b32 a125, v43
  v_accvgpr_write_b32 a126, v44
  v_accvgpr_write_b32 a127, v45
  s_branch L1_back1
L1_rare0:
  v_mov_b32 v38, v36
  v_mov_b32 v39, v37
  s_nop 1
  v_permlane32_swap_b32 v38, v39
  v_max_f32 v38, v38, v39
  v_mov_b32 v39, v38
  s_nop 1
  v_permlane32_swap_b32 v38, v39
  v_max_f32 v38, 0, v38
  v_sub_f32 v40, 0, v38
  v_exp_f32 v40, v40
  v_add_f32 v30, v30, v38
  v_mul_f32 v34, v34, v40
  v_max_f32 v39, 0, v39
  v_sub_f32 v41, 0, v39
  v_exp_f32 v41, v41
  v_add_f32 v31, v31, v39
  v_mul_f32 v35, v35, v41
  v_sub_f32 v80, v80, v38
  v_sub_f32 v81, v81, v38
  v_sub_f32 v82, v82, v38
  v_sub_f32 v83, v83, v38
  v_sub_f32 v84, v84, v38
  v_sub_f32 v85, v85, v38
  v_sub_f32 v86, v86, v38
  v_sub_f32 v87, v87, v38
  v_sub_f32 v88, v88, v38
  v_sub_f32 v89, v89, v38
  v_sub_f32 v90, v90, v38
  v_sub_f32 v91, v91, v38
  v_sub_f32 v92, v92, v38
  v_sub_f32 v93, v93, v38
  v_sub_f32 v94, v94, v38
  v_sub_f32 v95, v95, v38
  v_sub_f32 v96, v96, v39
  v_sub_f32 v97, v97, v39
  v_sub_f32 v98, v98, v39
  v_sub_f32 v99, v99, v39
  v_sub_f32 v100, v100, v39
  v_sub_f32 v101, v101, v39
  v_sub_f32 v102, v102, v39
  v_sub_f32 v103, v103, v39
  v_sub_f32 v104, v104, v39
  v_sub_f32 v105, v105, v39
  v_sub_f32 v106, v106, v39
  v_sub_f32 v107, v107, v39
  v_sub_f32 v108, v108, v39
  v_sub_f32 v109, v109, v39
  v_sub_f32 v110, v110, v39
  v_sub_f32 v111, v111, v39
  v_accvgpr_read_b32 v42, a0
  v_accvgpr_read_b32 v43, a1
  v_accvgpr_read_b32 v44, a2
  v_accvgpr_read_b32 v45, a3
  v_mul_f32 v42, v40, v42
  v_mul_f32 v43, v40, v43
  v_mul_f32 v44, v40, v44
  v_mul_f32 v45, v40, v45
  v_accvgpr_write_b32 a0, v42
  v_accvgpr_write_b32 a1, v43
  v_accvgpr_write_b32 a2, v44
  v_accvgpr_write_b32 a3, v45
  v_accvgpr_read_b32 v42, a4
  v_accvgpr_read_b32 v43, a5
  v_accvgpr_read_b32 v44, a6
  v_accvgpr_read_b32 v45, a7
  v_mul_f32 v42, v40, v42
  v_mul_f32 v43, v40, v43
  v_mul_f32 v44, v40, v44
  v_mul_f32 v45, v40, v45
  v_accvgpr_write_b32 a4, v42
  v_accvgpr_write_b32 a5, v43
  v_accvgpr_write_b32 a6, v44
  v_accvgpr_write_b32 a7, v45
  v_accvgpr_read_b32 v42, a8
  v_accvgpr_read_b32 v43, a9
  v_accvgpr_read_b32 v44, a10
  v_accvgpr_read_b32 v45, a11
  v_mul_f32 v42, v40, v42
  v_mul_f32 v43, v40, v43
  v_mul_f32 v44, v40, v44
  v_mul_f32 v45, v40, v45
  v_accvgpr_write_b32 a8, v42
  v_accvgpr_write_b32 a9, v43
  v_accvgpr_write_b32 a10, v44
  v_accvgpr_write_b32 a11, v45
  v_accvgpr_read_b32 v42, a12
  v_accvgpr_read_b32 v43, a13
  v_accvgpr_read_b32 v44, a14
  v_accvgpr_read_b32 v45, a15
  v_mul_f32 v42, v40, v42
  v_mul_f32 v43, v40, v43
  v_mul_f32 v44, v40, v44
  v_mul_f32 v45, v40, v45
  v_accvgpr_write_b32 a12, v42
  v_accvgpr_write_b32 a13, v43
  v_accvgpr_write_b32 a14, v44
  v_accvgpr_write_b32 a15, v45
  v_accvgpr_read_b32 v42, a16
  v_accvgpr_read_b32 v43, a17
  v_accvgpr_read_b32 v44, a18
  v_accvgpr_read_b32 v45, a19
  v_mul_f32 v42, v41, v42
  v_mul_f32 v43, v41, v43
  v_mul_f32 v44, v41, v44
  v_mul_f32 v45, v41, v45
  v_accvgpr_write_b32 a16, v42
  v_accvgpr_write_b32 a17, v43
  v_accvgpr_write_b32 a18, v44
  v_accvgpr_write_b32 a19, v45
  v_accvgpr_read_b32 v42, a20
  v_accvgpr_read_b32 v43, a21
  v_accvgpr_read_b32 v44, a22
  v_accvgpr_read_b32 v45, a23
  v_mul_f32 v42, v41, v42
  v_mul_f32 v43, v41, v43
  v_mul_f32 v44, v41, v44
  v_mul_f32 v45, v41, v45
  v_accvgpr_write_b32 a20, v42
  v_accvgpr_write_b32 a21, v43
  v_accvgpr_write_b32 a22, v44
  v_accvgpr_write_b32 a23, v45
  v_accvgpr_read_b32 v42, a24
  v_accvgpr_read_b32 v43, a25
  v_accvgpr_read_b32 v44, a26
  v_accvgpr_read_b32 v45, a27
  v_mul_f32 v42, v41, v42
  v_mul_f32 v43, v41, v43
  v_mul_f32 v44, v41, v44
  v_mul_f32 v45, v41, v45
  v_accvgpr_write_b32 a24, v42
  v_accvgpr_write_b32 a25, v43
  v_accvgpr_write_b32 a26, v44
  v_accvgpr_write_b32 a27, v45
  v_accvgpr_read_b32 v42, a28
  v_accvgpr_read_b32 v43, a29
  v_accvgpr_read_b32 v44, a30
  v_accvgpr_read_b32 v45, a31
  v_mul_f32 v42, v41, v42
  v_mul_f32 v43, v41, v43
  v_mul_f32 v44, v41, v44
  v_mul_f32 v45, v41, v45
  v_accvgpr_write_b32 a28, v42
  v_accvgpr_write_b32 a29, v43
  v_accvgpr_write_b32 a30, v44
  v_accvgpr_write_b32 a31, v45
  v_accvgpr_read_b32 v42, a32
  v_accvgpr_read_b32 v43, a33
  v_accvgpr_read_b32 v44, a34
  v_accvgpr_read_b32 v45, a35
  v_mul_f32 v42, v40, v42
  v_mul_f32 v43, v40, v43
  v_mul_f32 v44, v40, v44
  v_mul_f32 v45, v40, v45
  v_accvgpr_write_b32 a32, v42
  v_accvgpr_write_b32 a33, v43
  v_accvgpr_write_b32 a34, v44
  v_accvgpr_write_b32 a35, v45
  v_accvgpr_read_b32 v42, a36
  v_accvgpr_read_b32 v43, a37
  v_accvgpr_read_b32 v44, a38
  v_accvgpr_read_b32 v45, a39
  v_mul_f32 v42, v40, v42
  v_mul_f32 v43, v40, v43
  v_mul_f32 v44, v40, v44
  v_mul_f32 v45, v40, v45
  v_accvgpr_write_b32 a36, v42
  v_accvgpr_write_b32 a37, v43
  v_accvgpr_write_b32 a38, v44
  v_accvgpr_write_b32 a39, v45
  v_accvgpr_read_b32 v42, a40
  v_accvgpr_read_b32 v43, a41
  v_accvgpr_read_b32 v44, a42
  v_accvgpr_read_b32 v45, a43
  v_mul_f32 v42, v40, v42
  v_mul_f32 v43, v40, v43
  v_mul_f32 v44, v40, v44
  v_mul_f32 v45, v40, v45
  v_accvgpr_write_b32 a40, v42
  v_accvgpr_write_b32 a41, v43
  v_accvgpr_write_b32 a42, v44
  v_accvgpr_write_b32 a43, v45
  v_accvgpr_read_b32 v42, a44
  v_accvgpr_read_b32 v43, a45
  v_accvgpr_read_b32 v44, a46
  v_accvgpr_read_b32 v45, a47
  v_mul_f32 v42, v40, v42
  v_mul_f32 v43, v40, v43
  v_mul_f32 v44, v40, v44
  v_mul_f32 v45, v40, v45
  v_accvgpr_write_b32 a44, v42
  v_accvgpr_write_b32 a45, v43
  v_accvgpr_write_b32 a46, v44
  v_accvgpr_write_b32 a47, v45
  v_accvgpr_read_b32 v42, a48
  v_accvgpr_read_b32 v43, a49
  v_accvgpr_read_b32 v44, a50
  v_accvgpr_read_b32 v45, a51
  v_mul_f32 v42, v41, v42
  v_mul_f32 v43, v41, v43
  v_mul_f32 v44, v41, v44
  v_mul_f32 v45, v41, v45
  v_accvgpr_write_b32 a48, v42
  v_accvgpr_write_b32 a49, v43
  v_accvgpr_write_b32 a50, v44
  v_accvgpr_write_b32 a51, v45
  v_accvgpr_read_b32 v42, a52
  v_accvgpr_read_b32 v43, a53
  v_accvgpr_read_b32 v44, a54
  v_accvgpr_read_b32 v45, a55
  v_mul_f32 v42, v41, v42
  v_mul_f32 v43, v41, v43
  v_mul_f32 v44, v41, v44
  v_mul_f32 v45, v41, v45
  v_accvgpr_write_b32 a52, v42
  v_accvgpr_write_b32 a53, v43
  v_accvgpr_write_b32 a54, v44
  v_accvgpr_write_b32 a55, v45
  v_accvgpr_read_b32 v42, a56
  v_accvgpr_read_b32 v43, a57
  v_accvgpr_read_b32 v44, a58
  v_accvgpr_read_b32 v45, a59
  v_mul_f32 v42, v41, v42
  v_mul_f32 v43, v41, v43
  v_mul_f32 v44, v41, v44
  v_mul_f32 v45, v41, v45
  v_accvgpr_write_b32 a56, v42
  v_accvgpr_write_b32 a57, v43
  v_accvgpr_write_b32 a58, v44
  v_accvgpr_write_b32 a59, v45
  v_accvgpr_read_b32 v42, a60
  v_accvgpr_read_b32 v43, a61
  v_accvgpr_read_b32 v44, a62
  v_accvgpr_read_b32 v45, a63
  v_mul_f32 v42, v41, v42
  v_mul_f32 v43, v41, v43
  v_mul_f32 v44, v41, v44
  v_mul_f32 v45, v41, v45
  v_accvgpr_write_b32 a60, v42
  v_accvgpr_write_b32 a61, v43
  v_accvgpr_write_b32 a62, v44
  v_accvgpr_write_b32 a63, v45
  v_accvgpr_read_b32 v42, a64
  v_accvgpr_read_b32 v43, a65
  v_accvgpr_read_b32 v44, a66
  v_accvgpr_read_b32 v45, a67
  v_mul_f32 v42, v40, v42
  v_mul_f32 v43, v40, v43
  v_mul_f32 v44, v40, v44
  v_mul_f32 v45, v40, v45
  v_accvgpr_write_b32 a64, v42
  v_accvgpr_write_b32 a65, v43
  v_accvgpr_write_b32 a66, v44
  v_accvgpr_write_b32 a67, v45
  v_accvgpr_read_b32 v42, a68
  v_accvgpr_read_b32 v43, a69
  v_accvgpr_read_b32 v44, a70
  v_accvgpr_read_b32 v45, a71
  v_mul_f32 v42, v40, v42
  v_mul_f32 v43, v40, v43
  v_mul_f32 v44, v40, v44
  v_mul_f32 v45, v40, v45
  v_accvgpr_write_b32 a68, v42
  v_accvgpr_write_b32 a69, v43
  v_accvgpr_write_b32 a70, v44
  v_accvgpr_write_b32 a71, v45
  v_accvgpr_read_b32 v42, a72
  v_accvgpr_read_b32 v43, a73
  v_accvgpr_read_b32 v44, a74
  v_accvgpr_read_b32 v45, a75
  v_mul_f32 v42, v40, v42
  v_mul_f32 v43, v40, v43
  v_mul_f32 v44, v40, v44
  v_mul_f32 v45, v40, v45
  v_accvgpr_write_b32 a72, v42
  v_accvgpr_write_b32 a73, v43
  v_accvgpr_write_b32 a74, v44
  v_accvgpr_write_b32 a75, v45
  v_accvgpr_read_b32 v42, a76
  v_accvgpr_read_b32 v43, a77
  v_accvgpr_read_b32 v44, a78
  v_accvgpr_read_b32 v45, a79
  v_mul_f32 v42, v40, v42
  v_mul_f32 v43, v40, v43
  v_mul_f32 v44, v40, v44
  v_mul_f32 v45, v40, v45
  v_accvgpr_write_b32 a76, v42
  v_accvgpr_write_b32 a77, v43
  v_accvgpr_write_b32 a78, v44
  v_accvgpr_write_b32 a79, v45
  v_accvgpr_read_b32 v42, a80
  v_accvgpr_read_b32 v43, a81
  v_accvgpr_read_b32 v44, a82
  v_accvgpr_read_b32 v45, a83
  v_mul_f32 v42, v41, v42
  v_mul_f32 v43, v41, v43
  v_mul_f32 v44, v41, v44
  v_mul_f32 v45, v41, v45
  v_accvgpr_write_b32 a80, v42
  v_accvgpr_write_b32 a81, v43
  v_accvgpr_write_b32 a82, v44
  v_accvgpr_write_b32 a83, v45
  v_accvgpr_read_b32 v42, a84
  v_accvgpr_read_b32 v43, a85
  v_accvgpr_read_b32 v44, a86
  v_accvgpr_read_b32 v45, a87
  v_mul_f32 v42, v41, v42
  v_mul_f32 v43, v41, v43
  v_mul_f32 v44, v41, v44
  v_mul_f32 v45, v41, v45
  v_accvgpr_write_b32 a84, v42
  v_accvgpr_write_b32 a85, v43
  v_accvgpr_write_b32 a86, v44
  v_accvgpr_write_b32 a87, v45
  v_accvgpr_read_b32 v42, a88
  v_accvgpr_read_b32 v43, a89
  v_accvgpr_read_b32 v44, a90
  v_accvgpr_read_b32 v45, a91
  v_mul_f32 v42, v41, v42
  v_mul_f32 v43, v41, v43
  v_mul_f32 v44, v41, v44
  v_mul_f32 v45, v41, v45
  v_accvgpr_write_b32 a88, v42
  v_accvgpr_write_b32 a89, v43
  v_accvgpr_write_b32 a90, v44
  v_accvgpr_write_b32 a91, v45
  v_accvgpr_read_b32 v42, a92
  v_accvgpr_read_b32 v43, a93
  v_accvgpr_read_b32 v44, a94
  v_accvgpr_read_b32 v45, a95
  v_mul_f32 v42, v41, v42
  v_mul_f32 v43, v41, v43
  v_mul_f32 v44, v41, v44
  v_mul_f32 v45, v41, v45
  v_accvgpr_write_b32 a92, v42
  v_accvgpr_write_b32 a93, v43
  v_accvgpr_write_b32 a94, v44
  v_accvgpr_write_b32 a95, v45
  v_accvgpr_read_b32 v42, a96
  v_accvgpr_read_b32 v43, a97
  v_accvgpr_read_b32 v44, a98
  v_accvgpr_read_b32 v45, a99
  v_mul_f32 v42, v40, v42
  v_mul_f32 v43, v40, v43
  v_mul_f32 v44, v40, v44
  v_mul_f32 v45, v40, v45
  v_accvgpr_write_b32 a96, v42
  v_accvgpr_write_b32 a97, v43
  v_accvgpr_write_b32 a98, v44
  v_accvgpr_write_b32 a99, v45
  v_accvgpr_read_b32 v42, a100
  v_accvgpr_read_b32 v43, a101
  v_accvgpr_read_b32 v44, a102
  v_accvgpr_read_b32 v45, a103
  v_mul_f32 v42, v40, v42
  v_mul_f32 v43, v40, v43
  v_mul_f32 v44, v40, v44
  v_mul_f32 v45, v40, v45
  v_accvgpr_write_b32 a100, v42
  v_accvgpr_write_b32 a101, v43
  v_accvgpr_write_b32 a102, v44
  v_accvgpr_write_b32 a103, v45
  v_accvgpr_read_b32 v42, a104
  v_accvgpr_read_b32 v43, a105
  v_accvgpr_read_b32 v44, a106
  v_accvgpr_read_b32 v45, a107
  v_mul_f32 v42, v40, v42
  v_mul_f32 v43, v40, v43
  v_mul_f32 v44, v40, v44
  v_mul_f32 v45, v40, v45
  v_accvgpr_write_b32 a104, v42
  v_accvgpr_write_b32 a105, v43
  v_accvgpr_write_b32 a106, v44
  v_accvgpr_write_b32 a107, v45
  v_accvgpr_read_b32 v42, a108
  v_accvgpr_read_b32 v43, a109
  v_accvgpr_read_b32 v44, a110
  v_accvgpr_read_b32 v45, a111
  v_mul_f32 v42, v40, v42
  v_mul_f32 v43, v40, v43
  v_mul_f32 v44, v40, v44
  v_mul_f32 v45, v40, v45
  v_accvgpr_write_b32 a108, v42
  v_accvgpr_write_b32 a109, v43
  v_accvgpr_write_b32 a110, v44
  v_accvgpr_write_b32 a111, v45
  v_accvgpr_read_b32 v42, a112
  v_accvgpr_read_b32 v43, a113
  v_accvgpr_read_b32 v44, a114
  v_accvgpr_read_b32 v45, a115
  v_mul_f32 v42, v41, v42
  v_mul_f32 v43, v41, v43
  v_mul_f32 v44, v41, v44
  v_mul_f32 v45, v41, v45
  v_accvgpr_write_b32 a112, v42
  v_accvgpr_write_b32 a113, v43
  v_accvgpr_write_b32 a114, v44
  v_accvgpr_write_b32 a115, v45
  v_accvgpr_read_b32 v42, a116
  v_accvgpr_read_b32 v43, a117
  v_accvgpr_read_b32 v44, a118
  v_accvgpr_read_b32 v45, a119
  v_mul_f32 v42, v41, v42
  v_mul_f32 v43, v41, v43
  v_mul_f32 v44, v41, v44
  v_mul_f32 v45, v41, v45
  v_accvgpr_write_b32 a116, v42
  v_accvgpr_write_b32 a117, v43
  v_accvgpr_write_b32 a118, v44
  v_accvgpr_write_b32 a119, v45
  v_accvgpr_read_b32 v42, a120
  v_accvgpr_read_b32 v43, a121
  v_accvgpr_read_b32 v44, a122
  v_accvgpr_read_b32 v45, a123
  v_mul_f32 v42, v41, v42
  v_mul_f32 v43, v41, v43
  v_mul_f32 v44, v41, v44
  v_mul_f32 v45, v41, v45
  v_accvgpr_write_b32 a120, v42
  v_accvgpr_write_b32 a121, v43
  v_accvgpr_write_b32 a122, v44
  v_accvgpr_write_b32 a123, v45
  v_accvgpr_read_b32 v42, a124
  v_accvgpr_read_b32 v43, a125
  v_accvgpr_read_b32 v44, a126
  v_accvgpr_read_b32 v45, a127
  v_mul_f32 v42, v41, v42
  v_mul_f32 v43, v41, v43
  v_mul_f32 v44, v41, v44
  v_mul_f32 v45, v41, v45
  v_accvgpr_write_b32 a124, v42
  v_accvgpr_write_b32 a125, v43
  v_accvgpr_write_b32 a126, v44
  v_accvgpr_write_b32 a127, v45
  s_branch L1_back0
L1_rareT1:
  v_mov_b32 v38, v36
  v_mov_b32 v39, v37
  s_nop 1
  v_permlane32_swap_b32 v38, v39
  v_max_f32 v38, v38, v39
  v_mov_b32 v39, v38
  s_nop 1
  v_permlane32_swap_b32 v38, v39
  v_max_f32 v38, 0, v38
  v_sub_f32 v40, 0, v38
  v_exp_f32 v40, v40
  v_add_f32 v30, v30, v38
  v_mul_f32 v34, v34, v40
  v_max_f32 v39, 0, v39
  v_sub_f32 v41, 0, v39
  v_exp_f32 v41, v41
  v_add_f32 v31, v31, v39
  v_mul_f32 v35, v35, v41
  v_sub_f32 v48, v48, v38
  v_sub_f32 v49, v49, v38
  v_sub_f32 v50, v50, v38
  v_sub_f32 v51, v51, v38
  v_sub_f32 v52, v52, v38
  v_sub_f32 v53, v53, v38
  v_sub_f32 v54, v54, v38
  v_sub_f32 v55, v55, v38
  v_sub_f32 v56, v56, v38
  v_sub_f32 v57, v57, v38
  v_sub_f32 v58, v58, v38
  v_sub_f32 v59, v59, v38
  v_sub_f32 v60, v60, v38
  v_sub_f32 v61, v61, v38
  v_sub_f32 v62, v62, v38
  v_sub_f32 v63, v63, v38
  v_sub_f32 v64, v64, v39
  v_sub_f32 v65, v65, v39
  v_sub_f32 v66, v66, v39
  v_sub_f32 v67, v67, v39
  v_sub_f32 v68, v68, v39
  v_sub_f32 v69, v69, v39
  v_sub_f32 v70, v70, v39
  v_sub_f32 v71, v71, v39
  v_sub_f32 v72, v72, v39
  v_sub_f32 v73, v73, v39
  v_sub_f32 v74, v74, v39
  v_sub_f32 v75, v75, v39
  v_sub_f32 v76, v76, v39
  v_sub_f32 v77, v77, v39
  v_sub_f32 v78, v78, v39
  v_sub_f32 v79, v79, v39
  v_accvgpr_read_b32 v42, a0
  v_accvgpr_read_b32 v43, a1
  v_accvgpr_read_b32 v44, a2
  v_accvgpr_read_b32 v45, a3
  v_mul_f32 v42, v40, v42
  v_mul_f32 v43, v40, v43
  v_mul_f32 v44, v40, v44
  v_mul_f32 v45, v40, v45
  v_accvgpr_write_b32 a0, v42
  v_accvgpr_write_b32 a1, v43
  v_accvgpr_write_b32 a2, v44
  v_accvgpr_write_b32 a3, v45
  v_accvgpr_read_b32 v42, a4
  v_accvgpr_read_b32 v43, a5
  v_accvgpr_read_b32 v44, a6
  v_accvgpr_read_b32 v45, a7
  v_mul_f32 v42, v40, v42
  v_mul_f32 v43, v40, v43
  v_mul_f32 v44, v40, v44
  v_mul_f32 v45, v40, v45
  v_accvgpr_write_b32 a4, v42
  v_accvgpr_write_b32 a5, v43
  v_accvgpr_write_b32 a6, v44
  v_accvgpr_write_b32 a7, v45
  v_accvgpr_read_b32 v42, a8
  v_accvgpr_read_b32 v43, a9
  v_accvgpr_read_b32 v44, a10
  v_accvgpr_read_b32 v45, a11
  v_mul_f32 v42, v40, v42
  v_mul_f32 v43, v40, v43
  v_mul_f32 v44, v40, v44
  v_mul_f32 v45, v40, v45
  v_accvgpr_write_b32 a8, v42
  v_accvgpr_write_b32 a9, v43
  v_accvgpr_write_b32 a10, v44
  v_accvgpr_write_b32 a11, v45
  v_accvgpr_read_b32 v42, a12
  v_accvgpr_read_b32 v43, a13
  v_accvgpr_read_b32 v44, a14
  v_accvgpr_read_b32 v45, a15
  v_mul_f32 v42, v40, v42
  v_mul_f32 v43, v40, v43
  v_mul_f32 v44, v40, v44
  v_mul_f32 v45, v40, v45
  v_accvgpr_write_b32 a12, v42
  v_accvgpr_write_b32 a13, v43
  v_accvgpr_write_b32 a14, v44
  v_accvgpr_write_b32 a15, v45
  v_accvgpr_read_b32 v42, a16
  v_accvgpr_read_b32 v43, a17
  v_accvgpr_read_b32 v44, a18
  v_accvgpr_read_b32 v45, a19
  v_mul_f32 v42, v41, v42
  v_mul_f32 v43, v41, v43
  v_mul_f32 v44, v41, v44
  v_mul_f32 v45, v41, v45
  v_accvgpr_write_b32 a16, v42
  v_accvgpr_write_b32 a17, v43
  v_accvgpr_write_b32 a18, v44
  v_accvgpr_write_b32 a19, v45
  v_accvgpr_read_b32 v42, a20
  v_accvgpr_read_b32 v43, a21
  v_accvgpr_read_b32 v44, a22
  v_accvgpr_read_b32 v45, a23
  v_mul_f32 v42, v41, v42
  v_mul_f32 v43, v41, v43
  v_mul_f32 v44, v41, v44
  v_mul_f32 v45, v41, v45
  v_accvgpr_write_b32 a20, v42
  v_accvgpr_write_b32 a21, v43
  v_accvgpr_write_b32 a22, v44
  v_accvgpr_write_b32 a23, v45
  v_accvgpr_read_b32 v42, a24
  v_accvgpr_read_b32 v43, a25
  v_accvgpr_read_b32 v44, a26
  v_accvgpr_read_b32 v45, a27
  v_mul_f32 v42, v41, v42
  v_mul_f32 v43, v41, v43
  v_mul_f32 v44, v41, v44
  v_mul_f32 v45, v41, v45
  v_accvgpr_write_b32 a24, v42
  v_accvgpr_write_b32 a25, v43
  v_accvgpr_write_b32 a26, v44
  v_accvgpr_write_b32 a27, v45
  v_accvgpr_read_b32 v42, a28
  v_accvgpr_read_b32 v43, a29
  v_accvgpr_read_b32 v44, a30
  v_accvgpr_read_b32 v45, a31
  v_mul_f32 v42, v41, v42
  v_mul_f32 v43, v41, v43
  v_mul_f32 v44, v41, v44
  v_mul_f32 v45, v41, v45
  v_accvgpr_write_b32 a28, v42
  v_accvgpr_write_b32 a29, v43
  v_accvgpr_write_b32 a30, v44
  v_accvgpr_write_b32 a31, v45
  v_accvgpr_read_b32 v42, a32
  v_accvgpr_read_b32 v43, a33
  v_accvgpr_read_b32 v44, a34
  v_accvgpr_read_b32 v45, a35
  v_mul_f32 v42, v40, v42
  v_mul_f32 v43, v40, v43
  v_mul_f32 v44, v40, v44
  v_mul_f32 v45, v40, v45
  v_accvgpr_write_b32 a32, v42
  v_accvgpr_write_b32 a33, v43
  v_accvgpr_write_b32 a34, v44
  v_accvgpr_write_b32 a35, v45
  v_accvgpr_read_b32 v42, a36
  v_accvgpr_read_b32 v43, a37
  v_accvgpr_read_b32 v44, a38
  v_accvgpr_read_b32 v45, a39
  v_mul_f32 v42, v40, v42
  v_mul_f32 v43, v40, v43
  v_mul_f32 v44, v40, v44
  v_mul_f32 v45, v40, v45
  v_accvgpr_write_b32 a36, v42
  v_accvgpr_write_b32 a37, v43
  v_accvgpr_write_b32 a38, v44
  v_accvgpr_write_b32 a39, v45
  v_accvgpr_read_b32 v42, a40
  v_accvgpr_read_b32 v43, a41
  v_accvgpr_read_b32 v44, a42
  v_accvgpr_read_b32 v45, a43
  v_mul_f32 v42, v40, v42
  v_mul_f32 v43, v40, v43
  v_mul_f32 v44, v40, v44
  v_mul_f32 v45, v40, v45
  v_accvgpr_write_b32 a40, v42
  v_accvgpr_write_b32 a41, v43
  v_accvgpr_write_b32 a42, v44
  v_accvgpr_write_b32 a43, v45
  v_accvgpr_read_b32 v42, a44
  v_accvgpr_read_b32 v43, a45
  v_accvgpr_read_b32 v44, a46
  v_accvgpr_read_b32 v45, a47
  v_mul_f32 v42, v40, v42
  v_mul_f32 v43, v40, v43
  v_mul_f32 v44, v40, v44
  v_mul_f32 v45, v40, v45
  v_accvgpr_write_b32 a44, v42
  v_accvgpr_write_b32 a45, v43
  v_accvgpr_write_b32 a46, v44
  v_accvgpr_write_b32 a47, v45
  v_accvgpr_read_b32 v42, a48
  v_accvgpr_read_b32 v43, a49
  v_accvgpr_read_b32 v44, a50
  v_accvgpr_read_b32 v45, a51
  v_mul_f32 v42, v41, v42
  v_mul_f32 v43, v41, v43
  v_mul_f32 v44, v41, v44
  v_mul_f32 v45, v41, v45
  v_accvgpr_write_b32 a48, v42
  v_accvgpr_write_b32 a49, v43
  v_accvgpr_write_b32 a50, v44
  v_accvgpr_write_b32 a51, v45
  v_accvgpr_read_b32 v42, a52
  v_accvgpr_read_b32 v43, a53
  v_accvgpr_read_b32 v44, a54
  v_accvgpr_read_b32 v45, a55
  v_mul_f32 v42, v41, v42
  v_mul_f32 v43, v41, v43
  v_mul_f32 v44, v41, v44
  v_mul_f32 v45, v41, v45
  v_accvgpr_write_b32 a52, v42
  v_accvgpr_write_b32 a53, v43
  v_accvgpr_write_b32 a54, v44
  v_accvgpr_write_b32 a55, v45
  v_accvgpr_read_b32 v42, a56
  v_accvgpr_read_b32 v43, a57
  v_accvgpr_read_b32 v44, a58
  v_accvgpr_read_b32 v45, a59
  v_mul_f32 v42, v41, v42
  v_mul_f32 v43, v41, v43
  v_mul_f32 v44, v41, v44
  v_mul_f32 v45, v41, v45
  v_accvgpr_write_b32 a56, v42
  v_accvgpr_write_b32 a57, v43
  v_accvgpr_write_b32 a58, v44
  v_accvgpr_write_b32 a59, v45
  v_accvgpr_read_b32 v42, a60
  v_accvgpr_read_b32 v43, a61
  v_accvgpr_read_b32 v44, a62
  v_accvgpr_read_b32 v45, a63
  v_mul_f32 v42, v41, v42
  v_mul_f32 v43, v41, v43
  v_mul_f32 v44, v41, v44
  v_mul_f32 v45, v41, v45
  v_accvgpr_write_b32 a60, v42
  v_accvgpr_write_b32 a61, v43
  v_accvgpr_write_b32 a62, v44
  v_accvgpr_write_b32 a63, v45
  v_accvgpr_read_b32 v42, a64
  v_accvgpr_read_b32 v43, a65
  v_accvgpr_read_b32 v44, a66
  v_accvgpr_read_b32 v45, a67
  v_mul_f32 v42, v40, v42
  v_mul_f32 v43, v40, v43
  v_mul_f32 v44, v40, v44
  v_mul_f32 v45, v40, v45
  v_accvgpr_write_b32 a64, v42
  v_accvgpr_write_b32 a65, v43
  v_accvgpr_write_b32 a66, v44
  v_accvgpr_write_b32 a67, v45
  v_accvgpr_read_b32 v42, a68
  v_accvgpr_read_b32 v43, a69
  v_accvgpr_read_b32 v44, a70
  v_accvgpr_read_b32 v45, a71
  v_mul_f32 v42, v40, v42
  v_mul_f32 v43, v40, v43
  v_mul_f32 v44, v40, v44
  v_mul_f32 v45, v40, v45
  v_accvgpr_write_b32 a68, v42
  v_accvgpr_write_b32 a69, v43
  v_accvgpr_write_b32 a70, v44
  v_accvgpr_write_b32 a71, v45
  v_accvgpr_read_b32 v42, a72
  v_accvgpr_read_b32 v43, a73
  v_accvgpr_read_b32 v44, a74
  v_accvgpr_read_b32 v45, a75
  v_mul_f32 v42, v40, v42
  v_mul_f32 v43, v40, v43
  v_mul_f32 v44, v40, v44
  v_mul_f32 v45, v40, v45
  v_accvgpr_write_b32 a72, v42
  v_accvgpr_write_b32 a73, v43
  v_accvgpr_write_b32 a74, v44
  v_accvgpr_write_b32 a75, v45
  v_accvgpr_read_b32 v42, a76
  v_accvgpr_read_b32 v43, a77
  v_accvgpr_read_b32 v44, a78
  v_accvgpr_read_b32 v45, a79
  v_mul_f32 v42, v40, v42
  v_mul_f32 v43, v40, v43
  v_mul_f32 v44, v40, v44
  v_mul_f32 v45, v40, v45
  v_accvgpr_write_b32 a76, v42
  v_accvgpr_write_b32 a77, v43
  v_accvgpr_write_b32 a78, v44
  v_accvgpr_write_b32 a79, v45
  v_accvgpr_read_b32 v42, a80
  v_accvgpr_read_b32 v43, a81
  v_accvgpr_read_b32 v44, a82
  v_accvgpr_read_b32 v45, a83
  v_mul_f32 v42, v41, v42
  v_mul_f32 v43, v41, v43
  v_mul_f32 v44, v41, v44
  v_mul_f32 v45, v41, v45
  v_accvgpr_write_b32 a80, v42
  v_accvgpr_write_b32 a81, v43
  v_accvgpr_write_b32 a82, v44
  v_accvgpr_write_b32 a83, v45
  v_accvgpr_read_b32 v42, a84
  v_accvgpr_read_b32 v43, a85
  v_accvgpr_read_b32 v44, a86
  v_accvgpr_read_b32 v45, a87
  v_mul_f32 v42, v41, v42
  v_mul_f32 v43, v41, v43
  v_mul_f32 v44, v41, v44
  v_mul_f32 v45, v41, v45
  v_accvgpr_write_b32 a84, v42
  v_accvgpr_write_b32 a85, v43
  v_accvgpr_write_b32 a86, v44
  v_accvgpr_write_b32 a87, v45
  v_accvgpr_read_b32 v42, a88
  v_accvgpr_read_b32 v43, a89
  v_accvgpr_read_b32 v44, a90
  v_accvgpr_read_b32 v45, a91
  v_mul_f32 v42, v41, v42
  v_mul_f32 v43, v41, v43
  v_mul_f32 v44, v41, v44
  v_mul_f32 v45, v41, v45
  v_accvgpr_write_b32 a88, v42
  v_accvgpr_write_b32 a89, v43
  v_accvgpr_write_b32 a90, v44
  v_accvgpr_write_b32 a91, v45
  v_accvgpr_read_b32 v42, a92
  v_accvgpr_read_b32 v43, a93
  v_accvgpr_read_b32 v44, a94
  v_accvgpr_read_b32 v45, a95
  v_mul_f32 v42, v41, v42
  v_mul_f32 v43, v41, v43
  v_mul_f32 v44, v41, v44
  v_mul_f32 v45, v41, v45
  v_accvgpr_write_b32 a92, v42
  v_accvgpr_write_b32 a93, v43
  v_accvgpr_write_b32 a94, v44
  v_accvgpr_write_b32 a95, v45
  v_accvgpr_read_b32 v42, a96
  v_accvgpr_read_b32 v43, a97
  v_accvgpr_read_b32 v44, a98
  v_accvgpr_read_b32 v45, a99
  v_mul_f32 v42, v40, v42
  v_mul_f32 v43, v40, v43
  v_mul_f32 v44, v40, v44
  v_mul_f32 v45, v40, v45
  v_accvgpr_write_b32 a96, v42
  v_accvgpr_write_b32 a97, v43
  v_accvgpr_write_b32 a98, v44
  v_accvgpr_write_b32 a99, v45
  v_accvgpr_read_b32 v42, a100
  v_accvgpr_read_b32 v43, a101
  v_accvgpr_read_b32 v44, a102
  v_accvgpr_read_b32 v45, a103
  v_mul_f32 v42, v40, v42
  v_mul_f32 v43, v40, v43
  v_mul_f32 v44, v40, v44
  v_mul_f32 v45, v40, v45
  v_accvgpr_write_b32 a100, v42
  v_accvgpr_write_b32 a101, v43
  v_accvgpr_write_b32 a102, v44
  v_accvgpr_write_b32 a103, v45
  v_accvgpr_read_b32 v42, a104
  v_accvgpr_read_b32 v43, a105
  v_accvgpr_read_b32 v44, a106
  v_accvgpr_read_b32 v45, a107
  v_mul_f32 v42, v40, v42
  v_mul_f32 v43, v40, v43
  v_mul_f32 v44, v40, v44
  v_mul_f32 v45, v40, v45
  v_accvgpr_write_b32 a104, v42
  v_accvgpr_write_b32 a105, v43
  v_accvgpr_write_b32 a106, v44
  v_accvgpr_write_b32 a107, v45
  v_accvgpr_read_b32 v42, a108
  v_accvgpr_read_b32 v43, a109
  v_accvgpr_read_b32 v44, a110
  v_accvgpr_read_b32 v45, a111
  v_mul_f32 v42, v40, v42
  v_mul_f32 v43, v40, v43
  v_mul_f32 v44, v40, v44
  v_mul_f32 v45, v40, v45
  v_accvgpr_write_b32 a108, v42
  v_accvgpr_write_b32 a109, v43
  v_accvgpr_write_b32 a110, v44
  v_accvgpr_write_b32 a111, v45
  v_accvgpr_read_b32 v42, a112
  v_accvgpr_read_b32 v43, a113
  v_accvgpr_read_b32 v44, a114
  v_accvgpr_read_b32 v45, a115
  v_mul_f32 v42, v41, v42
  v_mul_f32 v43, v41, v43
  v_mul_f32 v44, v41, v44
  v_mul_f32 v45, v41, v45
  v_accvgpr_write_b32 a112, v42
  v_accvgpr_write_b32 a113, v43
  v_accvgpr_write_b32 a114, v44
  v_accvgpr_write_b32 a115, v45
  v_accvgpr_read_b32 v42, a116
  v_accvgpr_read_b32 v43, a117
  v_accvgpr_read_b32 v44, a118
  v_accvgpr_read_b32 v45, a119
  v_mul_f32 v42, v41, v42
  v_mul_f32 v43, v41, v43
  v_mul_f32 v44, v41, v44
  v_mul_f32 v45, v41, v45
  v_accvgpr_write_b32 a116, v42
  v_accvgpr_write_b32 a117, v43
  v_accvgpr_write_b32 a118, v44
  v_accvgpr_write_b32 a119, v45
  v_accvgpr_read_b32 v42, a120
  v_accvgpr_read_b32 v43, a121
  v_accvgpr_read_b32 v44, a122
  v_accvgpr_read_b32 v45, a123
  v_mul_f32 v42, v41, v42
  v_mul_f32 v43, v41, v43
  v_mul_f32 v44, v41, v44
  v_mul_f32 v45, v41, v45
  v_accvgpr_write_b32 a120, v42
  v_accvgpr_write_b32 a121, v43
  v_accvgpr_write_b32 a122, v44
  v_accvgpr_write_b32 a123, v45
  v_accvgpr_read_b32 v42, a124
  v_accvgpr_read_b32 v43, a125
  v_accvgpr_read_b32 v44, a126
  v_accvgpr_read_b32 v45, a127
  v_mul_f32 v42, v41, v42
  v_mul_f32 v43, v41, v43
  v_mul_f32 v44, v41, v44
  v_mul_f32 v45, v41, v45
  v_accvgpr_write_b32 a124, v42
  v_accvgpr_write_b32 a125, v43
  v_accvgpr_write_b32 a126, v44
  v_accvgpr_write_b32 a127, v45
  s_branch L1_backT1
L1_rareT0P:
  v_mov_b32 v38, v36
  v_mov_b32 v39, v37
  s_nop 1
  v_permlane32_swap_b32 v38, v39
  v_max_f32 v38, v38, v39
  v_mov_b32 v39, v38
  s_nop 1
  v_permlane32_swap_b32 v38, v39
  v_max_f32 v38, 0, v38
  v_sub_f32 v40, 0, v38
  v_exp_f32 v40, v40
  v_add_f32 v30, v30, v38
  v_mul_f32 v34, v34, v40
  v_max_f32 v39, 0, v39
  v_sub_f32 v41, 0, v39
  v_exp_f32 v41, v41
  v_add_f32 v31, v31, v39
  v_mul_f32 v35, v35, v41
  v_sub_f32 v80, v80, v38
  v_sub_f32 v81, v81, v38
  v_sub_f32 v82, v82, v38
  v_sub_f32 v83, v83, v38
  v_sub_f32 v84, v84, v38
  v_sub_f32 v85, v85, v38
  v_sub_f32 v86, v86, v38
  v_sub_f32 v87, v87, v38
  v_sub_f32 v88, v88, v38
  v_sub_f32 v89, v89, v38
  v_sub_f32 v90, v90, v38
  v_sub_f32 v91, v91, v38
  v_sub_f32 v92, v92, v38
  v_sub_f32 v93, v93, v38
  v_sub_f32 v94, v94, v38
  v_sub_f32 v95, v95, v38
  v_sub_f32 v96, v96, v39
  v_sub_f32 v97, v97, v39
  v_sub_f32 v98, v98, v39
  v_sub_f32 v99, v99, v39
  v_sub_f32 v100, v100, v39
  v_sub_f32 v101, v101, v39
  v_sub_f32 v102, v102, v39
  v_sub_f32 v103, v103, v39
  v_sub_f32 v104, v104, v39
  v_sub_f32 v105, v105, v39
  v_sub_f32 v106, v106, v39
  v_sub_f32 v107, v107, v39
  v_sub_f32 v108, v108, v39
  v_sub_f32 v109, v109, v39
  v_sub_f32 v110, v110, v39
  v_sub_f32 v111, v111, v39
  v_accvgpr_read_b32 v42, a0
  v_accvgpr_read_b32 v43, a1
  v_accvgpr_read_b32 v44, a2
  v_accvgpr_read_b32 v45, a3
  v_mul_f32 v42, v40, v42
  v_mul_f32 v43, v40, v43
  v_mul_f32 v44, v40, v44
  v_mul_f32 v45, v40, v45
  v_accvgpr_write_b32 a0, v42
  v_accvgpr_write_b32 a1, v43
  v_accvgpr_write_b32 a2, v44
  v_accvgpr_write_b32 a3, v45
  v_accvgpr_read_b32 v42, a4
  v_accvgpr_read_b32 v43, a5
  v_accvgpr_read_b32 v44, a6
  v_accvgpr_read_b32 v45, a7
  v_mul_f32 v42, v40, v42
  v_mul_f32 v43, v40, v43
  v_mul_f32 v44, v40, v44
  v_mul_f32 v45, v40, v45
  v_accvgpr_write_b32 a4, v42
  v_accvgpr_write_b32 a5, v43
  v_accvgpr_write_b32 a6, v44
  v_accvgpr_write_b32 a7, v45
  v_accvgpr_read_b32 v42, a8
  v_accvgpr_read_b32 v43, a9
  v_accvgpr_read_b32 v44, a10
  v_accvgpr_read_b32 v45, a11
  v_mul_f32 v42, v40, v42
  v_mul_f32 v43, v40, v43
  v_mul_f32 v44, v40, v44
  v_mul_f32 v45, v40, v45
  v_accvgpr_write_b32 a8, v42
  v_accvgpr_write_b32 a9, v43
  v_accvgpr_write_b32 a10, v44
  v_accvgpr_write_b32 a11, v45
  v_accvgpr_read_b32 v42, a12
  v_accvgpr_read_b32 v43, a13
  v_accvgpr_read_b32 v44, a14
  v_accvgpr_read_b32 v45, a15
  v_mul_f32 v42, v40, v42
  v_mul_f32 v43, v40, v43
  v_mul_f32 v44, v40, v44
  v_mul_f32 v45, v40, v45
  v_accvgpr_write_b32 a12, v42
  v_accvgpr_write_b32 a13, v43
  v_accvgpr_write_b32 a14, v44
  v_accvgpr_write_b32 a15, v45
  v_accvgpr_read_b32 v42, a16
  v_accvgpr_read_b32 v43, a17
  v_accvgpr_read_b32 v44, a18
  v_accvgpr_read_b32 v45, a19
  v_mul_f32 v42, v41, v42
  v_mul_f32 v43, v41, v43
  v_mul_f32 v44, v41, v44
  v_mul_f32 v45, v41, v45
  v_accvgpr_write_b32 a16, v42
  v_accvgpr_write_b32 a17, v43
  v_accvgpr_write_b32 a18, v44
  v_accvgpr_write_b32 a19, v45
  v_accvgpr_read_b32 v42, a20
  v_accvgpr_read_b32 v43, a21
  v_accvgpr_read_b32 v44, a22
  v_accvgpr_read_b32 v45, a23
  v_mul_f32 v42, v41, v42
  v_mul_f32 v43, v41, v43
  v_mul_f32 v44, v41, v44
  v_mul_f32 v45, v41, v45
  v_accvgpr_write_b32 a20, v42
  v_accvgpr_write_b32 a21, v43
  v_accvgpr_write_b32 a22, v44
  v_accvgpr_write_b32 a23, v45
  v_accvgpr_read_b32 v42, a24
  v_accvgpr_read_b32 v43, a25
  v_accvgpr_read_b32 v44, a26
  v_accvgpr_read_b32 v45, a27
  v_mul_f32 v42, v41, v42
  v_mul_f32 v43, v41, v43
  v_mul_f32 v44, v41, v44
  v_mul_f32 v45, v41, v45
  v_accvgpr_write_b32 a24, v42
  v_accvgpr_write_b32 a25, v43
  v_accvgpr_write_b32 a26, v44
  v_accvgpr_write_b32 a27, v45
  v_accvgpr_read_b32 v42, a28
  v_accvgpr_read_b32 v43, a29
  v_accvgpr_read_b32 v44, a30
  v_accvgpr_read_b32 v45, a31
  v_mul_f32 v42, v41, v42
  v_mul_f32 v43, v41, v43
  v_mul_f32 v44, v41, v44
  v_mul_f32 v45, v41, v45
  v_accvgpr_write_b32 a28, v42
  v_accvgpr_write_b32 a29, v43
  v_accvgpr_write_b32 a30, v44
  v_accvgpr_write_b32 a31, v45
  v_accvgpr_read_b32 v42, a32
  v_accvgpr_read_b32 v43, a33
  v_accvgpr_read_b32 v44, a34
  v_accvgpr_read_b32 v45, a35
  v_mul_f32 v42, v40, v42
  v_mul_f32 v43, v40, v43
  v_mul_f32 v44, v40, v44
  v_mul_f32 v45, v40, v45
  v_accvgpr_write_b32 a32, v42
  v_accvgpr_write_b32 a33, v43
  v_accvgpr_write_b32 a34, v44
  v_accvgpr_write_b32 a35, v45
  v_accvgpr_read_b32 v42, a36
  v_accvgpr_read_b32 v43, a37
  v_accvgpr_read_b32 v44, a38
  v_accvgpr_read_b32 v45, a39
  v_mul_f32 v42, v40, v42
  v_mul_f32 v43, v40, v43
  v_mul_f32 v44, v40, v44
  v_mul_f32 v45, v40, v45
  v_accvgpr_write_b32 a36, v42
  v_accvgpr_write_b32 a37, v43
  v_accvgpr_write_b32 a38, v44
  v_accvgpr_write_b32 a39, v45
  v_accvgpr_read_b32 v42, a40
  v_accvgpr_read_b32 v43, a41
  v_accvgpr_read_b32 v44, a42
  v_accvgpr_read_b32 v45, a43
  v_mul_f32 v42, v40, v42
  v_mul_f32 v43, v40, v43
  v_mul_f32 v44, v40, v44
  v_mul_f32 v45, v40, v45
  v_accvgpr_write_b32 a40, v42
  v_accvgpr_write_b32 a41, v43
  v_accvgpr_write_b32 a42, v44
  v_accvgpr_write_b32 a43, v45
  v_accvgpr_read_b32 v42, a44
  v_accvgpr_read_b32 v43, a45
  v_accvgpr_read_b32 v44, a46
  v_accvgpr_read_b32 v45, a47
  v_mul_f32 v42, v40, v42
  v_mul_f32 v43, v40, v43
  v_mul_f32 v44, v40, v44
  v_mul_f32 v45, v40, v45
  v_accvgpr_write_b32 a44, v42
  v_accvgpr_write_b32 a45, v43
  v_accvgpr_write_b32 a46, v44
  v_accvgpr_write_b32 a47, v45
  v_accvgpr_read_b32 v42, a48
  v_accvgpr_read_b32 v43, a49
  v_accvgpr_read_b32 v44, a50
  v_accvgpr_read_b32 v45, a51
  v_mul_f32 v42, v41, v42
  v_mul_f32 v43, v41, v43
  v_mul_f32 v44, v41, v44
  v_mul_f32 v45, v41, v45
  v_accvgpr_write_b32 a48, v42
  v_accvgpr_write_b32 a49, v43
  v_accvgpr_write_b32 a50, v44
  v_accvgpr_write_b32 a51, v45
  v_accvgpr_read_b32 v42, a52
  v_accvgpr_read_b32 v43, a53
  v_accvgpr_read_b32 v44, a54
  v_accvgpr_read_b32 v45, a55
  v_mul_f32 v42, v41, v42
  v_mul_f32 v43, v41, v43
  v_mul_f32 v44, v41, v44
  v_mul_f32 v45, v41, v45
  v_accvgpr_write_b32 a52, v42
  v_accvgpr_write_b32 a53, v43
  v_accvgpr_write_b32 a54, v44
  v_accvgpr_write_b32 a55, v45
  v_accvgpr_read_b32 v42, a56
  v_accvgpr_read_b32 v43, a57
  v_accvgpr_read_b32 v44, a58
  v_accvgpr_read_b32 v45, a59
  v_mul_f32 v42, v41, v42
  v_mul_f32 v43, v41, v43
  v_mul_f32 v44, v41, v44
  v_mul_f32 v45, v41, v45
  v_accvgpr_write_b32 a56, v42
  v_accvgpr_write_b32 a57, v43
  v_accvgpr_write_b32 a58, v44
  v_accvgpr_write_b32 a59, v45
  v_accvgpr_read_b32 v42, a60
  v_accvgpr_read_b32 v43, a61
  v_accvgpr_read_b32 v44, a62
  v_accvgpr_read_b32 v45, a63
  v_mul_f32 v42, v41, v42
  v_mul_f32 v43, v41, v43
  v_mul_f32 v44, v41, v44
  v_mul_f32 v45, v41, v45
  v_accvgpr_write_b32 a60, v42
  v_accvgpr_write_b32 a61, v43
  v_accvgpr_write_b32 a62, v44
  v_accvgpr_write_b32 a63, v45
  v_accvgpr_read_b32 v42, a64
  v_accvgpr_read_b32 v43, a65
  v_accvgpr_read_b32 v44, a66
  v_accvgpr_read_b32 v45, a67
  v_mul_f32 v42, v40, v42
  v_mul_f32 v43, v40, v43
  v_mul_f32 v44, v40, v44
  v_mul_f32 v45, v40, v45
  v_accvgpr_write_b32 a64, v42
  v_accvgpr_write_b32 a65, v43
  v_accvgpr_write_b32 a66, v44
  v_accvgpr_write_b32 a67, v45
  v_accvgpr_read_b32 v42, a68
  v_accvgpr_read_b32 v43, a69
  v_accvgpr_read_b32 v44, a70
  v_accvgpr_read_b32 v45, a71
  v_mul_f32 v42, v40, v42
  v_mul_f32 v43, v40, v43
  v_mul_f32 v44, v40, v44
  v_mul_f32 v45, v40, v45
  v_accvgpr_write_b32 a68, v42
  v_accvgpr_write_b32 a69, v43
  v_accvgpr_write_b32 a70, v44
  v_accvgpr_write_b32 a71, v45
  v_accvgpr_read_b32 v42, a72
  v_accvgpr_read_b32 v43, a73
  v_accvgpr_read_b32 v44, a74
  v_accvgpr_read_b32 v45, a75
  v_mul_f32 v42, v40, v42
  v_mul_f32 v43, v40, v43
  v_mul_f32 v44, v40, v44
  v_mul_f32 v45, v40, v45
  v_accvgpr_write_b32 a72, v42
  v_accvgpr_write_b32 a73, v43
  v_accvgpr_write_b32 a74, v44
  v_accvgpr_write_b32 a75, v45
  v_accvgpr_read_b32 v42, a76
  v_accvgpr_read_b32 v43, a77
  v_accvgpr_read_b32 v44, a78
  v_accvgpr_read_b32 v45, a79
  v_mul_f32 v42, v40, v42
  v_mul_f32 v43, v40, v43
  v_mul_f32 v44, v40, v44
  v_mul_f32 v45, v40, v45
  v_accvgpr_write_b32 a76, v42
  v_accvgpr_write_b32 a77, v43
  v_accvgpr_write_b32 a78, v44
  v_accvgpr_write_b32 a79, v45
  v_accvgpr_read_b32 v42, a80
  v_accvgpr_read_b32 v43, a81
  v_accvgpr_read_b32 v44, a82
  v_accvgpr_read_b32 v45, a83
  v_mul_f32 v42, v41, v42
  v_mul_f32 v43, v41, v43
  v_mul_f32 v44, v41, v44
  v_mul_f32 v45, v41, v45
  v_accvgpr_write_b32 a80, v42
  v_accvgpr_write_b32 a81, v43
  v_accvgpr_write_b32 a82, v44
  v_accvgpr_write_b32 a83, v45
  v_accvgpr_read_b32 v42, a84
  v_accvgpr_read_b32 v43, a85
  v_accvgpr_read_b32 v44, a86
  v_accvgpr_read_b32 v45, a87
  v_mul_f32 v42, v41, v42
  v_mul_f32 v43, v41, v43
  v_mul_f32 v44, v41, v44
  v_mul_f32 v45, v41, v45
  v_accvgpr_write_b32 a84, v42
  v_accvgpr_write_b32 a85, v43
  v_accvgpr_write_b32 a86, v44
  v_accvgpr_write_b32 a87, v45
  v_accvgpr_read_b32 v42, a88
  v_accvgpr_read_b32 v43, a89
  v_accvgpr_read_b32 v44, a90
  v_accvgpr_read_b32 v45, a91
  v_mul_f32 v42, v41, v42
  v_mul_f32 v43, v41, v43
  v_mul_f32 v44, v41, v44
  v_mul_f32 v45, v41, v45
  v_accvgpr_write_b32 a88, v42
  v_accvgpr_write_b32 a89, v43
  v_accvgpr_write_b32 a90, v44
  v_accvgpr_write_b32 a91, v45
  v_accvgpr_read_b32 v42, a92
  v_accvgpr_read_b32 v43, a93
  v_accvgpr_read_b32 v44, a94
  v_accvgpr_read_b32 v45, a95
  v_mul_f32 v42, v41, v42
  v_mul_f32 v43, v41, v43
  v_mul_f32 v44, v41, v44
  v_mul_f32 v45, v41, v45
  v_accvgpr_write_b32 a92, v42
  v_accvgpr_write_b32 a93, v43
  v_accvgpr_write_b32 a94, v44
  v_accvgpr_write_b32 a95, v45
  v_accvgpr_read_b32 v42, a96
  v_accvgpr_read_b32 v43, a97
  v_accvgpr_read_b32 v44, a98
  v_accvgpr_read_b32 v45, a99
  v_mul_f32 v42, v40, v42
  v_mul_f32 v43, v40, v43
  v_mul_f32 v44, v40, v44
  v_mul_f32 v45, v40, v45
  v_accvgpr_write_b32 a96, v42
  v_accvgpr_write_b32 a97, v43
  v_accvgpr_write_b32 a98, v44
  v_accvgpr_write_b32 a99, v45
  v_accvgpr_read_b32 v42, a100
  v_accvgpr_read_b32 v43, a101
  v_accvgpr_read_b32 v44, a102
  v_accvgpr_read_b32 v45, a103
  v_mul_f32 v42, v40, v42
  v_mul_f32 v43, v40, v43
  v_mul_f32 v44, v40, v44
  v_mul_f32 v45, v40, v45
  v_accvgpr_write_b32 a100, v42
  v_accvgpr_write_b32 a101, v43
  v_accvgpr_write_b32 a102, v44
  v_accvgpr_write_b32 a103, v45
  v_accvgpr_read_b32 v42, a104
  v_accvgpr_read_b32 v43, a105
  v_accvgpr_read_b32 v44, a106
  v_accvgpr_read_b32 v45, a107
  v_mul_f32 v42, v40, v42
  v_mul_f32 v43, v40, v43
  v_mul_f32 v44, v40, v44
  v_mul_f32 v45, v40, v45
  v_accvgpr_write_b32 a104, v42
  v_accvgpr_write_b32 a105, v43
  v_accvgpr_write_b32 a106, v44
  v_accvgpr_write_b32 a107, v45
  v_accvgpr_read_b32 v42, a108
  v_accvgpr_read_b32 v43, a109
  v_accvgpr_read_b32 v44, a110
  v_accvgpr_read_b32 v45, a111
  v_mul_f32 v42, v40, v42
  v_mul_f32 v43, v40, v43
  v_mul_f32 v44, v40, v44
  v_mul_f32 v45, v40, v45
  v_accvgpr_write_b32 a108, v42
  v_accvgpr_write_b32 a109, v43
  v_accvgpr_write_b32 a110, v44
  v_accvgpr_write_b32 a111, v45
  v_accvgpr_read_b32 v42, a112
  v_accvgpr_read_b32 v43, a113
  v_accvgpr_read_b32 v44, a114
  v_accvgpr_read_b32 v45, a115
  v_mul_f32 v42, v41, v42
  v_mul_f32 v43, v41, v43
  v_mul_f32 v44, v41, v44
  v_mul_f32 v45, v41, v45
  v_accvgpr_write_b32 a112, v42
  v_accvgpr_write_b32 a113, v43
  v_accvgpr_write_b32 a114, v44
  v_accvgpr_write_b32 a115, v45
  v_accvgpr_read_b32 v42, a116
  v_accvgpr_read_b32 v43, a117
  v_accvgpr_read_b32 v44, a118
  v_accvgpr_read_b32 v45, a119
  v_mul_f32 v42, v41, v42
  v_mul_f32 v43, v41, v43
  v_mul_f32 v44, v41, v44
  v_mul_f32 v45, v41, v45
  v_accvgpr_write_b32 a116, v42
  v_accvgpr_write_b32 a117, v43
  v_accvgpr_write_b32 a118, v44
  v_accvgpr_write_b32 a119, v45
  v_accvgpr_read_b32 v42, a120
  v_accvgpr_read_b32 v43, a121
  v_accvgpr_read_b32 v44, a122
  v_accvgpr_read_b32 v45, a123
  v_mul_f32 v42, v41, v42
  v_mul_f32 v43, v41, v43
  v_mul_f32 v44, v41, v44
  v_mul_f32 v45, v41, v45
  v_accvgpr_write_b32 a120, v42
  v_accvgpr_write_b32 a121, v43
  v_accvgpr_write_b32 a122, v44
  v_accvgpr_write_b32 a123, v45
  v_accvgpr_read_b32 v42, a124
  v_accvgpr_read_b32 v43, a125
  v_accvgpr_read_b32 v44, a126
  v_accvgpr_read_b32 v45, a127
  v_mul_f32 v42, v41, v42
  v_mul_f32 v43, v41, v43
  v_mul_f32 v44, v41, v44
  v_mul_f32 v45, v41, v45
  v_accvgpr_write_b32 a124, v42
  v_accvgpr_write_b32 a125, v43
  v_accvgpr_write_b32 a126, v44
  v_accvgpr_write_b32 a127, v45
  s_branch L1_backT0P
L1_rareT0C:
  v_mov_b32 v38, v36
  v_mov_b32 v39, v37
  s_nop 1
  v_permlane32_swap_b32 v38, v39
  v_max_f32 v38, v38, v39
  v_mov_b32 v39, v38
  s_nop 1
  v_permlane32_swap_b32 v38, v39
  v_max_f32 v38, 0, v38
  v_sub_f32 v40, 0, v38
  v_exp_f32 v40, v40
  v_add_f32 v30, v30, v38
  v_mul_f32 v34, v34, v40
  v_max_f32 v39, 0, v39
  v_sub_f32 v41, 0, v39
  v_exp_f32 v41, v41
  v_add_f32 v31, v31, v39
  v_mul_f32 v35, v35, v41
  v_sub_f32 v80, v80, v38
  v_sub_f32 v81, v81, v38
  v_sub_f32 v82, v82, v38
  v_sub_f32 v83, v83, v38
  v_sub_f32 v84, v84, v38
  v_sub_f32 v85, v85, v38
  v_sub_f32 v86, v86, v38
  v_sub_f32 v87, v87, v38
  v_sub_f32 v88, v88, v38
  v_sub_f32 v89, v89, v38
  v_sub_f32 v90, v90, v38
  v_sub_f32 v91, v91, v38
  v_sub_f32 v92, v92, v38
  v_sub_f32 v93, v93, v38
  v_sub_f32 v94, v94, v38
  v_sub_f32 v95, v95, v38
  v_sub_f32 v96, v96, v39
  v_sub_f32 v97, v97, v39
  v_sub_f32 v98, v98, v39
  v_sub_f32 v99, v99, v39
  v_sub_f32 v100, v100, v39
  v_sub_f32 v101, v101, v39
  v_sub_f32 v102, v102, v39
  v_sub_f32 v103, v103, v39
  v_sub_f32 v104, v104, v39
  v_sub_f32 v105, v105, v39
  v_sub_f32 v106, v106, v39
  v_sub_f32 v107, v107, v39
  v_sub_f32 v108, v108, v39
  v_sub_f32 v109, v109, v39
  v_sub_f32 v110, v110, v39
  v_sub_f32 v111, v111, v39
  v_accvgpr_read_b32 v42, a0
  v_accvgpr_read_b32 v43, a1
  v_accvgpr_read_b32 v44, a2
  v_accvgpr_read_b32 v45, a3
  v_mul_f32 v42, v40, v42
  v_mul_f32 v43, v40, v43
  v_mul_f32 v44, v40, v44
  v_mul_f32 v45, v40, v45
  v_accvgpr_write_b32 a0, v42
  v_accvgpr_write_b32 a1, v43
  v_accvgpr_write_b32 a2, v44
  v_accvgpr_write_b32 a3, v45
  v_accvgpr_read_b32 v42, a4
  v_accvgpr_read_b32 v43, a5
  v_accvgpr_read_b32 v44, a6
  v_accvgpr_read_b32 v45, a7
  v_mul_f32 v42, v40, v42
  v_mul_f32 v43, v40, v43
  v_mul_f32 v44, v40, v44
  v_mul_f32 v45, v40, v45
  v_accvgpr_write_b32 a4, v42
  v_accvgpr_write_b32 a5, v43
  v_accvgpr_write_b32 a6, v44
  v_accvgpr_write_b32 a7, v45
  v_accvgpr_read_b32 v42, a8
  v_accvgpr_read_b32 v43, a9
  v_accvgpr_read_b32 v44, a10
  v_accvgpr_read_b32 v45, a11
  v_mul_f32 v42, v40, v42
  v_mul_f32 v43, v40, v43
  v_mul_f32 v44, v40, v44
  v_mul_f32 v45, v40, v45
  v_accvgpr_write_b32 a8, v42
  v_accvgpr_write_b32 a9, v43
  v_accvgpr_write_b32 a10, v44
  v_accvgpr_write_b32 a11, v45
  v_accvgpr_read_b32 v42, a12
  v_accvgpr_read_b32 v43, a13
  v_accvgpr_read_b32 v44, a14
  v_accvgpr_read_b32 v45, a15
  v_mul_f32 v42, v40, v42
  v_mul_f32 v43, v40, v43
  v_mul_f32 v44, v40, v44
  v_mul_f32 v45, v40, v45
  v_accvgpr_write_b32 a12, v42
  v_accvgpr_write_b32 a13, v43
  v_accvgpr_write_b32 a14, v44
  v_accvgpr_write_b32 a15, v45
  v_accvgpr_read_b32 v42, a16
  v_accvgpr_read_b32 v43, a17
  v_accvgpr_read_b32 v44, a18
  v_accvgpr_read_b32 v45, a19
  v_mul_f32 v42, v41, v42
  v_mul_f32 v43, v41, v43
  v_mul_f32 v44, v41, v44
  v_mul_f32 v45, v41, v45
  v_accvgpr_write_b32 a16, v42
  v_accvgpr_write_b32 a17, v43
  v_accvgpr_write_b32 a18, v44
  v_accvgpr_write_b32 a19, v45
  v_accvgpr_read_b32 v42, a20
  v_accvgpr_read_b32 v43, a21
  v_accvgpr_read_b32 v44, a22
  v_accvgpr_read_b32 v45, a23
  v_mul_f32 v42, v41, v42
  v_mul_f32 v43, v41, v43
  v_mul_f32 v44, v41, v44
  v_mul_f32 v45, v41, v45
  v_accvgpr_write_b32 a20, v42
  v_accvgpr_write_b32 a21, v43
  v_accvgpr_write_b32 a22, v44
  v_accvgpr_write_b32 a23, v45
  v_accvgpr_read_b32 v42, a24
  v_accvgpr_read_b32 v43, a25
  v_accvgpr_read_b32 v44, a26
  v_accvgpr_read_b32 v45, a27
  v_mul_f32 v42, v41, v42
  v_mul_f32 v43, v41, v43
  v_mul_f32 v44, v41, v44
  v_mul_f32 v45, v41, v45
  v_accvgpr_write_b32 a24, v42
  v_accvgpr_write_b32 a25, v43
  v_accvgpr_write_b32 a26, v44
  v_accvgpr_write_b32 a27, v45
  v_accvgpr_read_b32 v42, a28
  v_accvgpr_read_b32 v43, a29
  v_accvgpr_read_b32 v44, a30
  v_accvgpr_read_b32 v45, a31
  v_mul_f32 v42, v41, v42
  v_mul_f32 v43, v41, v43
  v_mul_f32 v44, v41, v44
  v_mul_f32 v45, v41, v45
  v_accvgpr_write_b32 a28, v42
  v_accvgpr_write_b32 a29, v43
  v_accvgpr_write_b32 a30, v44
  v_accvgpr_write_b32 a31, v45
  v_accvgpr_read_b32 v42, a32
  v_accvgpr_read_b32 v43, a33
  v_accvgpr_read_b32 v44, a34
  v_accvgpr_read_b32 v45, a35
  v_mul_f32 v42, v40, v42
  v_mul_f32 v43, v40, v43
  v_mul_f32 v44, v40, v44
  v_mul_f32 v45, v40, v45
  v_accvgpr_write_b32 a32, v42
  v_accvgpr_write_b32 a33, v43
  v_accvgpr_write_b32 a34, v44
  v_accvgpr_write_b32 a35, v45
  v_accvgpr_read_b32 v42, a36
  v_accvgpr_read_b32 v43, a37
  v_accvgpr_read_b32 v44, a38
  v_accvgpr_read_b32 v45, a39
  v_mul_f32 v42, v40, v42
  v_mul_f32 v43, v40, v43
  v_mul_f32 v44, v40, v44
  v_mul_f32 v45, v40, v45
  v_accvgpr_write_b32 a36, v42
  v_accvgpr_write_b32 a37, v43
  v_accvgpr_write_b32 a38, v44
  v_accvgpr_write_b32 a39, v45
  v_accvgpr_read_b32 v42, a40
  v_accvgpr_read_b32 v43, a41
  v_accvgpr_read_b32 v44, a42
  v_accvgpr_read_b32 v45, a43
  v_mul_f32 v42, v40, v42
  v_mul_f32 v43, v40, v43
  v_mul_f32 v44, v40, v44
  v_mul_f32 v45, v40, v45
  v_accvgpr_write_b32 a40, v42
  v_accvgpr_write_b32 a41, v43
  v_accvgpr_write_b32 a42, v44
  v_accvgpr_write_b32 a43, v45
  v_accvgpr_read_b32 v42, a44
  v_accvgpr_read_b32 v43, a45
  v_accvgpr_read_b32 v44, a46
  v_accvgpr_read_b32 v45, a47
  v_mul_f32 v42, v40, v42
  v_mul_f32 v43, v40, v43
  v_mul_f32 v44, v40, v44
  v_mul_f32 v45, v40, v45
  v_accvgpr_write_b32 a44, v42
  v_accvgpr_write_b32 a45, v43
  v_accvgpr_write_b32 a46, v44
  v_accvgpr_write_b32 a47, v45
  v_accvgpr_read_b32 v42, a48
  v_accvgpr_read_b32 v43, a49
  v_accvgpr_read_b32 v44, a50
  v_accvgpr_read_b32 v45, a51
  v_mul_f32 v42, v41, v42
  v_mul_f32 v43, v41, v43
  v_mul_f32 v44, v41, v44
  v_mul_f32 v45, v41, v45
  v_accvgpr_write_b32 a48, v42
  v_accvgpr_write_b32 a49, v43
  v_accvgpr_write_b32 a50, v44
  v_accvgpr_write_b32 a51, v45
  v_accvgpr_read_b32 v42, a52
  v_accvgpr_read_b32 v43, a53
  v_accvgpr_read_b32 v44, a54
  v_accvgpr_read_b32 v45, a55
  v_mul_f32 v42, v41, v42
  v_mul_f32 v43, v41, v43
  v_mul_f32 v44, v41, v44
  v_mul_f32 v45, v41, v45
  v_accvgpr_write_b32 a52, v42
  v_accvgpr_write_b32 a53, v43
  v_accvgpr_write_b32 a54, v44
  v_accvgpr_write_b32 a55, v45
  v_accvgpr_read_b32 v42, a56
  v_accvgpr_read_b32 v43, a57
  v_accvgpr_read_b32 v44, a58
  v_accvgpr_read_b32 v45, a59
  v_mul_f32 v42, v41, v42
  v_mul_f32 v43, v41, v43
  v_mul_f32 v44, v41, v44
  v_mul_f32 v45, v41, v45
  v_accvgpr_write_b32 a56, v42
  v_accvgpr_write_b32 a57, v43
  v_accvgpr_write_b32 a58, v44
  v_accvgpr_write_b32 a59, v45
  v_accvgpr_read_b32 v42, a60
  v_accvgpr_read_b32 v43, a61
  v_accvgpr_read_b32 v44, a62
  v_accvgpr_read_b32 v45, a63
  v_mul_f32 v42, v41, v42
  v_mul_f32 v43, v41, v43
  v_mul_f32 v44, v41, v44
  v_mul_f32 v45, v41, v45
  v_accvgpr_write_b32 a60, v42
  v_accvgpr_write_b32 a61, v43
  v_accvgpr_write_b32 a62, v44
  v_accvgpr_write_b32 a63, v45
  v_accvgpr_read_b32 v42, a64
  v_accvgpr_read_b32 v43, a65
  v_accvgpr_read_b32 v44, a66
  v_accvgpr_read_b32 v45, a67
  v_mul_f32 v42, v40, v42
  v_mul_f32 v43, v40, v43
  v_mul_f32 v44, v40, v44
  v_mul_f32 v45, v40, v45
  v_accvgpr_write_b32 a64, v42
  v_accvgpr_write_b32 a65, v43
  v_accvgpr_write_b32 a66, v44
  v_accvgpr_write_b32 a67, v45
  v_accvgpr_read_b32 v42, a68
  v_accvgpr_read_b32 v43, a69
  v_accvgpr_read_b32 v44, a70
  v_accvgpr_read_b32 v45, a71
  v_mul_f32 v42, v40, v42
  v_mul_f32 v43, v40, v43
  v_mul_f32 v44, v40, v44
  v_mul_f32 v45, v40, v45
  v_accvgpr_write_b32 a68, v42
  v_accvgpr_write_b32 a69, v43
  v_accvgpr_write_b32 a70, v44
  v_accvgpr_write_b32 a71, v45
  v_accvgpr_read_b32 v42, a72
  v_accvgpr_read_b32 v43, a73
  v_accvgpr_read_b32 v44, a74
  v_accvgpr_read_b32 v45, a75
  v_mul_f32 v42, v40, v42
  v_mul_f32 v43, v40, v43
  v_mul_f32 v44, v40, v44
  v_mul_f32 v45, v40, v45
  v_accvgpr_write_b32 a72, v42
  v_accvgpr_write_b32 a73, v43
  v_accvgpr_write_b32 a74, v44
  v_accvgpr_write_b32 a75, v45
  v_accvgpr_read_b32 v42, a76
  v_accvgpr_read_b32 v43, a77
  v_accvgpr_read_b32 v44, a78
  v_accvgpr_read_b32 v45, a79
  v_mul_f32 v42, v40, v42
  v_mul_f32 v43, v40, v43
  v_mul_f32 v44, v40, v44
  v_mul_f32 v45, v40, v45
  v_accvgpr_write_b32 a76, v42
  v_accvgpr_write_b32 a77, v43
  v_accvgpr_write_b32 a78, v44
  v_accvgpr_write_b32 a79, v45
  v_accvgpr_read_b32 v42, a80
  v_accvgpr_read_b32 v43, a81
  v_accvgpr_read_b32 v44, a82
  v_accvgpr_read_b32 v45, a83
  v_mul_f32 v42, v41, v42
  v_mul_f32 v43, v41, v43
  v_mul_f32 v44, v41, v44
  v_mul_f32 v45, v41, v45
  v_accvgpr_write_b32 a80, v42
  v_accvgpr_write_b32 a81, v43
  v_accvgpr_write_b32 a82, v44
  v_accvgpr_write_b32 a83, v45
  v_accvgpr_read_b32 v42, a84
  v_accvgpr_read_b32 v43, a85
  v_accvgpr_read_b32 v44, a86
  v_accvgpr_read_b32 v45, a87
  v_mul_f32 v42, v41, v42
  v_mul_f32 v43, v41, v43
  v_mul_f32 v44, v41, v44
  v_mul_f32 v45, v41, v45
  v_accvgpr_write_b32 a84, v42
  v_accvgpr_write_b32 a85, v43
  v_accvgpr_write_b32 a86, v44
  v_accvgpr_write_b32 a87, v45
  v_accvgpr_read_b32 v42, a88
  v_accvgpr_read_b32 v43, a89
  v_accvgpr_read_b32 v44, a90
  v_accvgpr_read_b32 v45, a91
  v_mul_f32 v42, v41, v42
  v_mul_f32 v43, v41, v43
  v_mul_f32 v44, v41, v44
  v_mul_f32 v45, v41, v45
  v_accvgpr_write_b32 a88, v42
  v_accvgpr_write_b32 a89, v43
  v_accvgpr_write_b32 a90, v44
  v_accvgpr_write_b32 a91, v45
  v_accvgpr_read_b32 v42, a92
  v_accvgpr_read_b32 v43, a93
  v_accvgpr_read_b32 v44, a94
  v_accvgpr_read_b32 v45, a95
  v_mul_f32 v42, v41, v42
  v_mul_f32 v43, v41, v43
  v_mul_f32 v44, v41, v44
  v_mul_f32 v45, v41, v45
  v_accvgpr_write_b32 a92, v42
  v_accvgpr_write_b32 a93, v43
  v_accvgpr_write_b32 a94, v44
  v_accvgpr_write_b32 a95, v45
  v_accvgpr_read_b32 v42, a96
  v_accvgpr_read_b32 v43, a97
  v_accvgpr_read_b32 v44, a98
  v_accvgpr_read_b32 v45, a99
  v_mul_f32 v42, v40, v42
  v_mul_f32 v43, v40, v43
  v_mul_f32 v44, v40, v44
  v_mul_f32 v45, v40, v45
  v_accvgpr_write_b32 a96, v42
  v_accvgpr_write_b32 a97, v43
  v_accvgpr_write_b32 a98, v44
  v_accvgpr_write_b32 a99, v45
  v_accvgpr_read_b32 v42, a100
  v_accvgpr_read_b32 v43, a101
  v_accvgpr_read_b32 v44, a102
  v_accvgpr_read_b32 v45, a103
  v_mul_f32 v42, v40, v42
  v_mul_f32 v43, v40, v43
  v_mul_f32 v44, v40, v44
  v_mul_f32 v45, v40, v45
  v_accvgpr_write_b32 a100, v42
  v_accvgpr_write_b32 a101, v43
  v_accvgpr_write_b32 a102, v44
  v_accvgpr_write_b32 a103, v45
  v_accvgpr_read_b32 v42, a104
  v_accvgpr_read_b32 v43, a105
  v_accvgpr_read_b32 v44, a106
  v_accvgpr_read_b32 v45, a107
  v_mul_f32 v42, v40, v42
  v_mul_f32 v43, v40, v43
  v_mul_f32 v44, v40, v44
  v_mul_f32 v45, v40, v45
  v_accvgpr_write_b32 a104, v42
  v_accvgpr_write_b32 a105, v43
  v_accvgpr_write_b32 a106, v44
  v_accvgpr_write_b32 a107, v45
  v_accvgpr_read_b32 v42, a108
  v_accvgpr_read_b32 v43, a109
  v_accvgpr_read_b32 v44, a110
  v_accvgpr_read_b32 v45, a111
  v_mul_f32 v42, v40, v42
  v_mul_f32 v43, v40, v43
  v_mul_f32 v44, v40, v44
  v_mul_f32 v45, v40, v45
  v_accvgpr_write_b32 a108, v42
  v_accvgpr_write_b32 a109, v43
  v_accvgpr_write_b32 a110, v44
  v_accvgpr_write_b32 a111, v45
  v_accvgpr_read_b32 v42, a112
  v_accvgpr_read_b32 v43, a113
  v_accvgpr_read_b32 v44, a114
  v_accvgpr_read_b32 v45, a115
  v_mul_f32 v42, v41, v42
  v_mul_f32 v43, v41, v43
  v_mul_f32 v44, v41, v44
  v_mul_f32 v45, v41, v45
  v_accvgpr_write_b32 a112, v42
  v_accvgpr_write_b32 a113, v43
  v_accvgpr_write_b32 a114, v44
  v_accvgpr_write_b32 a115, v45
  v_accvgpr_read_b32 v42, a116
  v_accvgpr_read_b32 v43, a117
  v_accvgpr_read_b32 v44, a118
  v_accvgpr_read_b32 v45, a119
  v_mul_f32 v42, v41, v42
  v_mul_f32 v43, v41, v43
  v_mul_f32 v44, v41, v44
  v_mul_f32 v45, v41, v45
  v_accvgpr_write_b32 a116, v42
  v_accvgpr_write_b32 a117, v43
  v_accvgpr_write_b32 a118, v44
  v_accvgpr_write_b32 a119, v45
  v_accvgpr_read_b32 v42, a120
  v_accvgpr_read_b32 v43, a121
  v_accvgpr_read_b32 v44, a122
  v_accvgpr_read_b32 v45, a123
  v_mul_f32 v42, v41, v42
  v_mul_f32 v43, v41, v43
  v_mul_f32 v44, v41, v44
  v_mul_f32 v45, v41, v45
  v_accvgpr_write_b32 a120, v42
  v_accvgpr_write_b32 a121, v43
  v_accvgpr_write_b32 a122, v44
  v_accvgpr_write_b32 a123, v45
  v_accvgpr_read_b32 v42, a124
  v_accvgpr_read_b32 v43, a125
  v_accvgpr_read_b32 v44, a126
  v_accvgpr_read_b32 v45, a127
  v_mul_f32 v42, v41, v42
  v_mul_f32 v43, v41, v43
  v_mul_f32 v44, v41, v44
  v_mul_f32 v45, v41, v45
  v_accvgpr_write_b32 a124, v42
  v_accvgpr_write_b32 a125, v43
  v_accvgpr_write_b32 a126, v44
  v_accvgpr_write_b32 a127, v45
  s_branch L1_backT0C
.section .rodata,"a"
.p2align 6
.amdhsa_kernel standalone__gqa_block_cached__near_ridge_kernel
  .amdhsa_next_free_vgpr 512
  .amdhsa_next_free_sgpr 100
  .amdhsa_accum_offset 256
  .amdhsa_group_segment_fixed_size 0
  .amdhsa_kernarg_size 64
  .amdhsa_user_sgpr_count 2
  .amdhsa_user_sgpr_kernarg_segment_ptr 1
  .amdhsa_system_sgpr_workgroup_id_x 1
.end_amdhsa_kernel
.text
```
